```python
import torch

def _softmax(x, axis=-1):
    return torch.softmax(x, dim=axis)
def _gelu(x):
    return torch.nn.functional.gelu(x, approximate="tanh")
def _silu(x):
    return torch.nn.functional.silu(x)
def _sigmoid(x):
    return torch.sigmoid(x)
def _layernorm(x, axis=-1, eps=1e-5):
    m = x.mean(dim=axis, keepdim=True)
    v = x.var(dim=axis, keepdim=True, unbiased=False)
    return (x - m) / torch.sqrt(v + eps)
def _scatter_add(tgt, idx, src, axis=0):
    return tgt.clone().index_add_(axis, idx, src)
def _segment_sum(src, seg, n):
    out = torch.zeros((n,) + src.shape[1:], dtype=src.dtype)
    return out.index_add_(0, seg, src)
def _pad(x, pw):
    flat = tuple(v for pair in reversed(pw) for v in pair)
    return torch.nn.functional.pad(x, flat)

kernel_name = 'gated_mix__ssm_conv_s5__glu_gated_geglu__prompt'

def setup_inputs():

    _w = (lambda a: (lambda t: t.to(torch.bfloat16) if t.is_floating_point() else t)(torch.as_tensor(a)))
    def _A_setup():
        B, S, D = 1, 2048, 1024
        P = D
        Lambda_re = -0.5 * (lambda _x: torch.exp(torch.as_tensor(_x)))((lambda *s: torch.randn(*s, dtype=torch.bfloat16) * 0.4)(P))
        Lambda_im = (lambda *s: torch.randn(*s, dtype=torch.bfloat16) * 0.8)(P) * 1.0
        B_re = (lambda *s: torch.randn(*s, dtype=torch.bfloat16) * 0.4)(P, D) * (D ** -0.5)
        B_im = (lambda *s: torch.randn(*s, dtype=torch.bfloat16) * 0.4)(P, D) * (D ** -0.5)
        C_re = (lambda *s: torch.randn(*s, dtype=torch.bfloat16) * 0.4)(D, P) * (P ** -0.5)
        C_im = (lambda *s: torch.randn(*s, dtype=torch.bfloat16) * 0.4)(D, P) * (P ** -0.5)
        log_dt = (lambda *s: torch.randn(*s, dtype=torch.bfloat16) * 0.4)(P) * 0.3 - 2.0
        Dskip = (lambda *s: torch.randn(*s, dtype=torch.bfloat16) * 0.1)(D)
        return {
            "x": _w((lambda *s: torch.randn(*s, dtype=torch.bfloat16) * 0.05)(B, S, D)),
            "Lambda_re": _w(Lambda_re),
            "Lambda_im": _w(Lambda_im),
            "B_re": _w(B_re),
            "B_im": _w(B_im),
            "C_re": _w(C_re),
            "C_im": _w(C_im),
            "log_dt": _w(log_dt),
            "Dskip": _w(Dskip),
        }
    _A_in = _A_setup()

    def _B_setup():
        B, S, Dm, Df = 1, 2048, 1024, 3584
        return {
            "x": _w((lambda *s: torch.randn(*s, dtype=torch.bfloat16) * 0.05)(B, S, Dm)),
            "w_gate": _w((lambda *s: torch.randn(*s, dtype=torch.bfloat16) * 3.2)(Dm, Df) * (Dm ** -0.5)),
            "w_up": _w((lambda *s: torch.randn(*s, dtype=torch.bfloat16) * 3.2)(Dm, Df) * (Dm ** -0.5)),
            "w_down": _w((lambda *s: torch.randn(*s, dtype=torch.bfloat16) * 3.2)(Df, Dm) * (Df ** -0.5)),
        }
    _B_in = _B_setup()

    return {
        "A_x": _A_in["x"],
        "A_Lambda_re": _A_in["Lambda_re"],
        "A_Lambda_im": _A_in["Lambda_im"],
        "A_B_re": _A_in["B_re"],
        "A_B_im": _A_in["B_im"],
        "A_C_re": _A_in["C_re"],
        "A_C_im": _A_in["C_im"],
        "A_log_dt": _A_in["log_dt"],
        "A_Dskip": _A_in["Dskip"],
        "B_x": _B_in["x"],
        "B_w_gate": _B_in["w_gate"],
        "B_w_up": _B_in["w_up"],
        "B_w_down": _B_in["w_down"],
        "gate_w": _w((lambda *s: torch.randn(*s, dtype=torch.bfloat16) * 0.05)(1024) * 16.0),
    }

def reference(A_x, A_Lambda_re, A_Lambda_im, A_B_re, A_B_im, A_C_re, A_C_im, A_log_dt, A_Dskip, B_x, B_w_gate, B_w_up, B_w_down, gate_w):
    def _A_ref(x, Lambda_re, Lambda_im, B_re, B_im, C_re, C_im, log_dt, Dskip):
        Bsz, L, H = x.shape
        Lam = Lambda_re + 1j * Lambda_im
        Bmat = B_re + 1j * B_im
        Cmat = C_re + 1j * C_im
        dt = torch.exp(log_dt)
        Lam_bar = torch.exp(dt * Lam)
        B_bar = ((Lam_bar - 1.0) / Lam)[:, None] * Bmat
        Bu = torch.einsum("bld,pd->blp", x + 0j, B_bar)
        h = torch.zeros_like(Bu[:, 0, :])
        hs = []
        for t in range(L):
            h = Lam_bar[None, :] * h + Bu[:, t, :]
            hs.append(h)
        hseq = torch.stack(hs, 1)
        y = 2.0 * torch.einsum("blp,dp->bld", hseq, Cmat).real + x * Dskip[None, None, :]
        return y

    def _B_ref(x, w_gate, w_up, w_down):
        g = torch.einsum("bsd,df->bsf", x, w_gate)
        u = torch.einsum("bsd,df->bsf", x, w_up)
        h = _gelu(g) * u
        return torch.einsum("bsf,fd->bsd", h, w_down)

    x = A_x
    g = _sigmoid((x * gate_w).sum(-1, keepdims=True))
    a = _A_ref(x, A_Lambda_re, A_Lambda_im, A_B_re, A_B_im, A_C_re, A_C_im, A_log_dt, A_Dskip)
    b = _B_ref(x, B_w_gate, B_w_up, B_w_down)
    return g * a + (1 - g) * b
```

```asm
; @launch grid=(256,1,1) block=(256,1,1) lds=163840
.amdgcn_target "amdgcn-amd-amdhsa--gfx950"
.text
.globl gated_mix__ssm_conv_s5__glu_gated_geglu__prompt_kernel
.p2align 8
.type gated_mix__ssm_conv_s5__glu_gated_geglu__prompt_kernel,@function
gated_mix__ssm_conv_s5__glu_gated_geglu__prompt_kernel:
s_load_dwordx16 s[16:31], s[0:1], 0
s_load_dwordx16 s[32:47], s[0:1], 64
s_load_dwordx2 s[48:49], s[0:1], 128
    s_getpc_b64 s[92:93]
    s_cmp_ge_u32 s2, 256
    s_cbranch_scc1 L_done
    s_bfe_u32 s11, s2, 0x30003
    v_and_b32 v63, 7, v0
    v_lshlrev_b32 v64, 7, v0
    v_cmp_eq_u32 vcc, s11, v63
    s_and_b32 s15, s2, 1
    v_cndmask_b32 v43, 0, v64, vcc
global_load_dword v22, v43, s[92:93]
    v_lshrrev_b32 v63, 6, v0
    v_and_b32 v64, 63, v0
    v_readfirstlane_b32 s3, v63
    v_lshlrev_b32 v1, 4, v64
    s_bfe_u32 s4, s2, 0x30003
    s_and_b32 s6, s2, 7
    s_lshr_b32 s5, s2, 6
    s_lshl_b32 s9, s6, 2
    s_add_u32 s9, s9, s5
    s_lshr_b32 s7, s3, 1
    s_and_b32 s8, s3, 1
s_mov_b32 s68, 3072
s_mov_b32 s76, 3072
s_mov_b32 s69, 67584
s_mov_b32 s77, 30720
s_mov_b32 s70, 9216
s_mov_b32 s78, 115712
s_mov_b32 s71, 73728
s_mov_b32 s79, 143360
s_mov_b32 s72, 19456
s_mov_b32 s80, 232448
s_mov_b32 s73, 83968
s_mov_b32 s81, 260096
s_mov_b32 s74, 25600
s_mov_b32 s82, 345088
s_mov_b32 s75, 90112
s_mov_b32 s83, 372736
s_mov_b32 s84, 3072
s_mov_b32 s85, 34816
s_mov_b32 s86, 66560
s_mov_b32 s87, 98304
s_mov_b32 s88, 134144
s_mov_b32 s55, 0x20000
s_mov_b32 s59, 0x20000
s_mov_b32 s63, 0x20000
s_mov_b32 s67, 0x20000
s_mov_b32 s54, 134144
s_mov_b32 s58, 461824
s_mov_b32 s62, 166912
    v_lshrrev_b32 v65, 3, v64
    v_and_b32 v66, 7, v64
    v_lshrrev_b32 v67, 4, v64
    v_xor_b32 v68, v66, v67
    v_lshlrev_b32 v68, 4, v68
    v_lshrrev_b32 v69, 5, v64
    v_lshlrev_b32 v69, 4, v69
    v_and_b32 v70, 3, v65
    v_add_u32 v69, v69, v70
    v_lshl_add_u32 v2, v69, 11, v68
    v_xor_b32 v3, 64, v2
    v_and_b32 v70, 1, v65
    v_lshl_add_u32 v70, v70, 3, v67
    v_mul_u32_u24 v70, 7168, v70
    v_lshrrev_b32 v71, 1, v66
    v_xor_b32 v71, v71, v67
    v_lshlrev_b32 v71, 5, v71
    v_and_b32 v72, 1, v64
    v_lshl_add_u32 v71, v72, 4, v71
    v_add_u32 v4, v70, v71
    s_lshl_b32 s11, s8, 14
    s_lshl_b32 s12, s8, 6
    v_lshl_add_u32 v70, v65, 11, v68
    v_xor_b32 v70, s12, v70
    v_add_u32 v5, s11, v70
    s_lshl_b32 s89, s3, 13
    s_lshl_b32 s11, s6, 7
    s_lshl_b32 s12, s5, 4
    s_add_u32 s96, s11, s12
    s_mul_i32 s12, s6, 896
    s_lshl_b32 s13, s5, 8
    s_add_u32 s97, s12, s13
    v_add_u32 v76, s96, v0
    v_min_u32 v76, 1023, v76
    v_lshlrev_b32 v76, 1, v76
    v_mov_b32 v23, 0
    s_cmp_eq_u32 s5, 3
    s_cbranch_scc1 L1_B
    v_lshlrev_b32 v73, 11, v64
    s_lshl_b32 s11, s4, 2
    s_add_u32 s11, s11, s5
    s_lshl_b32 s11, s11, 17
    s_lshr_b32 s13, s4, 1
    s_mul_i32 s13, s13, 4
    s_add_u32 s13, s13, s96
    s_lshl_b32 s13, s13, 11
    s_mul_i32 s12, s4, 57344
    s_add_u32 s12, s12, s97
v_lshrrev_b32 v74, 1, v64
v_mul_u32_u24 v74, 7168, v74
v_and_b32 v75, 1, v64
v_lshl_add_u32 v74, v75, 7, v74
    s_cmp_eq_u32 s3, 0
    s_cselect_b32 s13, s11, s13
    s_cselect_b32 s11, 64, 4
    s_cselect_b32 s100, 2, 1
    s_lshl_b32 s100, s100, 21
    v_add_u32 v73, s13, v73
    v_add_u32 v74, s12, v74
    s_sub_u32 s14, s3, 1
s_cmp_lt_u32 s14, 2
    s_cselect_b32 s100, 7340032, s100
    s_cselect_b32 s11, 16, s11
    s_cselect_b32 s101, 3584, 1
    s_cselect_b64 vcc, -1, 0
    s_lshl_b32 s101, s101, 7
    v_cndmask_b32 v73, v73, v74, vcc
    v_cmp_gt_u32 vcc, s11, v64
    v_mov_b32 v75, 0x80000000
    s_lshl_b32 s11, s2, 1
    v_cndmask_b32 v20, v75, v73, vcc
    s_add_u32 s11, s11, s3
    s_cmp_lt_u32 s3, 2
    s_cselect_b32 s11, s11, s2
    s_lshl_b32 s11, s11, 11
    v_lshlrev_b32 v73, 7, v64
    v_add_u32 v73, s11, v73
    v_cmp_gt_u32 vcc, 16, v64
    s_nop 1
    v_cndmask_b32 v21, v75, v73, vcc
    s_lshl_b32 s11, s4, 2
    s_add_u32 s11, s11, s3
    s_lshl_b32 s11, s11, 17
    s_lshl_b32 s12, s96, 11
    s_lshl_b32 s13, s8, 7
    s_lshl_b32 s90, s3, 13
    s_lshl_b32 s91, s3, 10
    s_add_u32 s91, s91, 131072
    s_add_u32 s90, s90, 65536
    s_add_u32 s13, s13, s97
    s_lshl_b32 s10, s4, 5
    s_add_u32 s10, s10, s9
    s_lshl_b32 s10, s10, 2
    s_add_u32 s10, s10, s3
    s_lshl_b32 s10, s10, 1
    s_lshl_b32 s14, s10, 11
    s_mov_b32 s66, 2048
    s_waitcnt lgkmcnt(0)
    s_mov_b32 s64, s18
    s_mov_b32 s65, s19
    buffer_load_ushort v100, v76, s[64:67], 0 offen
    s_mov_b32 s64, s20
    s_mov_b32 s65, s21
    buffer_load_ushort v101, v76, s[64:67], 0 offen
    s_mov_b32 s64, s30
    s_mov_b32 s65, s31
    buffer_load_ushort v102, v76, s[64:67], 0 offen
    s_cmp_eq_u32 s7, 0
    s_cselect_b32 s56, s36, s38
    s_cselect_b32 s57, s37, s39
    s_cselect_b32 s60, s22, s24
    s_cselect_b32 s61, s23, s25
    s_cmp_eq_u32 s3, 1
    s_cselect_b32 s92, s36, s38
    s_cselect_b32 s93, s37, s39
    s_bitcmp1_b32 s4, 0
    s_cselect_b32 s94, s24, s22
    s_cselect_b32 s95, s25, s23
    s_cmp_eq_u32 s3, 0
    s_cselect_b32 s94, s16, s94
    s_cselect_b32 s95, s17, s95
    s_sub_u32 s98, s3, 1
s_cmp_lt_u32 s98, 2
    s_cselect_b32 s20, s92, s94
    s_cselect_b32 s21, s93, s95
    s_mov_b32 s22, s100
    s_mov_b32 s23, 0x20000
buffer_load_dword v22, v20, s[20:23], 0 offen
v_add_u32 v20, s101, v20
s_add_u32 s56, s56, s13
s_addc_u32 s57, s57, 0
s_sub_u32 s56, s56, 3072
s_subb_u32 s57, s57, 0
s_add_u32 m0, s90, 0
s_nop 0
buffer_load_dwordx4 v4, s[56:59], s76 offen offset:0 lds
buffer_load_dwordx4 v4, s[56:59], s77 offen offset:1024 lds
buffer_load_dwordx4 v4, s[56:59], s78 offen offset:2048 lds
buffer_load_dwordx4 v4, s[56:59], s79 offen offset:3072 lds
s_add_u32 m0, s90, 4096
s_nop 0
buffer_load_dwordx4 v4, s[56:59], s80 offen offset:0 lds
buffer_load_dwordx4 v4, s[56:59], s81 offen offset:1024 lds
buffer_load_dwordx4 v4, s[56:59], s82 offen offset:2048 lds
buffer_load_dwordx4 v4, s[56:59], s83 offen offset:3072 lds
s_add_u32 s60, s60, s12
s_addc_u32 s61, s61, 0
s_sub_u32 s60, s60, 3072
s_subb_u32 s61, s61, 0
s_add_u32 m0, s91, 0
s_nop 0
buffer_load_dwordx4 v5, s[60:63], s84 offen offset:0 lds
s_add_u32 s52, s16, s11
s_addc_u32 s53, s17, 0
s_sub_u32 s52, s52, 3072
s_subb_u32 s53, s53, 0
s_add_u32 m0, s89, 0
s_nop 0
buffer_load_dwordx4 v2, s[52:55], s68 offen offset:0 lds
buffer_load_dwordx4 v3, s[52:55], s69 offen offset:1024 lds
buffer_load_dwordx4 v2, s[52:55], s70 offen offset:2048 lds
buffer_load_dwordx4 v3, s[52:55], s71 offen offset:3072 lds
s_add_u32 m0, s89, 4096
s_nop 0
buffer_load_dwordx4 v2, s[52:55], s72 offen offset:0 lds
buffer_load_dwordx4 v3, s[52:55], s73 offen offset:1024 lds
buffer_load_dwordx4 v2, s[52:55], s74 offen offset:2048 lds
buffer_load_dwordx4 v3, s[52:55], s75 offen offset:3072 lds
buffer_load_dword v22, v20, s[20:23], 0 offen
v_add_u32 v20, s101, v20
    s_add_u32 s64, s48, 23330816
    s_addc_u32 s65, s49, 0
    buffer_load_dword v18, v23, s[64:67], 0 offen sc1
    s_mov_b32 s64, s42
    s_mov_b32 s65, s43
    buffer_load_dwordx4 v[44:47], v1, s[64:67], 0 offen
    buffer_load_dwordx4 v[48:51], v1, s[64:67], 0 offen offset:1024
    s_add_u32 s64, s16, s14
    s_addc_u32 s65, s17, 0
    s_mov_b32 s66, 4096
    buffer_load_dwordx4 v[24:27], v1, s[64:67], 0 offen
    buffer_load_dwordx4 v[28:31], v1, s[64:67], 0 offen offset:1024
    buffer_load_dwordx4 v[32:35], v1, s[64:67], 0 offen offset:2048
    buffer_load_dwordx4 v[36:39], v1, s[64:67], 0 offen offset:3072
buffer_load_dword v22, v20, s[20:23], 0 offen
v_add_u32 v20, s101, v20
    s_cmp_eq_u32 s3, 2
    s_cselect_b32 s92, s26, s28
    s_cselect_b32 s93, s27, s29
    s_cmp_lt_u32 s3, 2
    s_cselect_b32 s24, s40, s92
    s_cselect_b32 s25, s41, s93
    s_cselect_b32 s26, 7, 2
    s_cselect_b32 s29, 2, 1
    s_lshl_b32 s26, s26, 20
    s_lshl_b32 s29, s29, 19
    s_mov_b32 s27, 0x20000
    s_mov_b32 s28, s101
    v_and_b32 v70, 15, v64
    v_lshrrev_b32 v71, 1, v70
    v_xor_b32 v71, v71, v67
    v_lshlrev_b32 v71, 4, v71
    v_lshl_add_u32 v72, v70, 7, v71
    s_lshl_b32 s11, s7, 14
    s_lshl_b32 s12, s8, 13
    s_add_u32 s13, s11, s12
    s_xor_b32 s14, s13, 8192
    v_add_u32 v6, s13, v72
    v_add_u32 v7, s14, v72
    v_xor_b32 v8, 64, v6
    v_xor_b32 v9, 64, v7
    v_bfe_u32 v73, v64, 2, 2
    v_lshrrev_b32 v74, 5, v64
    v_lshlrev_b32 v74, 4, v74
    v_lshl_add_u32 v74, v73, 1, v74
    v_and_b32 v75, 1, v67
    v_add_u32 v74, v74, v75
    v_lshlrev_b32 v74, 7, v74
    v_and_b32 v75, 3, v64
    v_lshl_add_u32 v74, v75, 3, v74
s_lshl_b32 s11, s8, 13
s_add_u32 s11, s11, 65536
v_xor_b32 v75, 0, v73
v_lshl_add_u32 v75, v75, 5, v74
v_add_u32 v10, s11, v75
v_xor_b32 v75, 1, v73
v_lshl_add_u32 v75, v75, 5, v74
v_add_u32 v11, s11, v75
v_xor_b32 v75, 2, v73
v_lshl_add_u32 v75, v75, 5, v74
v_add_u32 v12, s11, v75
v_xor_b32 v75, 3, v73
v_lshl_add_u32 v75, v75, 5, v74
v_add_u32 v13, s11, v75
v_add_u32 v14, 131072, v72
v_xor_b32 v15, 64, v14
    s_lshl_b32 s92, s10, 3
    s_add_u32 s64, s48, 23068672
    s_addc_u32 s65, s49, 0
    s_mov_b32 s66, 327680
s_cmp_lt_u32 s3, 1
s_cbranch_scc0 L1A_nopar
s_waitcnt vmcnt(26)
v_lshlrev_b32 v100, 16, v100
v_lshlrev_b32 v101, 16, v101
v_lshlrev_b32 v102, 16, v102
s_mov_b32 s94, 0x3fb8aa3b
s_mov_b32 s95, 0x32a57060
v_mul_f32 v104, s94, v102
v_fma_f32 v105, v102, s94, -v104
v_fma_f32 v105, v102, s95, v105
v_exp_f32 v104, v104
v_mul_f32 v105, 0x3f317218, v105
v_fma_f32 v96, v104, v105, v104
v_cvt_pk_bf16_f32 v96, v96, v96
v_and_b32 v96, 0xffff0000, v96
v_mul_f32 v106, v96, v100
v_mul_f32 v107, v96, v101
v_mul_f32 v104, s94, v106
v_fma_f32 v105, v106, s94, -v104
v_fma_f32 v105, v106, s95, v105
v_exp_f32 v104, v104
v_mul_f32 v105, 0x3f317218, v105
v_fma_f32 v106, v104, v105, v104
s_mov_b32 s94, 0x3e22f983
s_mov_b32 s95, 0x31dc9c88
v_mul_f32 v104, s94, v107
v_fma_f32 v105, v107, s94, -v104
v_fma_f32 v105, v107, s95, v105
v_rndne_f32 v108, v104
v_sub_f32 v104, v104, v108
v_add_f32 v104, v104, v105
v_cos_f32 v108, v104
v_sin_f32 v109, v104
v_mul_f32 v105, v100, v100
v_mul_f32 v88, v106, v108
v_mul_f32 v89, v106, v109
v_fma_f32 v105, v101, v101, v105
v_add_f32 v104, -1.0, v88
v_rcp_f32 v108, v105
v_mul_f32 v90, v104, v100
v_fma_f32 v109, -v105, v108, 1.0
v_fma_f32 v108, v108, v109, v108
v_fma_f32 v90, v89, v101, v90
v_mul_f32 v91, v89, v100
v_fma_f32 v91, -v104, v101, v91
v_mul_f32 v90, v90, v108
v_mul_f32 v91, v91, v108
v_mul_f32 v104, v89, v89
v_mul_f32 v93, v88, v89
v_fma_f32 v92, v88, v88, -v104
v_add_f32 v93, v93, v93
v_mul_f32 v104, v93, v93
v_mul_f32 v93, v92, v93
v_fma_f32 v92, v92, v92, -v104
v_add_f32 v93, v93, v93
v_mul_f32 v104, v93, v93
v_mul_f32 v93, v92, v93
v_fma_f32 v92, v92, v92, -v104
v_add_f32 v93, v93, v93
v_mul_f32 v104, v93, v93
v_mul_f32 v93, v92, v93
v_fma_f32 v92, v92, v92, -v104
v_add_f32 v93, v93, v93
v_mul_f32 v104, v93, v93
v_mul_f32 v95, v92, v93
v_fma_f32 v94, v92, v92, -v104
v_add_f32 v95, v95, v95
v_mul_f32 v104, v95, v95
v_mul_f32 v95, v94, v95
v_fma_f32 v94, v94, v94, -v104
v_add_f32 v95, v95, v95
v_mul_f32 v104, v95, v95
v_mul_f32 v95, v94, v95
v_fma_f32 v94, v94, v94, -v104
v_add_f32 v95, v95, v95
v_mul_f32 v104, v95, v95
v_mul_f32 v95, v94, v95
v_fma_f32 v94, v94, v94, -v104
v_add_f32 v95, v95, v95
v_cmp_gt_u32 vcc, 16, v0
v_mov_b32 v96, 0x8000
s_nop 0
v_cndmask_b32 v96, v96, v0, vcc
v_lshlrev_b32 v104, 5, v96
v_add_u32 v104, 139264, v104
ds_write_b128 v104, v[88:91]
ds_write_b128 v104, v[92:95] offset:16
L1A_nopar:
s_waitcnt vmcnt(9) lgkmcnt(0)
s_barrier
ds_read_b128 a[152:155], v14 offset:0
ds_read_b128 a[156:159], v14 offset:2048
ds_read_b128 a[88:91], v6 offset:0
ds_read_b128 a[92:95], v6 offset:2048
ds_read_b128 a[96:99], v6 offset:4096
ds_read_b128 a[100:103], v6 offset:6144
s_waitcnt lgkmcnt(3)
v_mfma_f32_16x16x32_bf16 v[56:59], a[88:91], a[152:155], 0
ds_read_b64_tr_b16 a[160:161], v10 offset:0
ds_read_b64_tr_b16 a[162:163], v10 offset:1024
s_waitcnt lgkmcnt(4)
v_mfma_f32_16x16x32_bf16 v[64:67], a[92:95], a[152:155], 0
ds_read_b128 a[104:107], v7 offset:0
ds_read_b128 a[108:111], v7 offset:2048
s_waitcnt lgkmcnt(5)
v_mfma_f32_16x16x32_bf16 v[72:75], a[96:99], a[152:155], 0
ds_read_b128 a[112:115], v7 offset:4096
ds_read_b128 a[116:119], v7 offset:6144
s_waitcnt lgkmcnt(6)
v_mfma_f32_16x16x32_bf16 v[80:83], a[100:103], a[152:155], 0
ds_read_b64_tr_b16 a[164:165], v10 offset:16384
v_mfma_f32_16x16x32_bf16 v[84:87], a[100:103], a[156:159], 0
ds_read_b64_tr_b16 a[166:167], v10 offset:17408
s_add_u32 m0, s89, 32768
v_mfma_f32_16x16x32_bf16 v[76:79], a[96:99], a[156:159], 0
s_add_u32 s52, s52, 128
s_addc_u32 s53, s53, 0
v_mfma_f32_16x16x32_bf16 v[68:71], a[92:95], a[156:159], 0
s_add_u32 s56, s56, 458752
s_addc_u32 s57, s57, 0
v_mfma_f32_16x16x32_bf16 v[60:63], a[88:91], a[156:159], 0
ds_read_b64_tr_b16 a[168:169], v11 offset:0
s_waitcnt lgkmcnt(7)
v_mfma_f32_16x16x32_bf16 v[88:91], a[160:163], a[88:91], 0
s_add_u32 s60, s60, 128
s_addc_u32 s61, s61, 0
v_mfma_f32_16x16x32_bf16 v[120:123], a[160:163], a[92:95], 0
ds_read_b64_tr_b16 a[170:171], v11 offset:1024
ds_read_b64_tr_b16 a[152:153], v11 offset:16384
v_mfma_f32_16x16x32_bf16 v[152:155], a[160:163], a[96:99], 0
ds_read_b64_tr_b16 a[154:155], v11 offset:17408
ds_read_b64_tr_b16 a[156:157], v12 offset:0
v_mfma_f32_16x16x32_bf16 v[176:179], a[160:163], a[100:103], 0
ds_read_b64_tr_b16 a[158:159], v12 offset:1024
s_waitcnt lgkmcnt(7)
v_mfma_f32_16x16x32_bf16 v[192:195], a[160:163], a[104:107], 0
buffer_load_dwordx4 v2, s[52:55], s68 offen offset:0 lds
v_mfma_f32_16x16x32_bf16 v[208:211], a[160:163], a[108:111], 0
v_mfma_f32_16x16x32_bf16 v[224:227], a[160:163], a[112:115], 0
v_mfma_f32_16x16x32_bf16 v[240:243], a[160:163], a[116:119], 0
ds_read_b64_tr_b16 a[160:161], v12 offset:16384
s_waitcnt lgkmcnt(6)
v_mfma_f32_16x16x32_bf16 a[0:3], a[164:167], a[116:119], 0
buffer_load_dwordx4 v3, s[52:55], s69 offen offset:1024 lds
v_mfma_f32_16x16x32_bf16 a[16:19], a[164:167], a[112:115], 0
ds_read_b64_tr_b16 a[162:163], v12 offset:17408
v_mfma_f32_16x16x32_bf16 a[32:35], a[164:167], a[108:111], 0
v_mfma_f32_16x16x32_bf16 a[48:51], a[164:167], a[104:107], 0
v_mfma_f32_16x16x32_bf16 a[64:67], a[164:167], a[100:103], 0
buffer_load_dwordx4 v2, s[52:55], s70 offen offset:2048 lds
v_mfma_f32_16x16x32_bf16 a[80:83], a[164:167], a[96:99], 0
v_mfma_f32_16x16x32_bf16 v[124:127], a[164:167], a[92:95], 0
v_mfma_f32_16x16x32_bf16 v[92:95], a[164:167], a[88:91], 0
ds_read_b64_tr_b16 a[164:165], v13 offset:0
s_waitcnt lgkmcnt(2)
v_mfma_f32_16x16x32_bf16 v[96:99], a[168:171], a[88:91], 0
buffer_load_dwordx4 v3, s[52:55], s71 offen offset:3072 lds
v_mfma_f32_16x16x32_bf16 v[128:131], a[168:171], a[92:95], 0
s_add_u32 m0, s89, 36864
ds_read_b64_tr_b16 a[166:167], v13 offset:1024
v_mfma_f32_16x16x32_bf16 v[156:159], a[168:171], a[96:99], 0
v_mfma_f32_16x16x32_bf16 v[180:183], a[168:171], a[100:103], 0
v_mfma_f32_16x16x32_bf16 v[196:199], a[168:171], a[104:107], 0
buffer_load_dwordx4 v2, s[52:55], s72 offen offset:0 lds
v_mfma_f32_16x16x32_bf16 v[212:215], a[168:171], a[108:111], 0
v_mfma_f32_16x16x32_bf16 v[228:231], a[168:171], a[112:115], 0
v_mfma_f32_16x16x32_bf16 v[244:247], a[168:171], a[116:119], 0
ds_read_b64_tr_b16 a[168:169], v13 offset:16384
v_mfma_f32_16x16x32_bf16 a[4:7], a[152:155], a[116:119], 0
buffer_load_dwordx4 v3, s[52:55], s73 offen offset:1024 lds
v_mfma_f32_16x16x32_bf16 a[20:23], a[152:155], a[112:115], 0
ds_read_b64_tr_b16 a[170:171], v13 offset:17408
v_mfma_f32_16x16x32_bf16 a[36:39], a[152:155], a[108:111], 0
v_mfma_f32_16x16x32_bf16 a[52:55], a[152:155], a[104:107], 0
v_mfma_f32_16x16x32_bf16 a[68:71], a[152:155], a[100:103], 0
buffer_load_dwordx4 v2, s[52:55], s74 offen offset:2048 lds
v_mfma_f32_16x16x32_bf16 a[84:87], a[152:155], a[96:99], 0
v_mfma_f32_16x16x32_bf16 v[132:135], a[152:155], a[92:95], 0
v_mfma_f32_16x16x32_bf16 v[100:103], a[152:155], a[88:91], 0
ds_read_b128 a[152:155], v15 offset:0
v_mfma_f32_16x16x32_bf16 v[104:107], a[156:159], a[88:91], 0
buffer_load_dwordx4 v3, s[52:55], s75 offen offset:3072 lds
v_mfma_f32_16x16x32_bf16 v[136:139], a[156:159], a[92:95], 0
s_add_u32 m0, s90, 32768
ds_read_b128 a[120:123], v8 offset:0
v_mfma_f32_16x16x32_bf16 v[160:163], a[156:159], a[96:99], 0
ds_read_b128 a[124:127], v8 offset:2048
ds_read_b128 a[128:131], v8 offset:4096
v_mfma_f32_16x16x32_bf16 v[184:187], a[156:159], a[100:103], 0
ds_read_b128 a[132:135], v8 offset:6144
v_mfma_f32_16x16x32_bf16 v[200:203], a[156:159], a[104:107], 0
buffer_load_dwordx4 v4, s[56:59], s76 offen offset:0 lds
v_mfma_f32_16x16x32_bf16 v[216:219], a[156:159], a[108:111], 0
v_mfma_f32_16x16x32_bf16 v[232:235], a[156:159], a[112:115], 0
v_mfma_f32_16x16x32_bf16 v[248:251], a[156:159], a[116:119], 0
ds_read_b128 a[156:159], v15 offset:2048
s_waitcnt lgkmcnt(5)
v_mfma_f32_16x16x32_bf16 a[8:11], a[160:163], a[116:119], 0
buffer_load_dwordx4 v4, s[56:59], s77 offen offset:1024 lds
v_mfma_f32_16x16x32_bf16 a[24:27], a[160:163], a[112:115], 0
v_mfma_f32_16x16x32_bf16 a[40:43], a[160:163], a[108:111], 0
v_mfma_f32_16x16x32_bf16 a[56:59], a[160:163], a[104:107], 0
v_mfma_f32_16x16x32_bf16 a[72:75], a[160:163], a[100:103], 0
buffer_load_dwordx4 v4, s[56:59], s78 offen offset:2048 lds
v_mfma_f32_16x16x32_bf16 v[164:167], a[160:163], a[96:99], 0
v_mfma_f32_16x16x32_bf16 v[140:143], a[160:163], a[92:95], 0
v_mfma_f32_16x16x32_bf16 v[108:111], a[160:163], a[88:91], 0
ds_read_b64_tr_b16 a[160:161], v10 offset:4096
v_mfma_f32_16x16x32_bf16 v[112:115], a[164:167], a[88:91], 0
buffer_load_dwordx4 v4, s[56:59], s79 offen offset:3072 lds
v_mfma_f32_16x16x32_bf16 v[144:147], a[164:167], a[92:95], 0
s_add_u32 m0, s90, 36864
ds_read_b64_tr_b16 a[162:163], v10 offset:5120
v_mfma_f32_16x16x32_bf16 v[168:171], a[164:167], a[96:99], 0
ds_read_b128 a[136:139], v9 offset:0
ds_read_b128 a[140:143], v9 offset:2048
v_mfma_f32_16x16x32_bf16 v[188:191], a[164:167], a[100:103], 0
ds_read_b128 a[144:147], v9 offset:4096
ds_read_b128 a[148:151], v9 offset:6144
v_mfma_f32_16x16x32_bf16 v[204:207], a[164:167], a[104:107], 0
buffer_load_dwordx4 v4, s[56:59], s80 offen offset:0 lds
v_mfma_f32_16x16x32_bf16 v[220:223], a[164:167], a[108:111], 0
v_mfma_f32_16x16x32_bf16 v[236:239], a[164:167], a[112:115], 0
v_mfma_f32_16x16x32_bf16 v[252:255], a[164:167], a[116:119], 0
ds_read_b64_tr_b16 a[164:165], v10 offset:20480
v_mfma_f32_16x16x32_bf16 a[12:15], a[168:171], a[116:119], 0
buffer_load_dwordx4 v4, s[56:59], s81 offen offset:1024 lds
v_mfma_f32_16x16x32_bf16 a[28:31], a[168:171], a[112:115], 0
ds_read_b64_tr_b16 a[166:167], v10 offset:21504
v_mfma_f32_16x16x32_bf16 a[44:47], a[168:171], a[108:111], 0
v_mfma_f32_16x16x32_bf16 a[60:63], a[168:171], a[104:107], 0
v_mfma_f32_16x16x32_bf16 a[76:79], a[168:171], a[100:103], 0
buffer_load_dwordx4 v4, s[56:59], s82 offen offset:2048 lds
v_mfma_f32_16x16x32_bf16 v[172:175], a[168:171], a[96:99], 0
v_mfma_f32_16x16x32_bf16 v[148:151], a[168:171], a[92:95], 0
v_mfma_f32_16x16x32_bf16 v[116:119], a[168:171], a[88:91], 0
ds_read_b64_tr_b16 a[168:169], v11 offset:4096
s_waitcnt lgkmcnt(2)
v_mfma_f32_16x16x32_bf16 v[56:59], a[120:123], a[152:155], v[56:59]
buffer_load_dwordx4 v4, s[56:59], s83 offen offset:3072 lds
v_mfma_f32_16x16x32_bf16 v[64:67], a[124:127], a[152:155], v[64:67]
s_waitcnt vmcnt(17)
s_add_u32 m0, s91, 4096
v_mfma_f32_16x16x32_bf16 v[72:75], a[128:131], a[152:155], v[72:75]
ds_read_b64_tr_b16 a[170:171], v11 offset:5120
v_readfirstlane_b32 s98, v18
v_mfma_f32_16x16x32_bf16 v[80:83], a[132:135], a[152:155], v[80:83]
ds_read_b64_tr_b16 a[152:153], v11 offset:20480
v_mfma_f32_16x16x32_bf16 v[84:87], a[132:135], a[156:159], v[84:87]
buffer_load_dwordx4 v5, s[60:63], s84 offen offset:0 lds
v_mfma_f32_16x16x32_bf16 v[76:79], a[128:131], a[156:159], v[76:79]
ds_read_b64_tr_b16 a[154:155], v11 offset:21504
v_dot2_f32_bf16 v52, v24, v44, 0
v_mfma_f32_16x16x32_bf16 v[68:71], a[124:127], a[156:159], v[68:71]
v_dot2_f32_bf16 v53, v32, v44, 0
v_dot2_f32_bf16 v52, v25, v45, v52
v_mfma_f32_16x16x32_bf16 v[60:63], a[120:123], a[156:159], v[60:63]
buffer_load_dword v22, v20, s[20:23], 0 offen
v_mfma_f32_16x16x32_bf16 v[88:91], a[160:163], a[120:123], v[88:91]
v_add_u32 v20, s28, v20
ds_read_b64_tr_b16 a[156:157], v12 offset:4096
v_mfma_f32_16x16x32_bf16 v[120:123], a[160:163], a[124:127], v[120:123]
ds_read_b64_tr_b16 a[158:159], v12 offset:5120
v_dot2_f32_bf16 v53, v33, v45, v53
v_mfma_f32_16x16x32_bf16 v[152:155], a[160:163], a[128:131], v[152:155]
buffer_load_dword v22, v21, s[24:27], 0 offen
v_mfma_f32_16x16x32_bf16 v[176:179], a[160:163], a[132:135], v[176:179]
v_add_u32 v21, s29, v21
v_dot2_f32_bf16 v52, v26, v46, v52
v_mfma_f32_16x16x32_bf16 v[192:195], a[160:163], a[136:139], v[192:195]
v_dot2_f32_bf16 v53, v34, v46, v53
v_dot2_f32_bf16 v52, v27, v47, v52
v_mfma_f32_16x16x32_bf16 v[208:211], a[160:163], a[140:143], v[208:211]
v_dot2_f32_bf16 v53, v35, v47, v53
v_dot2_f32_bf16 v52, v28, v48, v52
v_mfma_f32_16x16x32_bf16 v[224:227], a[160:163], a[144:147], v[224:227]
v_dot2_f32_bf16 v53, v36, v48, v53
v_dot2_f32_bf16 v52, v29, v49, v52
v_mfma_f32_16x16x32_bf16 v[240:243], a[160:163], a[148:151], v[240:243]
ds_read_b64_tr_b16 a[160:161], v12 offset:20480
s_waitcnt lgkmcnt(3)
v_mfma_f32_16x16x32_bf16 a[0:3], a[164:167], a[148:151], a[0:3]
ds_read_b64_tr_b16 a[162:163], v12 offset:21504
v_dot2_f32_bf16 v53, v37, v49, v53
v_mfma_f32_16x16x32_bf16 a[16:19], a[164:167], a[144:147], a[16:19]
v_dot2_f32_bf16 v52, v30, v50, v52
v_dot2_f32_bf16 v53, v38, v50, v53
v_mfma_f32_16x16x32_bf16 a[32:35], a[164:167], a[140:143], a[32:35]
v_dot2_f32_bf16 v52, v31, v51, v52
v_dot2_f32_bf16 v53, v39, v51, v53
v_mfma_f32_16x16x32_bf16 a[48:51], a[164:167], a[136:139], a[48:51]
s_nop 2
v_add_f32_dpp v52, v52, v52 row_shr:1 row_mask:0xf bank_mask:0xf bound_ctrl:1
v_mfma_f32_16x16x32_bf16 a[64:67], a[164:167], a[132:135], a[64:67]
v_add_f32_dpp v53, v53, v53 row_shr:1 row_mask:0xf bank_mask:0xf bound_ctrl:1
s_nop 0
v_mfma_f32_16x16x32_bf16 a[80:83], a[164:167], a[128:131], a[80:83]
v_add_f32_dpp v52, v52, v52 row_shr:2 row_mask:0xf bank_mask:0xf bound_ctrl:1
v_add_f32_dpp v53, v53, v53 row_shr:2 row_mask:0xf bank_mask:0xf bound_ctrl:1
v_mfma_f32_16x16x32_bf16 v[124:127], a[164:167], a[124:127], v[124:127]
s_nop 0
v_add_f32_dpp v52, v52, v52 row_shr:4 row_mask:0xf bank_mask:0xf bound_ctrl:1
v_mfma_f32_16x16x32_bf16 v[92:95], a[164:167], a[120:123], v[92:95]
ds_read_b64_tr_b16 a[164:165], v13 offset:4096
v_mfma_f32_16x16x32_bf16 v[96:99], a[168:171], a[120:123], v[96:99]
ds_read_b64_tr_b16 a[166:167], v13 offset:5120
v_add_f32_dpp v53, v53, v53 row_shr:4 row_mask:0xf bank_mask:0xf bound_ctrl:1
v_mfma_f32_16x16x32_bf16 v[128:131], a[168:171], a[124:127], v[128:131]
s_nop 0
v_add_f32_dpp v52, v52, v52 row_shr:8 row_mask:0xf bank_mask:0xf bound_ctrl:1
v_mfma_f32_16x16x32_bf16 v[156:159], a[168:171], a[128:131], v[156:159]
v_add_f32_dpp v53, v53, v53 row_shr:8 row_mask:0xf bank_mask:0xf bound_ctrl:1
s_nop 0
v_mfma_f32_16x16x32_bf16 v[180:183], a[168:171], a[132:135], v[180:183]
v_add_f32_dpp v52, v52, v52 row_bcast:15 row_mask:0xa bank_mask:0xf
v_add_f32_dpp v53, v53, v53 row_bcast:15 row_mask:0xa bank_mask:0xf
v_mfma_f32_16x16x32_bf16 v[196:199], a[168:171], a[136:139], v[196:199]
s_nop 0
v_add_f32_dpp v52, v52, v52 row_bcast:31 row_mask:0xc bank_mask:0xf
v_mfma_f32_16x16x32_bf16 v[212:215], a[168:171], a[140:143], v[212:215]
v_add_f32_dpp v53, v53, v53 row_bcast:31 row_mask:0xc bank_mask:0xf
s_nop 0
v_mfma_f32_16x16x32_bf16 v[228:231], a[168:171], a[144:147], v[228:231]
v_readlane_b32 s94, v52, 63
v_readlane_b32 s95, v53, 63
v_mfma_f32_16x16x32_bf16 v[244:247], a[168:171], a[148:151], v[244:247]
ds_read_b64_tr_b16 a[168:169], v13 offset:20480
v_mfma_f32_16x16x32_bf16 a[4:7], a[152:155], a[148:151], a[4:7]
ds_read_b64_tr_b16 a[170:171], v13 offset:21504
s_nop 1
v_mfma_f32_16x16x32_bf16 a[20:23], a[152:155], a[144:147], a[20:23]
v_mov_b32 v52, s94
v_writelane_b32 v52, s95, 1
v_mfma_f32_16x16x32_bf16 a[36:39], a[152:155], a[140:143], a[36:39]
v_cvt_pk_bf16_f32 v52, v52, v52
v_and_b32 v52, 0xffff0000, v52
v_mfma_f32_16x16x32_bf16 a[52:55], a[152:155], a[136:139], a[52:55]
v_sub_f32 v24, 0, v52
v_min_f32 v24, 0x42b00000, v24
v_mfma_f32_16x16x32_bf16 a[68:71], a[152:155], a[132:135], a[68:71]
v_max_f32 v24, 0xc2f00000, v24
s_mov_b32 s94, 0x3fb8aa3b
v_mfma_f32_16x16x32_bf16 a[84:87], a[152:155], a[128:131], a[84:87]
s_mov_b32 s95, 0x32a57060
v_mul_f32 v25, s94, v24
v_mfma_f32_16x16x32_bf16 v[132:135], a[152:155], a[124:127], v[132:135]
v_fma_f32 v26, v24, s94, -v25
v_fma_f32 v26, v24, s95, v26
v_mfma_f32_16x16x32_bf16 v[100:103], a[152:155], a[120:123], v[100:103]
s_waitcnt lgkmcnt(1)
v_mfma_f32_16x16x32_bf16 v[104:107], a[156:159], a[120:123], v[104:107]
v_exp_f32 v25, v25
v_mfma_f32_16x16x32_bf16 v[136:139], a[156:159], a[124:127], v[136:139]
v_mul_f32 v26, 0x3f317218, v26
v_fma_f32 v24, v25, v26, v25
v_mfma_f32_16x16x32_bf16 v[160:163], a[156:159], a[128:131], v[160:163]
v_add_f32 v24, 1.0, v24
v_mfma_f32_16x16x32_bf16 v[184:187], a[156:159], a[132:135], v[184:187]
v_rcp_f32 v25, v24
v_mfma_f32_16x16x32_bf16 v[200:203], a[156:159], a[136:139], v[200:203]
s_nop 0
v_fma_f32 v26, -v24, v25, 1.0
v_fma_f32 v25, v25, v26, v25
v_cvt_pk_bf16_f32 v52, v25, v25
v_and_b32 v52, 0xffff0000, v52
s_add_u32 s98, s98, 1
v_mov_b32 v53, s98
v_lshrrev_b32 v39, 1, v1
v_mfma_f32_16x16x32_bf16 v[216:219], a[156:159], a[140:143], v[216:219]
s_mov_b64 exec, 3
buffer_store_dwordx2 v[52:53], v39, s[64:67], s92 offen sc0 sc1
s_mov_b64 exec, -1
s_nop 1
v_mfma_f32_16x16x32_bf16 v[232:235], a[156:159], a[144:147], v[232:235]
v_mfma_f32_16x16x32_bf16 v[248:251], a[156:159], a[148:151], v[248:251]
s_waitcnt vmcnt(3) lgkmcnt(0)
s_barrier
s_mov_b32 s10, 7
.p2align 3
L1A_loop:
s_add_u32 s52, s52, 128
s_addc_u32 s53, s53, 0
v_mfma_f32_16x16x32_bf16 a[8:11], a[160:163], a[148:151], a[8:11]
s_add_u32 s56, s56, 458752
s_addc_u32 s57, s57, 0
v_mfma_f32_16x16x32_bf16 a[24:27], a[160:163], a[144:147], a[24:27]
s_add_u32 s60, s60, 128
s_addc_u32 s61, s61, 0
v_mfma_f32_16x16x32_bf16 a[40:43], a[160:163], a[140:143], a[40:43]
s_add_u32 m0, s89, 0
ds_read_b128 a[152:155], v14 offset:4096
v_mfma_f32_16x16x32_bf16 a[56:59], a[160:163], a[136:139], a[56:59]
ds_read_b128 a[88:91], v6 offset:32768
ds_read_b128 a[92:95], v6 offset:34816
v_mfma_f32_16x16x32_bf16 a[72:75], a[160:163], a[132:135], a[72:75]
ds_read_b128 a[96:99], v6 offset:36864
ds_read_b128 a[100:103], v6 offset:38912
v_mfma_f32_16x16x32_bf16 v[164:167], a[160:163], a[128:131], v[164:167]
ds_read_b128 a[156:159], v14 offset:6144
v_mfma_f32_16x16x32_bf16 v[140:143], a[160:163], a[124:127], v[140:143]
v_mfma_f32_16x16x32_bf16 v[108:111], a[160:163], a[120:123], v[108:111]
ds_read_b64_tr_b16 a[160:161], v10 offset:32768
ds_read_b64_tr_b16 a[162:163], v10 offset:33792
v_mfma_f32_16x16x32_bf16 v[112:115], a[164:167], a[120:123], v[112:115]
ds_read_b128 a[104:107], v7 offset:32768
ds_read_b128 a[108:111], v7 offset:34816
v_mfma_f32_16x16x32_bf16 v[144:147], a[164:167], a[124:127], v[144:147]
ds_read_b128 a[112:115], v7 offset:36864
ds_read_b128 a[116:119], v7 offset:38912
v_mfma_f32_16x16x32_bf16 v[168:171], a[164:167], a[128:131], v[168:171]
v_mfma_f32_16x16x32_bf16 v[188:191], a[164:167], a[132:135], v[188:191]
v_mfma_f32_16x16x32_bf16 v[204:207], a[164:167], a[136:139], v[204:207]
buffer_load_dwordx4 v2, s[52:55], s68 offen offset:0 lds
v_mfma_f32_16x16x32_bf16 v[220:223], a[164:167], a[140:143], v[220:223]
v_mfma_f32_16x16x32_bf16 v[236:239], a[164:167], a[144:147], v[236:239]
v_mfma_f32_16x16x32_bf16 v[252:255], a[164:167], a[148:151], v[252:255]
ds_read_b64_tr_b16 a[164:165], v10 offset:49152
ds_read_b64_tr_b16 a[166:167], v10 offset:50176
v_mfma_f32_16x16x32_bf16 a[12:15], a[168:171], a[148:151], a[12:15]
buffer_load_dwordx4 v3, s[52:55], s69 offen offset:1024 lds
v_mfma_f32_16x16x32_bf16 a[28:31], a[168:171], a[144:147], a[28:31]
v_mfma_f32_16x16x32_bf16 a[44:47], a[168:171], a[140:143], a[44:47]
v_mfma_f32_16x16x32_bf16 a[60:63], a[168:171], a[136:139], a[60:63]
v_mfma_f32_16x16x32_bf16 a[76:79], a[168:171], a[132:135], a[76:79]
buffer_load_dwordx4 v2, s[52:55], s70 offen offset:2048 lds
v_mfma_f32_16x16x32_bf16 v[172:175], a[168:171], a[128:131], v[172:175]
v_mfma_f32_16x16x32_bf16 v[148:151], a[168:171], a[124:127], v[148:151]
v_mfma_f32_16x16x32_bf16 v[116:119], a[168:171], a[120:123], v[116:119]
ds_read_b64_tr_b16 a[168:169], v11 offset:32768
s_waitcnt lgkmcnt(1)
v_mfma_f32_16x16x32_bf16 v[56:59], a[88:91], a[152:155], v[56:59]
buffer_load_dwordx4 v3, s[52:55], s71 offen offset:3072 lds
v_mfma_f32_16x16x32_bf16 v[64:67], a[92:95], a[152:155], v[64:67]
s_add_u32 m0, s89, 4096
ds_read_b64_tr_b16 a[170:171], v11 offset:33792
v_mfma_f32_16x16x32_bf16 v[72:75], a[96:99], a[152:155], v[72:75]
v_mfma_f32_16x16x32_bf16 v[80:83], a[100:103], a[152:155], v[80:83]
ds_read_b64_tr_b16 a[152:153], v11 offset:49152
v_mfma_f32_16x16x32_bf16 v[84:87], a[100:103], a[156:159], v[84:87]
buffer_load_dwordx4 v2, s[52:55], s72 offen offset:0 lds
v_mfma_f32_16x16x32_bf16 v[76:79], a[96:99], a[156:159], v[76:79]
ds_read_b64_tr_b16 a[154:155], v11 offset:50176
v_mfma_f32_16x16x32_bf16 v[68:71], a[92:95], a[156:159], v[68:71]
v_mfma_f32_16x16x32_bf16 v[60:63], a[88:91], a[156:159], v[60:63]
ds_read_b64_tr_b16 a[156:157], v12 offset:32768
v_mfma_f32_16x16x32_bf16 v[88:91], a[160:163], a[88:91], v[88:91]
buffer_load_dwordx4 v3, s[52:55], s73 offen offset:1024 lds
v_mfma_f32_16x16x32_bf16 v[120:123], a[160:163], a[92:95], v[120:123]
ds_read_b64_tr_b16 a[158:159], v12 offset:33792
v_mfma_f32_16x16x32_bf16 v[152:155], a[160:163], a[96:99], v[152:155]
v_mfma_f32_16x16x32_bf16 v[176:179], a[160:163], a[100:103], v[176:179]
v_mfma_f32_16x16x32_bf16 v[192:195], a[160:163], a[104:107], v[192:195]
buffer_load_dwordx4 v2, s[52:55], s74 offen offset:2048 lds
v_mfma_f32_16x16x32_bf16 v[208:211], a[160:163], a[108:111], v[208:211]
v_mfma_f32_16x16x32_bf16 v[224:227], a[160:163], a[112:115], v[224:227]
v_mfma_f32_16x16x32_bf16 v[240:243], a[160:163], a[116:119], v[240:243]
ds_read_b64_tr_b16 a[160:161], v12 offset:49152
v_mfma_f32_16x16x32_bf16 a[0:3], a[164:167], a[116:119], a[0:3]
buffer_load_dwordx4 v3, s[52:55], s75 offen offset:3072 lds
v_mfma_f32_16x16x32_bf16 a[16:19], a[164:167], a[112:115], a[16:19]
s_add_u32 m0, s90, 0
ds_read_b64_tr_b16 a[162:163], v12 offset:50176
v_mfma_f32_16x16x32_bf16 a[32:35], a[164:167], a[108:111], a[32:35]
v_mfma_f32_16x16x32_bf16 a[48:51], a[164:167], a[104:107], a[48:51]
v_mfma_f32_16x16x32_bf16 a[64:67], a[164:167], a[100:103], a[64:67]
buffer_load_dwordx4 v4, s[56:59], s76 offen offset:0 lds
v_mfma_f32_16x16x32_bf16 a[80:83], a[164:167], a[96:99], a[80:83]
v_mfma_f32_16x16x32_bf16 v[124:127], a[164:167], a[92:95], v[124:127]
v_mfma_f32_16x16x32_bf16 v[92:95], a[164:167], a[88:91], v[92:95]
ds_read_b64_tr_b16 a[164:165], v13 offset:32768
s_waitcnt lgkmcnt(2)
v_mfma_f32_16x16x32_bf16 v[96:99], a[168:171], a[88:91], v[96:99]
buffer_load_dwordx4 v4, s[56:59], s77 offen offset:1024 lds
v_mfma_f32_16x16x32_bf16 v[128:131], a[168:171], a[92:95], v[128:131]
ds_read_b64_tr_b16 a[166:167], v13 offset:33792
v_mfma_f32_16x16x32_bf16 v[156:159], a[168:171], a[96:99], v[156:159]
v_mfma_f32_16x16x32_bf16 v[180:183], a[168:171], a[100:103], v[180:183]
v_mfma_f32_16x16x32_bf16 v[196:199], a[168:171], a[104:107], v[196:199]
buffer_load_dwordx4 v4, s[56:59], s78 offen offset:2048 lds
v_mfma_f32_16x16x32_bf16 v[212:215], a[168:171], a[108:111], v[212:215]
v_mfma_f32_16x16x32_bf16 v[228:231], a[168:171], a[112:115], v[228:231]
v_mfma_f32_16x16x32_bf16 v[244:247], a[168:171], a[116:119], v[244:247]
ds_read_b64_tr_b16 a[168:169], v13 offset:49152
v_mfma_f32_16x16x32_bf16 a[4:7], a[152:155], a[116:119], a[4:7]
buffer_load_dwordx4 v4, s[56:59], s79 offen offset:3072 lds
v_mfma_f32_16x16x32_bf16 a[20:23], a[152:155], a[112:115], a[20:23]
s_add_u32 m0, s90, 4096
ds_read_b64_tr_b16 a[170:171], v13 offset:50176
v_mfma_f32_16x16x32_bf16 a[36:39], a[152:155], a[108:111], a[36:39]
v_mfma_f32_16x16x32_bf16 a[52:55], a[152:155], a[104:107], a[52:55]
v_mfma_f32_16x16x32_bf16 a[68:71], a[152:155], a[100:103], a[68:71]
buffer_load_dwordx4 v4, s[56:59], s80 offen offset:0 lds
v_mfma_f32_16x16x32_bf16 a[84:87], a[152:155], a[96:99], a[84:87]
v_mfma_f32_16x16x32_bf16 v[132:135], a[152:155], a[92:95], v[132:135]
v_mfma_f32_16x16x32_bf16 v[100:103], a[152:155], a[88:91], v[100:103]
ds_read_b128 a[152:155], v15 offset:4096
v_mfma_f32_16x16x32_bf16 v[104:107], a[156:159], a[88:91], v[104:107]
buffer_load_dwordx4 v4, s[56:59], s81 offen offset:1024 lds
v_mfma_f32_16x16x32_bf16 v[136:139], a[156:159], a[92:95], v[136:139]
ds_read_b128 a[120:123], v8 offset:32768
ds_read_b128 a[124:127], v8 offset:34816
v_mfma_f32_16x16x32_bf16 v[160:163], a[156:159], a[96:99], v[160:163]
ds_read_b128 a[128:131], v8 offset:36864
ds_read_b128 a[132:135], v8 offset:38912
v_mfma_f32_16x16x32_bf16 v[184:187], a[156:159], a[100:103], v[184:187]
v_mfma_f32_16x16x32_bf16 v[200:203], a[156:159], a[104:107], v[200:203]
buffer_load_dwordx4 v4, s[56:59], s82 offen offset:2048 lds
v_mfma_f32_16x16x32_bf16 v[216:219], a[156:159], a[108:111], v[216:219]
v_mfma_f32_16x16x32_bf16 v[232:235], a[156:159], a[112:115], v[232:235]
v_mfma_f32_16x16x32_bf16 v[248:251], a[156:159], a[116:119], v[248:251]
ds_read_b128 a[156:159], v15 offset:6144
s_waitcnt lgkmcnt(5)
v_mfma_f32_16x16x32_bf16 a[8:11], a[160:163], a[116:119], a[8:11]
buffer_load_dwordx4 v4, s[56:59], s83 offen offset:3072 lds
v_mfma_f32_16x16x32_bf16 a[24:27], a[160:163], a[112:115], a[24:27]
s_add_u32 m0, s91, 0
v_mfma_f32_16x16x32_bf16 a[40:43], a[160:163], a[108:111], a[40:43]
v_mfma_f32_16x16x32_bf16 a[56:59], a[160:163], a[104:107], a[56:59]
v_mfma_f32_16x16x32_bf16 a[72:75], a[160:163], a[100:103], a[72:75]
buffer_load_dwordx4 v5, s[60:63], s84 offen offset:0 lds
v_mfma_f32_16x16x32_bf16 v[164:167], a[160:163], a[96:99], v[164:167]
v_mfma_f32_16x16x32_bf16 v[140:143], a[160:163], a[92:95], v[140:143]
v_mfma_f32_16x16x32_bf16 v[108:111], a[160:163], a[88:91], v[108:111]
buffer_load_dword v22, v20, s[20:23], 0 offen
v_mfma_f32_16x16x32_bf16 v[112:115], a[164:167], a[88:91], v[112:115]
v_add_u32 v20, s28, v20
ds_read_b64_tr_b16 a[160:161], v10 offset:36864
v_mfma_f32_16x16x32_bf16 v[144:147], a[164:167], a[92:95], v[144:147]
ds_read_b64_tr_b16 a[162:163], v10 offset:37888
ds_read_b128 a[136:139], v9 offset:32768
v_mfma_f32_16x16x32_bf16 v[168:171], a[164:167], a[96:99], v[168:171]
buffer_load_dword v22, v21, s[24:27], 0 offen
v_mfma_f32_16x16x32_bf16 v[188:191], a[164:167], a[100:103], v[188:191]
v_add_u32 v21, s29, v21
ds_read_b128 a[140:143], v9 offset:34816
v_mfma_f32_16x16x32_bf16 v[204:207], a[164:167], a[104:107], v[204:207]
ds_read_b128 a[144:147], v9 offset:36864
ds_read_b128 a[148:151], v9 offset:38912
v_mfma_f32_16x16x32_bf16 v[220:223], a[164:167], a[108:111], v[220:223]
v_mfma_f32_16x16x32_bf16 v[236:239], a[164:167], a[112:115], v[236:239]
v_mfma_f32_16x16x32_bf16 v[252:255], a[164:167], a[116:119], v[252:255]
ds_read_b64_tr_b16 a[164:165], v10 offset:53248
v_mfma_f32_16x16x32_bf16 a[12:15], a[168:171], a[116:119], a[12:15]
ds_read_b64_tr_b16 a[166:167], v10 offset:54272
v_mfma_f32_16x16x32_bf16 a[28:31], a[168:171], a[112:115], a[28:31]
v_mfma_f32_16x16x32_bf16 a[44:47], a[168:171], a[108:111], a[44:47]
v_mfma_f32_16x16x32_bf16 a[60:63], a[168:171], a[104:107], a[60:63]
v_mfma_f32_16x16x32_bf16 a[76:79], a[168:171], a[100:103], a[76:79]
v_mfma_f32_16x16x32_bf16 v[172:175], a[168:171], a[96:99], v[172:175]
v_mfma_f32_16x16x32_bf16 v[148:151], a[168:171], a[92:95], v[148:151]
v_mfma_f32_16x16x32_bf16 v[116:119], a[168:171], a[88:91], v[116:119]
ds_read_b64_tr_b16 a[168:169], v11 offset:36864
s_waitcnt lgkmcnt(2)
v_mfma_f32_16x16x32_bf16 v[56:59], a[120:123], a[152:155], v[56:59]
ds_read_b64_tr_b16 a[170:171], v11 offset:37888
v_mfma_f32_16x16x32_bf16 v[64:67], a[124:127], a[152:155], v[64:67]
v_mfma_f32_16x16x32_bf16 v[72:75], a[128:131], a[152:155], v[72:75]
v_mfma_f32_16x16x32_bf16 v[80:83], a[132:135], a[152:155], v[80:83]
ds_read_b64_tr_b16 a[152:153], v11 offset:53248
v_mfma_f32_16x16x32_bf16 v[84:87], a[132:135], a[156:159], v[84:87]
ds_read_b64_tr_b16 a[154:155], v11 offset:54272
v_mfma_f32_16x16x32_bf16 v[76:79], a[128:131], a[156:159], v[76:79]
v_mfma_f32_16x16x32_bf16 v[68:71], a[124:127], a[156:159], v[68:71]
v_mfma_f32_16x16x32_bf16 v[60:63], a[120:123], a[156:159], v[60:63]
ds_read_b64_tr_b16 a[156:157], v12 offset:36864
v_mfma_f32_16x16x32_bf16 v[88:91], a[160:163], a[120:123], v[88:91]
ds_read_b64_tr_b16 a[158:159], v12 offset:37888
v_mfma_f32_16x16x32_bf16 v[120:123], a[160:163], a[124:127], v[120:123]
v_mfma_f32_16x16x32_bf16 v[152:155], a[160:163], a[128:131], v[152:155]
v_mfma_f32_16x16x32_bf16 v[176:179], a[160:163], a[132:135], v[176:179]
v_mfma_f32_16x16x32_bf16 v[192:195], a[160:163], a[136:139], v[192:195]
v_mfma_f32_16x16x32_bf16 v[208:211], a[160:163], a[140:143], v[208:211]
v_mfma_f32_16x16x32_bf16 v[224:227], a[160:163], a[144:147], v[224:227]
v_mfma_f32_16x16x32_bf16 v[240:243], a[160:163], a[148:151], v[240:243]
ds_read_b64_tr_b16 a[160:161], v12 offset:53248
s_waitcnt lgkmcnt(2)
v_mfma_f32_16x16x32_bf16 a[0:3], a[164:167], a[148:151], a[0:3]
ds_read_b64_tr_b16 a[162:163], v12 offset:54272
v_mfma_f32_16x16x32_bf16 a[16:19], a[164:167], a[144:147], a[16:19]
v_mfma_f32_16x16x32_bf16 a[32:35], a[164:167], a[140:143], a[32:35]
v_mfma_f32_16x16x32_bf16 a[48:51], a[164:167], a[136:139], a[48:51]
v_mfma_f32_16x16x32_bf16 a[64:67], a[164:167], a[132:135], a[64:67]
v_mfma_f32_16x16x32_bf16 a[80:83], a[164:167], a[128:131], a[80:83]
v_mfma_f32_16x16x32_bf16 v[124:127], a[164:167], a[124:127], v[124:127]
v_mfma_f32_16x16x32_bf16 v[92:95], a[164:167], a[120:123], v[92:95]
ds_read_b64_tr_b16 a[164:165], v13 offset:36864
v_mfma_f32_16x16x32_bf16 v[96:99], a[168:171], a[120:123], v[96:99]
ds_read_b64_tr_b16 a[166:167], v13 offset:37888
v_mfma_f32_16x16x32_bf16 v[128:131], a[168:171], a[124:127], v[128:131]
v_mfma_f32_16x16x32_bf16 v[156:159], a[168:171], a[128:131], v[156:159]
v_mfma_f32_16x16x32_bf16 v[180:183], a[168:171], a[132:135], v[180:183]
v_mfma_f32_16x16x32_bf16 v[196:199], a[168:171], a[136:139], v[196:199]
v_mfma_f32_16x16x32_bf16 v[212:215], a[168:171], a[140:143], v[212:215]
v_mfma_f32_16x16x32_bf16 v[228:231], a[168:171], a[144:147], v[228:231]
v_mfma_f32_16x16x32_bf16 v[244:247], a[168:171], a[148:151], v[244:247]
ds_read_b64_tr_b16 a[168:169], v13 offset:53248
v_mfma_f32_16x16x32_bf16 a[4:7], a[152:155], a[148:151], a[4:7]
ds_read_b64_tr_b16 a[170:171], v13 offset:54272
v_mfma_f32_16x16x32_bf16 a[20:23], a[152:155], a[144:147], a[20:23]
v_mfma_f32_16x16x32_bf16 a[36:39], a[152:155], a[140:143], a[36:39]
v_mfma_f32_16x16x32_bf16 a[52:55], a[152:155], a[136:139], a[52:55]
v_mfma_f32_16x16x32_bf16 a[68:71], a[152:155], a[132:135], a[68:71]
v_mfma_f32_16x16x32_bf16 a[84:87], a[152:155], a[128:131], a[84:87]
v_mfma_f32_16x16x32_bf16 v[132:135], a[152:155], a[124:127], v[132:135]
v_mfma_f32_16x16x32_bf16 v[100:103], a[152:155], a[120:123], v[100:103]
s_waitcnt lgkmcnt(1)
v_mfma_f32_16x16x32_bf16 v[104:107], a[156:159], a[120:123], v[104:107]
v_mfma_f32_16x16x32_bf16 v[136:139], a[156:159], a[124:127], v[136:139]
v_mfma_f32_16x16x32_bf16 v[160:163], a[156:159], a[128:131], v[160:163]
v_mfma_f32_16x16x32_bf16 v[184:187], a[156:159], a[132:135], v[184:187]
v_mfma_f32_16x16x32_bf16 v[200:203], a[156:159], a[136:139], v[200:203]
v_mfma_f32_16x16x32_bf16 v[216:219], a[156:159], a[140:143], v[216:219]
v_mfma_f32_16x16x32_bf16 v[232:235], a[156:159], a[144:147], v[232:235]
v_mfma_f32_16x16x32_bf16 v[248:251], a[156:159], a[148:151], v[248:251]
s_waitcnt vmcnt(2) lgkmcnt(0)
s_barrier
s_add_u32 s52, s52, 128
s_addc_u32 s53, s53, 0
v_mfma_f32_16x16x32_bf16 a[8:11], a[160:163], a[148:151], a[8:11]
s_add_u32 s56, s56, 458752
s_addc_u32 s57, s57, 0
v_mfma_f32_16x16x32_bf16 a[24:27], a[160:163], a[144:147], a[24:27]
s_add_u32 s60, s60, 128
s_addc_u32 s61, s61, 0
v_mfma_f32_16x16x32_bf16 a[40:43], a[160:163], a[140:143], a[40:43]
s_add_u32 m0, s89, 32768
ds_read_b128 a[152:155], v14 offset:0
v_mfma_f32_16x16x32_bf16 a[56:59], a[160:163], a[136:139], a[56:59]
ds_read_b128 a[88:91], v6 offset:0
ds_read_b128 a[92:95], v6 offset:2048
v_mfma_f32_16x16x32_bf16 a[72:75], a[160:163], a[132:135], a[72:75]
ds_read_b128 a[96:99], v6 offset:4096
ds_read_b128 a[100:103], v6 offset:6144
v_mfma_f32_16x16x32_bf16 v[164:167], a[160:163], a[128:131], v[164:167]
ds_read_b128 a[156:159], v14 offset:2048
v_mfma_f32_16x16x32_bf16 v[140:143], a[160:163], a[124:127], v[140:143]
v_mfma_f32_16x16x32_bf16 v[108:111], a[160:163], a[120:123], v[108:111]
ds_read_b64_tr_b16 a[160:161], v10 offset:0
ds_read_b64_tr_b16 a[162:163], v10 offset:1024
v_mfma_f32_16x16x32_bf16 v[112:115], a[164:167], a[120:123], v[112:115]
ds_read_b128 a[104:107], v7 offset:0
ds_read_b128 a[108:111], v7 offset:2048
v_mfma_f32_16x16x32_bf16 v[144:147], a[164:167], a[124:127], v[144:147]
ds_read_b128 a[112:115], v7 offset:4096
ds_read_b128 a[116:119], v7 offset:6144
v_mfma_f32_16x16x32_bf16 v[168:171], a[164:167], a[128:131], v[168:171]
v_mfma_f32_16x16x32_bf16 v[188:191], a[164:167], a[132:135], v[188:191]
v_mfma_f32_16x16x32_bf16 v[204:207], a[164:167], a[136:139], v[204:207]
buffer_load_dwordx4 v2, s[52:55], s68 offen offset:0 lds
v_mfma_f32_16x16x32_bf16 v[220:223], a[164:167], a[140:143], v[220:223]
v_mfma_f32_16x16x32_bf16 v[236:239], a[164:167], a[144:147], v[236:239]
v_mfma_f32_16x16x32_bf16 v[252:255], a[164:167], a[148:151], v[252:255]
ds_read_b64_tr_b16 a[164:165], v10 offset:16384
ds_read_b64_tr_b16 a[166:167], v10 offset:17408
v_mfma_f32_16x16x32_bf16 a[12:15], a[168:171], a[148:151], a[12:15]
buffer_load_dwordx4 v3, s[52:55], s69 offen offset:1024 lds
v_mfma_f32_16x16x32_bf16 a[28:31], a[168:171], a[144:147], a[28:31]
v_mfma_f32_16x16x32_bf16 a[44:47], a[168:171], a[140:143], a[44:47]
v_mfma_f32_16x16x32_bf16 a[60:63], a[168:171], a[136:139], a[60:63]
v_mfma_f32_16x16x32_bf16 a[76:79], a[168:171], a[132:135], a[76:79]
buffer_load_dwordx4 v2, s[52:55], s70 offen offset:2048 lds
v_mfma_f32_16x16x32_bf16 v[172:175], a[168:171], a[128:131], v[172:175]
v_mfma_f32_16x16x32_bf16 v[148:151], a[168:171], a[124:127], v[148:151]
v_mfma_f32_16x16x32_bf16 v[116:119], a[168:171], a[120:123], v[116:119]
ds_read_b64_tr_b16 a[168:169], v11 offset:0
s_waitcnt lgkmcnt(1)
v_mfma_f32_16x16x32_bf16 v[56:59], a[88:91], a[152:155], v[56:59]
buffer_load_dwordx4 v3, s[52:55], s71 offen offset:3072 lds
v_mfma_f32_16x16x32_bf16 v[64:67], a[92:95], a[152:155], v[64:67]
s_add_u32 m0, s89, 36864
ds_read_b64_tr_b16 a[170:171], v11 offset:1024
v_mfma_f32_16x16x32_bf16 v[72:75], a[96:99], a[152:155], v[72:75]
v_mfma_f32_16x16x32_bf16 v[80:83], a[100:103], a[152:155], v[80:83]
ds_read_b64_tr_b16 a[152:153], v11 offset:16384
v_mfma_f32_16x16x32_bf16 v[84:87], a[100:103], a[156:159], v[84:87]
buffer_load_dwordx4 v2, s[52:55], s72 offen offset:0 lds
v_mfma_f32_16x16x32_bf16 v[76:79], a[96:99], a[156:159], v[76:79]
ds_read_b64_tr_b16 a[154:155], v11 offset:17408
v_mfma_f32_16x16x32_bf16 v[68:71], a[92:95], a[156:159], v[68:71]
v_mfma_f32_16x16x32_bf16 v[60:63], a[88:91], a[156:159], v[60:63]
ds_read_b64_tr_b16 a[156:157], v12 offset:0
v_mfma_f32_16x16x32_bf16 v[88:91], a[160:163], a[88:91], v[88:91]
buffer_load_dwordx4 v3, s[52:55], s73 offen offset:1024 lds
v_mfma_f32_16x16x32_bf16 v[120:123], a[160:163], a[92:95], v[120:123]
ds_read_b64_tr_b16 a[158:159], v12 offset:1024
v_mfma_f32_16x16x32_bf16 v[152:155], a[160:163], a[96:99], v[152:155]
v_mfma_f32_16x16x32_bf16 v[176:179], a[160:163], a[100:103], v[176:179]
v_mfma_f32_16x16x32_bf16 v[192:195], a[160:163], a[104:107], v[192:195]
buffer_load_dwordx4 v2, s[52:55], s74 offen offset:2048 lds
v_mfma_f32_16x16x32_bf16 v[208:211], a[160:163], a[108:111], v[208:211]
v_mfma_f32_16x16x32_bf16 v[224:227], a[160:163], a[112:115], v[224:227]
v_mfma_f32_16x16x32_bf16 v[240:243], a[160:163], a[116:119], v[240:243]
ds_read_b64_tr_b16 a[160:161], v12 offset:16384
v_mfma_f32_16x16x32_bf16 a[0:3], a[164:167], a[116:119], a[0:3]
buffer_load_dwordx4 v3, s[52:55], s75 offen offset:3072 lds
v_mfma_f32_16x16x32_bf16 a[16:19], a[164:167], a[112:115], a[16:19]
s_add_u32 m0, s90, 32768
ds_read_b64_tr_b16 a[162:163], v12 offset:17408
v_mfma_f32_16x16x32_bf16 a[32:35], a[164:167], a[108:111], a[32:35]
v_mfma_f32_16x16x32_bf16 a[48:51], a[164:167], a[104:107], a[48:51]
v_mfma_f32_16x16x32_bf16 a[64:67], a[164:167], a[100:103], a[64:67]
buffer_load_dwordx4 v4, s[56:59], s76 offen offset:0 lds
v_mfma_f32_16x16x32_bf16 a[80:83], a[164:167], a[96:99], a[80:83]
v_mfma_f32_16x16x32_bf16 v[124:127], a[164:167], a[92:95], v[124:127]
v_mfma_f32_16x16x32_bf16 v[92:95], a[164:167], a[88:91], v[92:95]
ds_read_b64_tr_b16 a[164:165], v13 offset:0
s_waitcnt lgkmcnt(2)
v_mfma_f32_16x16x32_bf16 v[96:99], a[168:171], a[88:91], v[96:99]
buffer_load_dwordx4 v4, s[56:59], s77 offen offset:1024 lds
v_mfma_f32_16x16x32_bf16 v[128:131], a[168:171], a[92:95], v[128:131]
ds_read_b64_tr_b16 a[166:167], v13 offset:1024
v_mfma_f32_16x16x32_bf16 v[156:159], a[168:171], a[96:99], v[156:159]
v_mfma_f32_16x16x32_bf16 v[180:183], a[168:171], a[100:103], v[180:183]
v_mfma_f32_16x16x32_bf16 v[196:199], a[168:171], a[104:107], v[196:199]
buffer_load_dwordx4 v4, s[56:59], s78 offen offset:2048 lds
v_mfma_f32_16x16x32_bf16 v[212:215], a[168:171], a[108:111], v[212:215]
v_mfma_f32_16x16x32_bf16 v[228:231], a[168:171], a[112:115], v[228:231]
v_mfma_f32_16x16x32_bf16 v[244:247], a[168:171], a[116:119], v[244:247]
ds_read_b64_tr_b16 a[168:169], v13 offset:16384
v_mfma_f32_16x16x32_bf16 a[4:7], a[152:155], a[116:119], a[4:7]
buffer_load_dwordx4 v4, s[56:59], s79 offen offset:3072 lds
v_mfma_f32_16x16x32_bf16 a[20:23], a[152:155], a[112:115], a[20:23]
s_add_u32 m0, s90, 36864
ds_read_b64_tr_b16 a[170:171], v13 offset:17408
v_mfma_f32_16x16x32_bf16 a[36:39], a[152:155], a[108:111], a[36:39]
v_mfma_f32_16x16x32_bf16 a[52:55], a[152:155], a[104:107], a[52:55]
s_sub_u32 s10, s10, 1
v_mfma_f32_16x16x32_bf16 a[68:71], a[152:155], a[100:103], a[68:71]
buffer_load_dwordx4 v4, s[56:59], s80 offen offset:0 lds
v_mfma_f32_16x16x32_bf16 a[84:87], a[152:155], a[96:99], a[84:87]
v_mfma_f32_16x16x32_bf16 v[132:135], a[152:155], a[92:95], v[132:135]
v_mfma_f32_16x16x32_bf16 v[100:103], a[152:155], a[88:91], v[100:103]
ds_read_b128 a[152:155], v15 offset:0
v_mfma_f32_16x16x32_bf16 v[104:107], a[156:159], a[88:91], v[104:107]
buffer_load_dwordx4 v4, s[56:59], s81 offen offset:1024 lds
v_mfma_f32_16x16x32_bf16 v[136:139], a[156:159], a[92:95], v[136:139]
ds_read_b128 a[120:123], v8 offset:0
ds_read_b128 a[124:127], v8 offset:2048
v_mfma_f32_16x16x32_bf16 v[160:163], a[156:159], a[96:99], v[160:163]
ds_read_b128 a[128:131], v8 offset:4096
ds_read_b128 a[132:135], v8 offset:6144
v_mfma_f32_16x16x32_bf16 v[184:187], a[156:159], a[100:103], v[184:187]
v_mfma_f32_16x16x32_bf16 v[200:203], a[156:159], a[104:107], v[200:203]
buffer_load_dwordx4 v4, s[56:59], s82 offen offset:2048 lds
v_mfma_f32_16x16x32_bf16 v[216:219], a[156:159], a[108:111], v[216:219]
v_mfma_f32_16x16x32_bf16 v[232:235], a[156:159], a[112:115], v[232:235]
v_mfma_f32_16x16x32_bf16 v[248:251], a[156:159], a[116:119], v[248:251]
ds_read_b128 a[156:159], v15 offset:2048
s_waitcnt lgkmcnt(5)
v_mfma_f32_16x16x32_bf16 a[8:11], a[160:163], a[116:119], a[8:11]
buffer_load_dwordx4 v4, s[56:59], s83 offen offset:3072 lds
v_mfma_f32_16x16x32_bf16 a[24:27], a[160:163], a[112:115], a[24:27]
s_add_u32 m0, s91, 4096
v_mfma_f32_16x16x32_bf16 a[40:43], a[160:163], a[108:111], a[40:43]
v_mfma_f32_16x16x32_bf16 a[56:59], a[160:163], a[104:107], a[56:59]
v_mfma_f32_16x16x32_bf16 a[72:75], a[160:163], a[100:103], a[72:75]
buffer_load_dwordx4 v5, s[60:63], s84 offen offset:0 lds
v_mfma_f32_16x16x32_bf16 v[164:167], a[160:163], a[96:99], v[164:167]
v_mfma_f32_16x16x32_bf16 v[140:143], a[160:163], a[92:95], v[140:143]
v_mfma_f32_16x16x32_bf16 v[108:111], a[160:163], a[88:91], v[108:111]
buffer_load_dword v22, v20, s[20:23], 0 offen
v_mfma_f32_16x16x32_bf16 v[112:115], a[164:167], a[88:91], v[112:115]
v_add_u32 v20, s28, v20
ds_read_b64_tr_b16 a[160:161], v10 offset:4096
v_mfma_f32_16x16x32_bf16 v[144:147], a[164:167], a[92:95], v[144:147]
ds_read_b64_tr_b16 a[162:163], v10 offset:5120
ds_read_b128 a[136:139], v9 offset:0
v_mfma_f32_16x16x32_bf16 v[168:171], a[164:167], a[96:99], v[168:171]
buffer_load_dword v22, v21, s[24:27], 0 offen
v_mfma_f32_16x16x32_bf16 v[188:191], a[164:167], a[100:103], v[188:191]
v_add_u32 v21, s29, v21
ds_read_b128 a[140:143], v9 offset:2048
v_mfma_f32_16x16x32_bf16 v[204:207], a[164:167], a[104:107], v[204:207]
ds_read_b128 a[144:147], v9 offset:4096
ds_read_b128 a[148:151], v9 offset:6144
v_mfma_f32_16x16x32_bf16 v[220:223], a[164:167], a[108:111], v[220:223]
v_mfma_f32_16x16x32_bf16 v[236:239], a[164:167], a[112:115], v[236:239]
v_mfma_f32_16x16x32_bf16 v[252:255], a[164:167], a[116:119], v[252:255]
ds_read_b64_tr_b16 a[164:165], v10 offset:20480
v_mfma_f32_16x16x32_bf16 a[12:15], a[168:171], a[116:119], a[12:15]
ds_read_b64_tr_b16 a[166:167], v10 offset:21504
v_mfma_f32_16x16x32_bf16 a[28:31], a[168:171], a[112:115], a[28:31]
v_mfma_f32_16x16x32_bf16 a[44:47], a[168:171], a[108:111], a[44:47]
v_mfma_f32_16x16x32_bf16 a[60:63], a[168:171], a[104:107], a[60:63]
v_mfma_f32_16x16x32_bf16 a[76:79], a[168:171], a[100:103], a[76:79]
v_mfma_f32_16x16x32_bf16 v[172:175], a[168:171], a[96:99], v[172:175]
v_mfma_f32_16x16x32_bf16 v[148:151], a[168:171], a[92:95], v[148:151]
v_mfma_f32_16x16x32_bf16 v[116:119], a[168:171], a[88:91], v[116:119]
ds_read_b64_tr_b16 a[168:169], v11 offset:4096
s_waitcnt lgkmcnt(2)
v_mfma_f32_16x16x32_bf16 v[56:59], a[120:123], a[152:155], v[56:59]
ds_read_b64_tr_b16 a[170:171], v11 offset:5120
v_mfma_f32_16x16x32_bf16 v[64:67], a[124:127], a[152:155], v[64:67]
v_mfma_f32_16x16x32_bf16 v[72:75], a[128:131], a[152:155], v[72:75]
v_mfma_f32_16x16x32_bf16 v[80:83], a[132:135], a[152:155], v[80:83]
ds_read_b64_tr_b16 a[152:153], v11 offset:20480
v_mfma_f32_16x16x32_bf16 v[84:87], a[132:135], a[156:159], v[84:87]
ds_read_b64_tr_b16 a[154:155], v11 offset:21504
v_mfma_f32_16x16x32_bf16 v[76:79], a[128:131], a[156:159], v[76:79]
v_mfma_f32_16x16x32_bf16 v[68:71], a[124:127], a[156:159], v[68:71]
v_mfma_f32_16x16x32_bf16 v[60:63], a[120:123], a[156:159], v[60:63]
ds_read_b64_tr_b16 a[156:157], v12 offset:4096
v_mfma_f32_16x16x32_bf16 v[88:91], a[160:163], a[120:123], v[88:91]
ds_read_b64_tr_b16 a[158:159], v12 offset:5120
v_mfma_f32_16x16x32_bf16 v[120:123], a[160:163], a[124:127], v[120:123]
v_mfma_f32_16x16x32_bf16 v[152:155], a[160:163], a[128:131], v[152:155]
v_mfma_f32_16x16x32_bf16 v[176:179], a[160:163], a[132:135], v[176:179]
v_mfma_f32_16x16x32_bf16 v[192:195], a[160:163], a[136:139], v[192:195]
v_mfma_f32_16x16x32_bf16 v[208:211], a[160:163], a[140:143], v[208:211]
v_mfma_f32_16x16x32_bf16 v[224:227], a[160:163], a[144:147], v[224:227]
v_mfma_f32_16x16x32_bf16 v[240:243], a[160:163], a[148:151], v[240:243]
ds_read_b64_tr_b16 a[160:161], v12 offset:20480
s_waitcnt lgkmcnt(2)
v_mfma_f32_16x16x32_bf16 a[0:3], a[164:167], a[148:151], a[0:3]
ds_read_b64_tr_b16 a[162:163], v12 offset:21504
v_mfma_f32_16x16x32_bf16 a[16:19], a[164:167], a[144:147], a[16:19]
v_mfma_f32_16x16x32_bf16 a[32:35], a[164:167], a[140:143], a[32:35]
v_mfma_f32_16x16x32_bf16 a[48:51], a[164:167], a[136:139], a[48:51]
v_mfma_f32_16x16x32_bf16 a[64:67], a[164:167], a[132:135], a[64:67]
v_mfma_f32_16x16x32_bf16 a[80:83], a[164:167], a[128:131], a[80:83]
v_mfma_f32_16x16x32_bf16 v[124:127], a[164:167], a[124:127], v[124:127]
v_mfma_f32_16x16x32_bf16 v[92:95], a[164:167], a[120:123], v[92:95]
ds_read_b64_tr_b16 a[164:165], v13 offset:4096
v_mfma_f32_16x16x32_bf16 v[96:99], a[168:171], a[120:123], v[96:99]
ds_read_b64_tr_b16 a[166:167], v13 offset:5120
v_mfma_f32_16x16x32_bf16 v[128:131], a[168:171], a[124:127], v[128:131]
v_mfma_f32_16x16x32_bf16 v[156:159], a[168:171], a[128:131], v[156:159]
v_mfma_f32_16x16x32_bf16 v[180:183], a[168:171], a[132:135], v[180:183]
v_mfma_f32_16x16x32_bf16 v[196:199], a[168:171], a[136:139], v[196:199]
v_mfma_f32_16x16x32_bf16 v[212:215], a[168:171], a[140:143], v[212:215]
v_mfma_f32_16x16x32_bf16 v[228:231], a[168:171], a[144:147], v[228:231]
v_mfma_f32_16x16x32_bf16 v[244:247], a[168:171], a[148:151], v[244:247]
ds_read_b64_tr_b16 a[168:169], v13 offset:20480
v_mfma_f32_16x16x32_bf16 a[4:7], a[152:155], a[148:151], a[4:7]
ds_read_b64_tr_b16 a[170:171], v13 offset:21504
v_mfma_f32_16x16x32_bf16 a[20:23], a[152:155], a[144:147], a[20:23]
v_mfma_f32_16x16x32_bf16 a[36:39], a[152:155], a[140:143], a[36:39]
v_mfma_f32_16x16x32_bf16 a[52:55], a[152:155], a[136:139], a[52:55]
v_mfma_f32_16x16x32_bf16 a[68:71], a[152:155], a[132:135], a[68:71]
v_mfma_f32_16x16x32_bf16 a[84:87], a[152:155], a[128:131], a[84:87]
v_mfma_f32_16x16x32_bf16 v[132:135], a[152:155], a[124:127], v[132:135]
v_mfma_f32_16x16x32_bf16 v[100:103], a[152:155], a[120:123], v[100:103]
s_waitcnt lgkmcnt(1)
v_mfma_f32_16x16x32_bf16 v[104:107], a[156:159], a[120:123], v[104:107]
v_mfma_f32_16x16x32_bf16 v[136:139], a[156:159], a[124:127], v[136:139]
v_mfma_f32_16x16x32_bf16 v[160:163], a[156:159], a[128:131], v[160:163]
v_mfma_f32_16x16x32_bf16 v[184:187], a[156:159], a[132:135], v[184:187]
v_mfma_f32_16x16x32_bf16 v[200:203], a[156:159], a[136:139], v[200:203]
v_mfma_f32_16x16x32_bf16 v[216:219], a[156:159], a[140:143], v[216:219]
v_mfma_f32_16x16x32_bf16 v[232:235], a[156:159], a[144:147], v[232:235]
v_mfma_f32_16x16x32_bf16 v[248:251], a[156:159], a[148:151], v[248:251]
s_waitcnt vmcnt(2) lgkmcnt(0)
s_barrier
s_cmp_lg_u32 s10, 0
s_cbranch_scc1 L1A_loop
v_mfma_f32_16x16x32_bf16 a[8:11], a[160:163], a[148:151], a[8:11]
ds_read_b128 a[152:155], v14 offset:4096
ds_read_b128 a[88:91], v6 offset:32768
v_mfma_f32_16x16x32_bf16 a[24:27], a[160:163], a[144:147], a[24:27]
ds_read_b128 a[92:95], v6 offset:34816
ds_read_b128 a[96:99], v6 offset:36864
v_mfma_f32_16x16x32_bf16 a[40:43], a[160:163], a[140:143], a[40:43]
ds_read_b128 a[100:103], v6 offset:38912
ds_read_b128 a[156:159], v14 offset:6144
v_mfma_f32_16x16x32_bf16 a[56:59], a[160:163], a[136:139], a[56:59]
v_mfma_f32_16x16x32_bf16 a[72:75], a[160:163], a[132:135], a[72:75]
v_mfma_f32_16x16x32_bf16 v[164:167], a[160:163], a[128:131], v[164:167]
v_mfma_f32_16x16x32_bf16 v[140:143], a[160:163], a[124:127], v[140:143]
v_mfma_f32_16x16x32_bf16 v[108:111], a[160:163], a[120:123], v[108:111]
ds_read_b64_tr_b16 a[160:161], v10 offset:32768
ds_read_b64_tr_b16 a[162:163], v10 offset:33792
v_mfma_f32_16x16x32_bf16 v[112:115], a[164:167], a[120:123], v[112:115]
ds_read_b128 a[104:107], v7 offset:32768
ds_read_b128 a[108:111], v7 offset:34816
v_mfma_f32_16x16x32_bf16 v[144:147], a[164:167], a[124:127], v[144:147]
ds_read_b128 a[112:115], v7 offset:36864
ds_read_b128 a[116:119], v7 offset:38912
v_mfma_f32_16x16x32_bf16 v[168:171], a[164:167], a[128:131], v[168:171]
v_mfma_f32_16x16x32_bf16 v[188:191], a[164:167], a[132:135], v[188:191]
v_mfma_f32_16x16x32_bf16 v[204:207], a[164:167], a[136:139], v[204:207]
v_mfma_f32_16x16x32_bf16 v[220:223], a[164:167], a[140:143], v[220:223]
s_getpc_b64 s[92:93]
L1A_pc0:
s_add_u32 s92, s92, L1A_epi-L1A_pc0
s_addc_u32 s93, s93, 0
global_load_dword v22, v43, s[92:93]
v_mfma_f32_16x16x32_bf16 v[236:239], a[164:167], a[144:147], v[236:239]
v_mfma_f32_16x16x32_bf16 v[252:255], a[164:167], a[148:151], v[252:255]
ds_read_b64_tr_b16 a[164:165], v10 offset:49152
ds_read_b64_tr_b16 a[166:167], v10 offset:50176
v_mfma_f32_16x16x32_bf16 a[12:15], a[168:171], a[148:151], a[12:15]
v_mfma_f32_16x16x32_bf16 a[28:31], a[168:171], a[144:147], a[28:31]
v_mfma_f32_16x16x32_bf16 a[44:47], a[168:171], a[140:143], a[44:47]
v_mfma_f32_16x16x32_bf16 a[60:63], a[168:171], a[136:139], a[60:63]
s_getpc_b64 s[92:93]
L1A_pc1:
s_add_u32 s92, s92, L2_start-L1A_pc1
s_addc_u32 s93, s93, 0
global_load_dword v22, v43, s[92:93]
v_mfma_f32_16x16x32_bf16 a[76:79], a[168:171], a[132:135], a[76:79]
v_mfma_f32_16x16x32_bf16 v[172:175], a[168:171], a[128:131], v[172:175]
v_mfma_f32_16x16x32_bf16 v[148:151], a[168:171], a[124:127], v[148:151]
v_mfma_f32_16x16x32_bf16 v[116:119], a[168:171], a[120:123], v[116:119]
ds_read_b64_tr_b16 a[168:169], v11 offset:32768
s_waitcnt lgkmcnt(1)
v_mfma_f32_16x16x32_bf16 v[56:59], a[88:91], a[152:155], v[56:59]
ds_read_b64_tr_b16 a[170:171], v11 offset:33792
v_mfma_f32_16x16x32_bf16 v[64:67], a[92:95], a[152:155], v[64:67]
v_mfma_f32_16x16x32_bf16 v[72:75], a[96:99], a[152:155], v[72:75]
v_mfma_f32_16x16x32_bf16 v[80:83], a[100:103], a[152:155], v[80:83]
ds_read_b64_tr_b16 a[152:153], v11 offset:49152
v_mfma_f32_16x16x32_bf16 v[84:87], a[100:103], a[156:159], v[84:87]
ds_read_b64_tr_b16 a[154:155], v11 offset:50176
v_mfma_f32_16x16x32_bf16 v[76:79], a[96:99], a[156:159], v[76:79]
s_bfe_u32 s11, s2, 0x10001
s_lshl_b32 s11, s11, 3
s_add_u32 s80, s11, s4
s_and_b32 s11, s2, 4
s_add_u32 s81, s11, s5
v_mfma_f32_16x16x32_bf16 v[68:71], a[92:95], a[156:159], v[68:71]
v_mov_b32 v24, -1
v_mov_b32 v25, -1
v_mfma_f32_16x16x32_bf16 v[60:63], a[88:91], a[156:159], v[60:63]
v_mov_b32 v26, -1
v_mfma_f32_16x16x32_bf16 v[88:91], a[160:163], a[88:91], v[88:91]
v_mov_b32 v27, -1
ds_read_b64_tr_b16 a[156:157], v12 offset:32768
v_mfma_f32_16x16x32_bf16 v[120:123], a[160:163], a[92:95], v[120:123]
ds_read_b64_tr_b16 a[158:159], v12 offset:33792
v_mfma_f32_16x16x32_bf16 v[152:155], a[160:163], a[96:99], v[152:155]
v_mfma_f32_16x16x32_bf16 v[176:179], a[160:163], a[100:103], v[176:179]
s_lshl_b32 s11, s80, 3
s_add_u32 s11, s11, s81
s_lshl_b32 s11, s11, 1
s_add_u32 s11, s11, s15
v_mfma_f32_16x16x32_bf16 v[192:195], a[160:163], a[104:107], v[192:195]
v_mfma_f32_16x16x32_bf16 v[208:211], a[160:163], a[108:111], v[208:211]
v_mfma_f32_16x16x32_bf16 v[224:227], a[160:163], a[112:115], v[224:227]
v_mfma_f32_16x16x32_bf16 v[240:243], a[160:163], a[116:119], v[240:243]
ds_read_b64_tr_b16 a[160:161], v12 offset:49152
v_mfma_f32_16x16x32_bf16 a[0:3], a[164:167], a[116:119], a[0:3]
ds_read_b64_tr_b16 a[162:163], v12 offset:50176
v_mfma_f32_16x16x32_bf16 a[16:19], a[164:167], a[112:115], a[16:19]
s_lshl_b32 s11, s11, 2
s_add_u32 s83, s11, s3
s_xor_b32 s11, s83, 4
s_lshl_b32 s11, s11, 12
v_mfma_f32_16x16x32_bf16 a[32:35], a[164:167], a[108:111], a[32:35]
v_mfma_f32_16x16x32_bf16 a[48:51], a[164:167], a[104:107], a[48:51]
v_mfma_f32_16x16x32_bf16 a[64:67], a[164:167], a[100:103], a[64:67]
v_mfma_f32_16x16x32_bf16 a[80:83], a[164:167], a[96:99], a[80:83]
v_mfma_f32_16x16x32_bf16 v[124:127], a[164:167], a[92:95], v[124:127]
v_mfma_f32_16x16x32_bf16 v[92:95], a[164:167], a[88:91], v[92:95]
ds_read_b64_tr_b16 a[164:165], v13 offset:32768
s_waitcnt lgkmcnt(2)
v_mfma_f32_16x16x32_bf16 v[96:99], a[168:171], a[88:91], v[96:99]
s_add_u32 s64, s48, 25165824
s_addc_u32 s65, s49, 0
s_mov_b32 s66, 4194304
v_mfma_f32_16x16x32_bf16 v[128:131], a[168:171], a[92:95], v[128:131]
ds_read_b64_tr_b16 a[166:167], v13 offset:33792
s_mul_i32 s94, s15, 28
v_mfma_f32_16x16x32_bf16 v[156:159], a[168:171], a[96:99], v[156:159]
s_add_u32 s94, s94, s8
s_lshl_b32 s94, s94, 17
v_mfma_f32_16x16x32_bf16 v[180:183], a[168:171], a[100:103], v[180:183]
s_xor_b32 s95, s7, s15
s_lshl_b32 s84, s81, 1
v_mfma_f32_16x16x32_bf16 v[196:199], a[168:171], a[104:107], v[196:199]
s_add_u32 s95, s95, s84
s_lshl_b32 s95, s95, 7
v_mfma_f32_16x16x32_bf16 v[212:215], a[168:171], a[108:111], v[212:215]
s_add_u32 s94, s94, s95
v_mfma_f32_16x16x32_bf16 v[228:231], a[168:171], a[112:115], v[228:231]
s_add_u32 s52, s40, s94
s_addc_u32 s53, s41, 0
v_mfma_f32_16x16x32_bf16 v[244:247], a[168:171], a[116:119], v[244:247]
buffer_store_dwordx4 v[24:27], v1, s[64:67], s11 offen offset:0 sc0 sc1
v_mfma_f32_16x16x32_bf16 a[4:7], a[152:155], a[116:119], a[4:7]
ds_read_b64_tr_b16 a[168:169], v13 offset:49152
ds_read_b64_tr_b16 a[170:171], v13 offset:50176
v_mfma_f32_16x16x32_bf16 a[20:23], a[152:155], a[112:115], a[20:23]
s_sub_u32 s52, s52, 3072
s_subb_u32 s53, s53, 0
v_mfma_f32_16x16x32_bf16 a[36:39], a[152:155], a[108:111], a[36:39]
s_mov_b32 s54, 134144
s_mov_b32 s77, 262144
v_mfma_f32_16x16x32_bf16 a[52:55], a[152:155], a[104:107], a[52:55]
s_lshl_b32 s76, s3, 13
v_lshrrev_b32 v28, 4, v1
v_mfma_f32_16x16x32_bf16 a[68:71], a[152:155], a[100:103], a[68:71]
v_lshrrev_b32 v29, 4, v28
v_bfe_u32 v30, v28, 3, 1
v_mfma_f32_16x16x32_bf16 a[84:87], a[152:155], a[96:99], a[84:87]
buffer_store_dwordx4 v[24:27], v1, s[64:67], s11 offen offset:1024 sc0 sc1
v_mfma_f32_16x16x32_bf16 v[132:135], a[152:155], a[92:95], v[132:135]
v_lshl_add_u32 v30, v30, 2, v29
v_bfe_u32 v31, v28, 1, 2
v_mfma_f32_16x16x32_bf16 v[100:103], a[152:155], a[88:91], v[100:103]
v_xor_b32 v31, v31, v29
v_mfma_f32_16x16x32_bf16 v[104:107], a[156:159], a[88:91], v[104:107]
v_lshlrev_b32 v31, 5, v31
v_and_b32 v28, 1, v28
v_mfma_f32_16x16x32_bf16 v[136:139], a[156:159], a[92:95], v[136:139]
v_lshl_add_u32 v31, v28, 4, v31
v_lshl_add_u32 v0, v30, 11, v31
v_mfma_f32_16x16x32_bf16 v[160:163], a[156:159], a[96:99], v[160:163]
s_mov_b32 s68, 3072
s_mov_b32 s69, 18432
v_mfma_f32_16x16x32_bf16 v[184:187], a[156:159], a[100:103], v[184:187]
buffer_store_dwordx4 v[24:27], v1, s[64:67], s11 offen offset:2048 sc0 sc1
v_mfma_f32_16x16x32_bf16 v[200:203], a[156:159], a[104:107], v[200:203]
s_mov_b32 s70, 33792
s_mov_b32 s71, 49152
v_mfma_f32_16x16x32_bf16 v[216:219], a[156:159], a[108:111], v[216:219]
s_mov_b32 s72, 68608
s_mov_b32 s73, 83968
v_mfma_f32_16x16x32_bf16 v[232:235], a[156:159], a[112:115], v[232:235]
s_mov_b32 s74, 99328
s_mov_b32 s75, 114688
v_mfma_f32_16x16x32_bf16 v[248:251], a[156:159], a[116:119], v[248:251]
ds_read_b128 a[152:155], v15 offset:4096
s_waitcnt lgkmcnt(1)
v_mfma_f32_16x16x32_bf16 a[8:11], a[160:163], a[116:119], a[8:11]
ds_read_b128 a[120:123], v8 offset:32768
ds_read_b128 a[124:127], v8 offset:34816
v_mfma_f32_16x16x32_bf16 a[24:27], a[160:163], a[112:115], a[24:27]
buffer_store_dwordx4 v[24:27], v1, s[64:67], s11 offen offset:3072 sc0 sc1
v_mfma_f32_16x16x32_bf16 a[40:43], a[160:163], a[108:111], a[40:43]
ds_read_b128 a[128:131], v8 offset:36864
ds_read_b128 a[132:135], v8 offset:38912
v_mfma_f32_16x16x32_bf16 a[56:59], a[160:163], a[104:107], a[56:59]
ds_read_b128 a[156:159], v15 offset:6144
v_mfma_f32_16x16x32_bf16 a[72:75], a[160:163], a[100:103], a[72:75]
v_mfma_f32_16x16x32_bf16 v[164:167], a[160:163], a[96:99], v[164:167]
v_mfma_f32_16x16x32_bf16 v[140:143], a[160:163], a[92:95], v[140:143]
v_mfma_f32_16x16x32_bf16 v[108:111], a[160:163], a[88:91], v[108:111]
ds_read_b64_tr_b16 a[160:161], v10 offset:36864
v_mfma_f32_16x16x32_bf16 v[112:115], a[164:167], a[88:91], v[112:115]
ds_read_b64_tr_b16 a[162:163], v10 offset:37888
ds_read_b128 a[136:139], v9 offset:32768
v_mfma_f32_16x16x32_bf16 v[144:147], a[164:167], a[92:95], v[144:147]
ds_read_b128 a[140:143], v9 offset:34816
ds_read_b128 a[144:147], v9 offset:36864
v_mfma_f32_16x16x32_bf16 v[168:171], a[164:167], a[96:99], v[168:171]
ds_read_b128 a[148:151], v9 offset:38912
v_mfma_f32_16x16x32_bf16 v[188:191], a[164:167], a[100:103], v[188:191]
v_mfma_f32_16x16x32_bf16 v[204:207], a[164:167], a[104:107], v[204:207]
v_mfma_f32_16x16x32_bf16 v[220:223], a[164:167], a[108:111], v[220:223]
v_mfma_f32_16x16x32_bf16 v[236:239], a[164:167], a[112:115], v[236:239]
s_add_u32 m0, s76, 0
v_mfma_f32_16x16x32_bf16 v[252:255], a[164:167], a[116:119], v[252:255]
buffer_load_dwordx4 v0, s[52:55], s68 offen offset:0  lds
v_mfma_f32_16x16x32_bf16 a[12:15], a[168:171], a[116:119], a[12:15]
ds_read_b64_tr_b16 a[164:165], v10 offset:53248
ds_read_b64_tr_b16 a[166:167], v10 offset:54272
v_mfma_f32_16x16x32_bf16 a[28:31], a[168:171], a[112:115], a[28:31]
v_mfma_f32_16x16x32_bf16 a[44:47], a[168:171], a[108:111], a[44:47]
v_mfma_f32_16x16x32_bf16 a[60:63], a[168:171], a[104:107], a[60:63]
v_mfma_f32_16x16x32_bf16 a[76:79], a[168:171], a[100:103], a[76:79]
buffer_load_dwordx4 v0, s[52:55], s69 offen offset:1024  lds
v_mfma_f32_16x16x32_bf16 v[172:175], a[168:171], a[96:99], v[172:175]
v_mfma_f32_16x16x32_bf16 v[148:151], a[168:171], a[92:95], v[148:151]
v_mfma_f32_16x16x32_bf16 v[116:119], a[168:171], a[88:91], v[116:119]
ds_read_b64_tr_b16 a[168:169], v11 offset:36864
s_waitcnt lgkmcnt(3)
v_mfma_f32_16x16x32_bf16 v[56:59], a[120:123], a[152:155], v[56:59]
ds_read_b64_tr_b16 a[170:171], v11 offset:37888
v_mfma_f32_16x16x32_bf16 v[64:67], a[124:127], a[152:155], v[64:67]
buffer_load_dwordx4 v0, s[52:55], s70 offen offset:2048  lds
v_mfma_f32_16x16x32_bf16 v[72:75], a[128:131], a[152:155], v[72:75]
v_mfma_f32_16x16x32_bf16 v[80:83], a[132:135], a[152:155], v[80:83]
ds_read_b64_tr_b16 a[152:153], v11 offset:53248
v_mfma_f32_16x16x32_bf16 v[84:87], a[132:135], a[156:159], v[84:87]
ds_read_b64_tr_b16 a[154:155], v11 offset:54272
v_mfma_f32_16x16x32_bf16 v[76:79], a[128:131], a[156:159], v[76:79]
v_mfma_f32_16x16x32_bf16 v[68:71], a[124:127], a[156:159], v[68:71]
buffer_load_dwordx4 v0, s[52:55], s71 offen offset:3072  lds
v_mfma_f32_16x16x32_bf16 v[60:63], a[120:123], a[156:159], v[60:63]
ds_read_b64_tr_b16 a[156:157], v12 offset:36864
v_mfma_f32_16x16x32_bf16 v[88:91], a[160:163], a[120:123], v[88:91]
ds_read_b64_tr_b16 a[158:159], v12 offset:37888
v_mfma_f32_16x16x32_bf16 v[120:123], a[160:163], a[124:127], v[120:123]
v_mfma_f32_16x16x32_bf16 v[152:155], a[160:163], a[128:131], v[152:155]
s_add_u32 m0, s76, 4096
v_mfma_f32_16x16x32_bf16 v[176:179], a[160:163], a[132:135], v[176:179]
buffer_load_dwordx4 v0, s[52:55], s72 offen offset:0  lds
v_mfma_f32_16x16x32_bf16 v[192:195], a[160:163], a[136:139], v[192:195]
v_mfma_f32_16x16x32_bf16 v[208:211], a[160:163], a[140:143], v[208:211]
v_mfma_f32_16x16x32_bf16 v[224:227], a[160:163], a[144:147], v[224:227]
v_mfma_f32_16x16x32_bf16 v[240:243], a[160:163], a[148:151], v[240:243]
ds_read_b64_tr_b16 a[160:161], v12 offset:53248
s_waitcnt lgkmcnt(2)
v_mfma_f32_16x16x32_bf16 a[0:3], a[164:167], a[148:151], a[0:3]
buffer_load_dwordx4 v0, s[52:55], s73 offen offset:1024  lds
v_mfma_f32_16x16x32_bf16 a[16:19], a[164:167], a[144:147], a[16:19]
ds_read_b64_tr_b16 a[162:163], v12 offset:54272
v_mfma_f32_16x16x32_bf16 a[32:35], a[164:167], a[140:143], a[32:35]
v_mfma_f32_16x16x32_bf16 a[48:51], a[164:167], a[136:139], a[48:51]
v_mfma_f32_16x16x32_bf16 a[64:67], a[164:167], a[132:135], a[64:67]
v_mfma_f32_16x16x32_bf16 a[80:83], a[164:167], a[128:131], a[80:83]
buffer_load_dwordx4 v0, s[52:55], s74 offen offset:2048  lds
v_mfma_f32_16x16x32_bf16 v[124:127], a[164:167], a[124:127], v[124:127]
v_mfma_f32_16x16x32_bf16 v[92:95], a[164:167], a[120:123], v[92:95]
ds_read_b64_tr_b16 a[164:165], v13 offset:36864
v_mfma_f32_16x16x32_bf16 v[96:99], a[168:171], a[120:123], v[96:99]
ds_read_b64_tr_b16 a[166:167], v13 offset:37888
v_mfma_f32_16x16x32_bf16 v[128:131], a[168:171], a[124:127], v[128:131]
v_mfma_f32_16x16x32_bf16 v[156:159], a[168:171], a[128:131], v[156:159]
buffer_load_dwordx4 v0, s[52:55], s75 offen offset:3072  lds
v_mfma_f32_16x16x32_bf16 v[180:183], a[168:171], a[132:135], v[180:183]
v_mfma_f32_16x16x32_bf16 v[196:199], a[168:171], a[136:139], v[196:199]
v_mfma_f32_16x16x32_bf16 v[212:215], a[168:171], a[140:143], v[212:215]
v_mfma_f32_16x16x32_bf16 v[228:231], a[168:171], a[144:147], v[228:231]
v_mfma_f32_16x16x32_bf16 v[244:247], a[168:171], a[148:151], v[244:247]
ds_read_b64_tr_b16 a[168:169], v13 offset:53248
v_mfma_f32_16x16x32_bf16 a[4:7], a[152:155], a[148:151], a[4:7]
ds_read_b64_tr_b16 a[170:171], v13 offset:54272
v_mfma_f32_16x16x32_bf16 a[20:23], a[152:155], a[144:147], a[20:23]
v_mfma_f32_16x16x32_bf16 a[36:39], a[152:155], a[140:143], a[36:39]
v_mfma_f32_16x16x32_bf16 a[52:55], a[152:155], a[136:139], a[52:55]
v_mfma_f32_16x16x32_bf16 a[68:71], a[152:155], a[132:135], a[68:71]
v_mfma_f32_16x16x32_bf16 a[84:87], a[152:155], a[128:131], a[84:87]
v_mfma_f32_16x16x32_bf16 v[132:135], a[152:155], a[124:127], v[132:135]
v_mfma_f32_16x16x32_bf16 v[100:103], a[152:155], a[120:123], v[100:103]
s_waitcnt lgkmcnt(1)
v_mfma_f32_16x16x32_bf16 v[104:107], a[156:159], a[120:123], v[104:107]
v_mfma_f32_16x16x32_bf16 v[136:139], a[156:159], a[124:127], v[136:139]
v_mfma_f32_16x16x32_bf16 v[160:163], a[156:159], a[128:131], v[160:163]
v_mfma_f32_16x16x32_bf16 v[184:187], a[156:159], a[132:135], v[184:187]
v_mfma_f32_16x16x32_bf16 v[200:203], a[156:159], a[136:139], v[200:203]
v_mfma_f32_16x16x32_bf16 v[216:219], a[156:159], a[140:143], v[216:219]
v_mfma_f32_16x16x32_bf16 v[232:235], a[156:159], a[144:147], v[232:235]
v_mfma_f32_16x16x32_bf16 v[248:251], a[156:159], a[148:151], v[248:251]
s_waitcnt vmcnt(8) lgkmcnt(0)
s_barrier
    s_add_u32 s64, s48, 23396352
    s_addc_u32 s65, s49, 0
    s_mov_b32 s66, 65536
    s_lshl_b32 s11, s83, 6
    v_mov_b32 v52, v53
    s_mov_b64 exec, 1
    buffer_store_dwordx2 v[52:53], v23, s[64:67], s11 offen sc0 sc1
    s_mov_b64 exec, -1
s_load_dwordx16 s[16:31], s[0:1], 0
s_load_dwordx16 s[32:47], s[0:1], 64
s_load_dwordx2 s[48:49], s[0:1], 128
v_mfma_f32_16x16x32_bf16 a[8:11], a[160:163], a[148:151], a[8:11]
v_mfma_f32_16x16x32_bf16 a[24:27], a[160:163], a[144:147], a[24:27]
v_mfma_f32_16x16x32_bf16 a[40:43], a[160:163], a[140:143], a[40:43]
v_mfma_f32_16x16x32_bf16 a[56:59], a[160:163], a[136:139], a[56:59]
v_mfma_f32_16x16x32_bf16 a[72:75], a[160:163], a[132:135], a[72:75]
v_mfma_f32_16x16x32_bf16 v[164:167], a[160:163], a[128:131], v[164:167]
v_mfma_f32_16x16x32_bf16 v[140:143], a[160:163], a[124:127], v[140:143]
v_mfma_f32_16x16x32_bf16 v[108:111], a[160:163], a[120:123], v[108:111]
v_mfma_f32_16x16x32_bf16 v[112:115], a[164:167], a[120:123], v[112:115]
v_mfma_f32_16x16x32_bf16 v[144:147], a[164:167], a[124:127], v[144:147]
v_mfma_f32_16x16x32_bf16 v[168:171], a[164:167], a[128:131], v[168:171]
v_mfma_f32_16x16x32_bf16 v[188:191], a[164:167], a[132:135], v[188:191]
v_mfma_f32_16x16x32_bf16 v[204:207], a[164:167], a[136:139], v[204:207]
v_mfma_f32_16x16x32_bf16 v[220:223], a[164:167], a[140:143], v[220:223]
v_mfma_f32_16x16x32_bf16 v[236:239], a[164:167], a[144:147], v[236:239]
v_mfma_f32_16x16x32_bf16 v[252:255], a[164:167], a[148:151], v[252:255]
v_mfma_f32_16x16x32_bf16 a[12:15], a[168:171], a[148:151], a[12:15]
v_mfma_f32_16x16x32_bf16 a[28:31], a[168:171], a[144:147], a[28:31]
v_mfma_f32_16x16x32_bf16 a[44:47], a[168:171], a[140:143], a[44:47]
v_mfma_f32_16x16x32_bf16 a[60:63], a[168:171], a[136:139], a[60:63]
v_mfma_f32_16x16x32_bf16 a[76:79], a[168:171], a[132:135], a[76:79]
v_mfma_f32_16x16x32_bf16 v[172:175], a[168:171], a[128:131], v[172:175]
v_mfma_f32_16x16x32_bf16 v[148:151], a[168:171], a[124:127], v[148:151]
v_mfma_f32_16x16x32_bf16 v[116:119], a[168:171], a[120:123], v[116:119]
s_branch L1A_epi
L1_B:
    v_lshlrev_b32 v73, 11, v64
    s_lshl_b32 s11, s4, 2
    s_add_u32 s11, s11, s5
    s_lshl_b32 s11, s11, 17
    s_lshr_b32 s13, s4, 1
    s_mul_i32 s13, s13, 20
    s_add_u32 s13, s13, s96
    s_lshl_b32 s13, s13, 11
    s_mul_i32 s12, s4, 57344
    s_add_u32 s12, s12, s97
v_mul_u32_u24 v74, 7168, v64
    s_cmp_eq_u32 s3, 0
    s_cselect_b32 s13, s11, s13
    s_cselect_b32 s11, 64, 20
    s_cselect_b32 s100, 2, 1
    s_lshl_b32 s100, s100, 21
    v_add_u32 v73, s13, v73
    v_add_u32 v74, s12, v74
    s_sub_u32 s14, s3, 1
s_cmp_lt_u32 s14, 2
    s_cselect_b32 s100, 7340032, s100
    s_cselect_b32 s11, 8, s11
    s_cselect_b32 s101, 3584, 1
    s_cselect_b64 vcc, -1, 0
    s_lshl_b32 s101, s101, 7
    v_cndmask_b32 v73, v73, v74, vcc
    v_cmp_gt_u32 vcc, s11, v64
    v_mov_b32 v75, 0x80000000
    s_lshl_b32 s11, s2, 1
    v_cndmask_b32 v20, v75, v73, vcc
    s_add_u32 s11, s11, s3
    s_cmp_lt_u32 s3, 2
    s_cselect_b32 s11, s11, s2
    s_lshl_b32 s11, s11, 11
    v_lshlrev_b32 v73, 7, v64
    v_add_u32 v73, s11, v73
    v_cmp_gt_u32 vcc, 16, v64
    s_nop 1
    v_cndmask_b32 v21, v75, v73, vcc
    s_lshl_b32 s11, s4, 2
    s_add_u32 s11, s11, s3
    s_lshl_b32 s11, s11, 17
    s_lshl_b32 s12, s96, 11
    s_mul_i32 s13, s8, 229376
    s_lshl_b32 s90, s3, 12
    s_mul_i32 s91, s3, 5120
    s_add_u32 s91, s91, 98304
    s_add_u32 s90, s90, 65536
    s_add_u32 s13, s13, s97
    s_lshl_b32 s10, s4, 5
    s_add_u32 s10, s10, s9
    s_lshl_b32 s10, s10, 2
    s_add_u32 s10, s10, s3
    s_lshl_b32 s10, s10, 1
    s_lshl_b32 s14, s10, 11
    s_mov_b32 s66, 2048
    s_waitcnt lgkmcnt(0)
    s_mov_b32 s64, s18
    s_mov_b32 s65, s19
    buffer_load_ushort v100, v76, s[64:67], 0 offen
    s_mov_b32 s64, s20
    s_mov_b32 s65, s21
    buffer_load_ushort v101, v76, s[64:67], 0 offen
    s_mov_b32 s64, s30
    s_mov_b32 s65, s31
    buffer_load_ushort v102, v76, s[64:67], 0 offen
    s_cmp_eq_u32 s7, 0
    s_cselect_b32 s56, s36, s38
    s_cselect_b32 s57, s37, s39
    s_cselect_b32 s60, s22, s24
    s_cselect_b32 s61, s23, s25
    s_cmp_eq_u32 s3, 1
    s_cselect_b32 s92, s36, s38
    s_cselect_b32 s93, s37, s39
    s_bitcmp1_b32 s4, 0
    s_cselect_b32 s94, s24, s22
    s_cselect_b32 s95, s25, s23
    s_cmp_eq_u32 s3, 0
    s_cselect_b32 s94, s16, s94
    s_cselect_b32 s95, s17, s95
    s_sub_u32 s98, s3, 1
s_cmp_lt_u32 s98, 2
    s_cselect_b32 s20, s92, s94
    s_cselect_b32 s21, s93, s95
    s_mov_b32 s22, s100
    s_mov_b32 s23, 0x20000
buffer_load_dword v22, v20, s[20:23], 0 offen
v_add_u32 v20, s101, v20
s_add_u32 s56, s56, s13
s_addc_u32 s57, s57, 0
s_sub_u32 s56, s56, 3072
s_subb_u32 s57, s57, 0
s_add_u32 m0, s90, 0
s_nop 0
buffer_load_dwordx4 v4, s[56:59], s76 offen offset:0 lds
buffer_load_dwordx4 v4, s[56:59], s77 offen offset:1024 lds
buffer_load_dwordx4 v4, s[56:59], s78 offen offset:2048 lds
buffer_load_dwordx4 v4, s[56:59], s79 offen offset:3072 lds
s_add_u32 s60, s60, s12
s_addc_u32 s61, s61, 0
s_sub_u32 s60, s60, 3072
s_subb_u32 s61, s61, 0
s_add_u32 m0, s91, 0
s_nop 0
buffer_load_dwordx4 v5, s[60:63], s84 offen offset:0 lds
buffer_load_dwordx4 v5, s[60:63], s85 offen offset:1024 lds
buffer_load_dwordx4 v5, s[60:63], s86 offen offset:2048 lds
buffer_load_dwordx4 v5, s[60:63], s87 offen offset:3072 lds
s_add_u32 m0, s91, 4096
s_nop 0
buffer_load_dwordx4 v5, s[60:63], s88 offen offset:0 lds
s_add_u32 s52, s16, s11
s_addc_u32 s53, s17, 0
s_sub_u32 s52, s52, 3072
s_subb_u32 s53, s53, 0
s_add_u32 m0, s89, 0
s_nop 0
buffer_load_dwordx4 v2, s[52:55], s68 offen offset:0 lds
buffer_load_dwordx4 v3, s[52:55], s69 offen offset:1024 lds
buffer_load_dwordx4 v2, s[52:55], s70 offen offset:2048 lds
buffer_load_dwordx4 v3, s[52:55], s71 offen offset:3072 lds
s_add_u32 m0, s89, 4096
s_nop 0
buffer_load_dwordx4 v2, s[52:55], s72 offen offset:0 lds
buffer_load_dwordx4 v3, s[52:55], s73 offen offset:1024 lds
buffer_load_dwordx4 v2, s[52:55], s74 offen offset:2048 lds
buffer_load_dwordx4 v3, s[52:55], s75 offen offset:3072 lds
buffer_load_dword v22, v20, s[20:23], 0 offen
v_add_u32 v20, s101, v20
    s_add_u32 s64, s48, 23330816
    s_addc_u32 s65, s49, 0
    buffer_load_dword v18, v23, s[64:67], 0 offen sc1
    s_mov_b32 s64, s42
    s_mov_b32 s65, s43
    buffer_load_dwordx4 v[44:47], v1, s[64:67], 0 offen
    buffer_load_dwordx4 v[48:51], v1, s[64:67], 0 offen offset:1024
    s_add_u32 s64, s16, s14
    s_addc_u32 s65, s17, 0
    s_mov_b32 s66, 4096
    buffer_load_dwordx4 v[24:27], v1, s[64:67], 0 offen
    buffer_load_dwordx4 v[28:31], v1, s[64:67], 0 offen offset:1024
    buffer_load_dwordx4 v[32:35], v1, s[64:67], 0 offen offset:2048
    buffer_load_dwordx4 v[36:39], v1, s[64:67], 0 offen offset:3072
buffer_load_dword v22, v20, s[20:23], 0 offen
v_add_u32 v20, s101, v20
    s_cmp_eq_u32 s3, 2
    s_cselect_b32 s92, s26, s28
    s_cselect_b32 s93, s27, s29
    s_cmp_lt_u32 s3, 2
    s_cselect_b32 s24, s40, s92
    s_cselect_b32 s25, s41, s93
    s_cselect_b32 s26, 7, 2
    s_cselect_b32 s29, 2, 1
    s_lshl_b32 s26, s26, 20
    s_lshl_b32 s29, s29, 19
    s_mov_b32 s27, 0x20000
    s_mov_b32 s28, s101
    v_and_b32 v70, 15, v64
    v_lshrrev_b32 v71, 1, v70
    v_xor_b32 v71, v71, v67
    v_lshlrev_b32 v71, 4, v71
    v_lshl_add_u32 v72, v70, 7, v71
    s_lshl_b32 s11, s7, 14
    s_lshl_b32 s12, s8, 13
    s_add_u32 s13, s11, s12
    s_xor_b32 s14, s13, 8192
    v_add_u32 v6, s13, v72
    v_add_u32 v7, s14, v72
    v_xor_b32 v8, 64, v6
    v_xor_b32 v9, 64, v7
    v_bfe_u32 v73, v64, 2, 2
    v_lshrrev_b32 v74, 5, v64
    v_lshlrev_b32 v74, 4, v74
    v_lshl_add_u32 v74, v73, 1, v74
    v_and_b32 v75, 1, v67
    v_add_u32 v74, v74, v75
    v_lshlrev_b32 v74, 7, v74
    v_and_b32 v75, 3, v64
    v_lshl_add_u32 v74, v75, 3, v74
s_lshl_b32 s11, s8, 1
v_xor_b32 v75, s11, v73
v_lshl_add_u32 v75, v75, 5, v74
v_add_u32 v10, 65536, v75
v_xor_b32 v75, s11, v73
v_xor_b32 v75, 1, v75
v_lshl_add_u32 v75, v75, 5, v74
v_add_u32 v11, 65536, v75
    v_lshrrev_b32 v75, 3, v70
    v_mul_u32_u24 v75, 5120, v75
    v_and_b32 v77, 7, v70
    v_lshl_add_u32 v75, v77, 7, v75
    v_add_u32 v75, v75, v71
    v_add_u32 v14, 98304, v75
    v_xor_b32 v15, 64, v14
    s_lshl_b32 s11, s8, 11
    v_add_u32 v16, s11, v14
    v_add_u32 v17, s11, v15
    s_lshl_b32 s92, s10, 3
    s_add_u32 s64, s48, 23068672
    s_addc_u32 s65, s49, 0
    s_mov_b32 s66, 327680
s_cmp_lt_u32 s3, 2
s_cbranch_scc0 L1B_nopar
s_waitcnt vmcnt(26)
v_lshlrev_b32 v100, 16, v100
v_lshlrev_b32 v101, 16, v101
v_lshlrev_b32 v102, 16, v102
s_mov_b32 s94, 0x3fb8aa3b
s_mov_b32 s95, 0x32a57060
v_mul_f32 v104, s94, v102
v_fma_f32 v105, v102, s94, -v104
v_fma_f32 v105, v102, s95, v105
v_exp_f32 v104, v104
v_mul_f32 v105, 0x3f317218, v105
v_fma_f32 v96, v104, v105, v104
v_cvt_pk_bf16_f32 v96, v96, v96
v_and_b32 v96, 0xffff0000, v96
v_mul_f32 v106, v96, v100
v_mul_f32 v107, v96, v101
v_mul_f32 v104, s94, v106
v_fma_f32 v105, v106, s94, -v104
v_fma_f32 v105, v106, s95, v105
v_exp_f32 v104, v104
v_mul_f32 v105, 0x3f317218, v105
v_fma_f32 v106, v104, v105, v104
s_mov_b32 s94, 0x3e22f983
s_mov_b32 s95, 0x31dc9c88
v_mul_f32 v104, s94, v107
v_fma_f32 v105, v107, s94, -v104
v_fma_f32 v105, v107, s95, v105
v_rndne_f32 v108, v104
v_sub_f32 v104, v104, v108
v_add_f32 v104, v104, v105
v_cos_f32 v108, v104
v_sin_f32 v109, v104
v_mul_f32 v105, v100, v100
v_mul_f32 v88, v106, v108
v_mul_f32 v89, v106, v109
v_fma_f32 v105, v101, v101, v105
v_add_f32 v104, -1.0, v88
v_rcp_f32 v108, v105
v_mul_f32 v90, v104, v100
v_fma_f32 v109, -v105, v108, 1.0
v_fma_f32 v108, v108, v109, v108
v_fma_f32 v90, v89, v101, v90
v_mul_f32 v91, v89, v100
v_fma_f32 v91, -v104, v101, v91
v_mul_f32 v90, v90, v108
v_mul_f32 v91, v91, v108
v_mul_f32 v104, v89, v89
v_mul_f32 v93, v88, v89
v_fma_f32 v92, v88, v88, -v104
v_add_f32 v93, v93, v93
v_mul_f32 v104, v93, v93
v_mul_f32 v93, v92, v93
v_fma_f32 v92, v92, v92, -v104
v_add_f32 v93, v93, v93
v_mul_f32 v104, v93, v93
v_mul_f32 v93, v92, v93
v_fma_f32 v92, v92, v92, -v104
v_add_f32 v93, v93, v93
v_mul_f32 v104, v93, v93
v_mul_f32 v93, v92, v93
v_fma_f32 v92, v92, v92, -v104
v_add_f32 v93, v93, v93
v_mul_f32 v104, v93, v93
v_mul_f32 v95, v92, v93
v_fma_f32 v94, v92, v92, -v104
v_add_f32 v95, v95, v95
v_mul_f32 v104, v95, v95
v_mul_f32 v95, v94, v95
v_fma_f32 v94, v94, v94, -v104
v_add_f32 v95, v95, v95
v_mul_f32 v104, v95, v95
v_mul_f32 v95, v94, v95
v_fma_f32 v94, v94, v94, -v104
v_add_f32 v95, v95, v95
v_mul_f32 v104, v95, v95
v_mul_f32 v95, v94, v95
v_fma_f32 v94, v94, v94, -v104
v_add_f32 v95, v95, v95
v_cmp_gt_u32 vcc, 80, v0
v_mov_b32 v96, 0x8000
s_nop 0
v_cndmask_b32 v96, v96, v0, vcc
v_lshlrev_b32 v104, 5, v96
v_add_u32 v104, 139264, v104
ds_write_b128 v104, v[88:91]
ds_write_b128 v104, v[92:95] offset:16
L1B_nopar:
s_waitcnt vmcnt(9) lgkmcnt(0)
s_barrier
ds_read_b128 a[152:155], v14 offset:4096
ds_read_b128 a[156:159], v14 offset:14336
ds_read_b128 a[88:91], v6 offset:0
ds_read_b128 a[92:95], v6 offset:2048
ds_read_b128 a[96:99], v6 offset:4096
ds_read_b128 a[100:103], v6 offset:6144
s_waitcnt lgkmcnt(3)
v_mfma_f32_16x16x32_bf16 v[56:59], a[88:91], a[152:155], 0
ds_read_b64_tr_b16 a[160:161], v10 offset:0
ds_read_b64_tr_b16 a[162:163], v10 offset:1024
s_waitcnt lgkmcnt(4)
v_mfma_f32_16x16x32_bf16 v[64:67], a[92:95], a[152:155], 0
ds_read_b128 a[104:107], v7 offset:0
ds_read_b128 a[108:111], v7 offset:2048
s_waitcnt lgkmcnt(5)
v_mfma_f32_16x16x32_bf16 v[72:75], a[96:99], a[152:155], 0
ds_read_b128 a[112:115], v7 offset:4096
ds_read_b128 a[116:119], v7 offset:6144
s_waitcnt lgkmcnt(6)
v_mfma_f32_16x16x32_bf16 v[80:83], a[100:103], a[152:155], 0
ds_read_b64_tr_b16 a[164:165], v10 offset:8192
v_mfma_f32_16x16x32_bf16 v[84:87], a[100:103], a[156:159], 0
ds_read_b64_tr_b16 a[166:167], v10 offset:9216
s_add_u32 m0, s89, 32768
v_mfma_f32_16x16x32_bf16 v[76:79], a[96:99], a[156:159], 0
s_add_u32 s52, s52, 128
s_addc_u32 s53, s53, 0
v_mfma_f32_16x16x32_bf16 v[68:71], a[92:95], a[156:159], 0
s_add_u32 s56, s56, 458752
s_addc_u32 s57, s57, 0
v_mfma_f32_16x16x32_bf16 v[60:63], a[88:91], a[156:159], 0
ds_read_b64_tr_b16 a[168:169], v11 offset:0
s_waitcnt lgkmcnt(7)
v_mfma_f32_16x16x32_bf16 v[216:219], a[160:163], a[88:91], 0
s_add_u32 s60, s60, 128
s_addc_u32 s61, s61, 0
v_mfma_f32_16x16x32_bf16 v[224:227], a[160:163], a[92:95], 0
ds_read_b64_tr_b16 a[170:171], v11 offset:1024
ds_read_b64_tr_b16 a[152:153], v11 offset:8192
v_mfma_f32_16x16x32_bf16 v[232:235], a[160:163], a[96:99], 0
ds_read_b64_tr_b16 a[154:155], v11 offset:9216
ds_read_b128 a[156:159], v16 offset:0
v_mfma_f32_16x16x32_bf16 v[240:243], a[160:163], a[100:103], 0
s_waitcnt lgkmcnt(6)
v_mfma_f32_16x16x32_bf16 v[248:251], a[160:163], a[104:107], 0
buffer_load_dwordx4 v2, s[52:55], s68 offen offset:0 lds
v_mfma_f32_16x16x32_bf16 a[80:83], a[160:163], a[108:111], 0
v_mfma_f32_16x16x32_bf16 a[72:75], a[160:163], a[112:115], 0
v_mfma_f32_16x16x32_bf16 a[64:67], a[160:163], a[116:119], 0
ds_read_b128 a[160:163], v16 offset:10240
s_waitcnt lgkmcnt(5)
v_mfma_f32_16x16x32_bf16 a[0:3], a[164:167], a[116:119], 0
buffer_load_dwordx4 v3, s[52:55], s69 offen offset:1024 lds
v_mfma_f32_16x16x32_bf16 a[8:11], a[164:167], a[112:115], 0
v_mfma_f32_16x16x32_bf16 a[16:19], a[164:167], a[108:111], 0
v_mfma_f32_16x16x32_bf16 a[24:27], a[164:167], a[104:107], 0
v_mfma_f32_16x16x32_bf16 a[32:35], a[164:167], a[100:103], 0
buffer_load_dwordx4 v2, s[52:55], s70 offen offset:2048 lds
v_mfma_f32_16x16x32_bf16 a[40:43], a[164:167], a[96:99], 0
v_mfma_f32_16x16x32_bf16 a[48:51], a[164:167], a[92:95], 0
v_mfma_f32_16x16x32_bf16 a[56:59], a[164:167], a[88:91], 0
ds_read_b128 a[164:167], v16 offset:1024
s_waitcnt lgkmcnt(1)
v_mfma_f32_16x16x32_bf16 v[220:223], a[168:171], a[88:91], 0
buffer_load_dwordx4 v3, s[52:55], s71 offen offset:3072 lds
v_mfma_f32_16x16x32_bf16 v[228:231], a[168:171], a[92:95], 0
s_add_u32 m0, s89, 36864
v_mfma_f32_16x16x32_bf16 v[236:239], a[168:171], a[96:99], 0
v_mfma_f32_16x16x32_bf16 v[244:247], a[168:171], a[100:103], 0
v_mfma_f32_16x16x32_bf16 v[252:255], a[168:171], a[104:107], 0
buffer_load_dwordx4 v2, s[52:55], s72 offen offset:0 lds
v_mfma_f32_16x16x32_bf16 a[84:87], a[168:171], a[108:111], 0
v_mfma_f32_16x16x32_bf16 a[76:79], a[168:171], a[112:115], 0
v_mfma_f32_16x16x32_bf16 a[68:71], a[168:171], a[116:119], 0
ds_read_b128 a[168:171], v16 offset:11264
v_mfma_f32_16x16x32_bf16 a[4:7], a[152:155], a[116:119], 0
buffer_load_dwordx4 v3, s[52:55], s73 offen offset:1024 lds
v_mfma_f32_16x16x32_bf16 a[12:15], a[152:155], a[112:115], 0
v_mfma_f32_16x16x32_bf16 a[20:23], a[152:155], a[108:111], 0
v_mfma_f32_16x16x32_bf16 a[28:31], a[152:155], a[104:107], 0
v_mfma_f32_16x16x32_bf16 a[36:39], a[152:155], a[100:103], 0
buffer_load_dwordx4 v2, s[52:55], s74 offen offset:2048 lds
v_mfma_f32_16x16x32_bf16 a[44:47], a[152:155], a[96:99], 0
v_mfma_f32_16x16x32_bf16 a[52:55], a[152:155], a[92:95], 0
v_mfma_f32_16x16x32_bf16 a[60:63], a[152:155], a[88:91], 0
ds_read_b128 a[152:155], v15 offset:4096
v_mfma_f32_16x16x32_bf16 v[88:91], a[88:91], a[156:159], 0
buffer_load_dwordx4 v3, s[52:55], s75 offen offset:3072 lds
v_mfma_f32_16x16x32_bf16 v[96:99], a[92:95], a[156:159], 0
s_add_u32 m0, s90, 16384
ds_read_b128 a[120:123], v8 offset:0
v_mfma_f32_16x16x32_bf16 v[104:107], a[96:99], a[156:159], 0
ds_read_b128 a[124:127], v8 offset:2048
ds_read_b128 a[128:131], v8 offset:4096
v_mfma_f32_16x16x32_bf16 v[112:115], a[100:103], a[156:159], 0
ds_read_b128 a[132:135], v8 offset:6144
v_mfma_f32_16x16x32_bf16 v[120:123], a[104:107], a[156:159], 0
buffer_load_dwordx4 v4, s[56:59], s76 offen offset:0 lds
v_mfma_f32_16x16x32_bf16 v[128:131], a[108:111], a[156:159], 0
v_mfma_f32_16x16x32_bf16 v[136:139], a[112:115], a[156:159], 0
v_mfma_f32_16x16x32_bf16 v[144:147], a[116:119], a[156:159], 0
ds_read_b128 a[156:159], v15 offset:14336
v_mfma_f32_16x16x32_bf16 v[148:151], a[116:119], a[160:163], 0
buffer_load_dwordx4 v4, s[56:59], s77 offen offset:1024 lds
v_mfma_f32_16x16x32_bf16 v[140:143], a[112:115], a[160:163], 0
v_mfma_f32_16x16x32_bf16 v[132:135], a[108:111], a[160:163], 0
v_mfma_f32_16x16x32_bf16 v[124:127], a[104:107], a[160:163], 0
v_mfma_f32_16x16x32_bf16 v[116:119], a[100:103], a[160:163], 0
buffer_load_dwordx4 v4, s[56:59], s78 offen offset:2048 lds
v_mfma_f32_16x16x32_bf16 v[108:111], a[96:99], a[160:163], 0
v_mfma_f32_16x16x32_bf16 v[100:103], a[92:95], a[160:163], 0
v_mfma_f32_16x16x32_bf16 v[92:95], a[88:91], a[160:163], 0
ds_read_b64_tr_b16 a[160:161], v10 offset:4096
s_waitcnt lgkmcnt(1)
v_mfma_f32_16x16x32_bf16 v[152:155], a[88:91], a[164:167], 0
buffer_load_dwordx4 v4, s[56:59], s79 offen offset:3072 lds
v_mfma_f32_16x16x32_bf16 v[160:163], a[92:95], a[164:167], 0
s_add_u32 m0, s91, 20480
ds_read_b64_tr_b16 a[162:163], v10 offset:5120
v_mfma_f32_16x16x32_bf16 v[168:171], a[96:99], a[164:167], 0
ds_read_b128 a[136:139], v9 offset:0
ds_read_b128 a[140:143], v9 offset:2048
v_mfma_f32_16x16x32_bf16 v[176:179], a[100:103], a[164:167], 0
ds_read_b128 a[144:147], v9 offset:4096
ds_read_b128 a[148:151], v9 offset:6144
v_mfma_f32_16x16x32_bf16 v[184:187], a[104:107], a[164:167], 0
buffer_load_dwordx4 v5, s[60:63], s84 offen offset:0 lds
v_mfma_f32_16x16x32_bf16 v[192:195], a[108:111], a[164:167], 0
v_mfma_f32_16x16x32_bf16 v[200:203], a[112:115], a[164:167], 0
v_mfma_f32_16x16x32_bf16 v[208:211], a[116:119], a[164:167], 0
ds_read_b64_tr_b16 a[164:165], v10 offset:12288
v_mfma_f32_16x16x32_bf16 v[212:215], a[116:119], a[168:171], 0
buffer_load_dwordx4 v5, s[60:63], s85 offen offset:1024 lds
v_mfma_f32_16x16x32_bf16 v[204:207], a[112:115], a[168:171], 0
ds_read_b64_tr_b16 a[166:167], v10 offset:13312
v_mfma_f32_16x16x32_bf16 v[196:199], a[108:111], a[168:171], 0
v_mfma_f32_16x16x32_bf16 v[188:191], a[104:107], a[168:171], 0
v_mfma_f32_16x16x32_bf16 v[180:183], a[100:103], a[168:171], 0
buffer_load_dwordx4 v5, s[60:63], s86 offen offset:2048 lds
v_mfma_f32_16x16x32_bf16 v[172:175], a[96:99], a[168:171], 0
v_mfma_f32_16x16x32_bf16 v[164:167], a[92:95], a[168:171], 0
v_mfma_f32_16x16x32_bf16 v[156:159], a[88:91], a[168:171], 0
ds_read_b64_tr_b16 a[168:169], v11 offset:4096
v_mfma_f32_16x16x32_bf16 v[56:59], a[120:123], a[152:155], v[56:59]
buffer_load_dwordx4 v5, s[60:63], s87 offen offset:3072 lds
v_mfma_f32_16x16x32_bf16 v[64:67], a[124:127], a[152:155], v[64:67]
s_waitcnt vmcnt(17)
s_add_u32 m0, s91, 24576
v_mfma_f32_16x16x32_bf16 v[72:75], a[128:131], a[152:155], v[72:75]
ds_read_b64_tr_b16 a[170:171], v11 offset:5120
v_readfirstlane_b32 s98, v18
v_mfma_f32_16x16x32_bf16 v[80:83], a[132:135], a[152:155], v[80:83]
ds_read_b64_tr_b16 a[152:153], v11 offset:12288
v_mfma_f32_16x16x32_bf16 v[84:87], a[132:135], a[156:159], v[84:87]
buffer_load_dwordx4 v5, s[60:63], s88 offen offset:0 lds
v_mfma_f32_16x16x32_bf16 v[76:79], a[128:131], a[156:159], v[76:79]
ds_read_b64_tr_b16 a[154:155], v11 offset:13312
v_dot2_f32_bf16 v52, v24, v44, 0
v_mfma_f32_16x16x32_bf16 v[68:71], a[124:127], a[156:159], v[68:71]
v_dot2_f32_bf16 v53, v32, v44, 0
v_dot2_f32_bf16 v52, v25, v45, v52
v_mfma_f32_16x16x32_bf16 v[60:63], a[120:123], a[156:159], v[60:63]
buffer_load_dword v22, v20, s[20:23], 0 offen
s_waitcnt lgkmcnt(3)
v_mfma_f32_16x16x32_bf16 v[216:219], a[160:163], a[120:123], v[216:219]
v_add_u32 v20, s28, v20
ds_read_b128 a[156:159], v17 offset:0
v_mfma_f32_16x16x32_bf16 v[224:227], a[160:163], a[124:127], v[224:227]
v_dot2_f32_bf16 v53, v33, v45, v53
v_dot2_f32_bf16 v52, v26, v46, v52
v_mfma_f32_16x16x32_bf16 v[232:235], a[160:163], a[128:131], v[232:235]
buffer_load_dword v22, v21, s[24:27], 0 offen
v_mfma_f32_16x16x32_bf16 v[240:243], a[160:163], a[132:135], v[240:243]
v_add_u32 v21, s29, v21
v_dot2_f32_bf16 v53, v34, v46, v53
v_mfma_f32_16x16x32_bf16 v[248:251], a[160:163], a[136:139], v[248:251]
v_dot2_f32_bf16 v52, v27, v47, v52
v_dot2_f32_bf16 v53, v35, v47, v53
v_mfma_f32_16x16x32_bf16 a[80:83], a[160:163], a[140:143], a[80:83]
v_dot2_f32_bf16 v52, v28, v48, v52
v_dot2_f32_bf16 v53, v36, v48, v53
v_mfma_f32_16x16x32_bf16 a[72:75], a[160:163], a[144:147], a[72:75]
v_dot2_f32_bf16 v52, v29, v49, v52
v_dot2_f32_bf16 v53, v37, v49, v53
v_mfma_f32_16x16x32_bf16 a[64:67], a[160:163], a[148:151], a[64:67]
ds_read_b128 a[160:163], v17 offset:10240
v_mfma_f32_16x16x32_bf16 a[0:3], a[164:167], a[148:151], a[0:3]
v_dot2_f32_bf16 v52, v30, v50, v52
v_dot2_f32_bf16 v53, v38, v50, v53
v_mfma_f32_16x16x32_bf16 a[8:11], a[164:167], a[144:147], a[8:11]
v_dot2_f32_bf16 v52, v31, v51, v52
v_dot2_f32_bf16 v53, v39, v51, v53
v_mfma_f32_16x16x32_bf16 a[16:19], a[164:167], a[140:143], a[16:19]
s_nop 2
v_add_f32_dpp v52, v52, v52 row_shr:1 row_mask:0xf bank_mask:0xf bound_ctrl:1
v_mfma_f32_16x16x32_bf16 a[24:27], a[164:167], a[136:139], a[24:27]
v_add_f32_dpp v53, v53, v53 row_shr:1 row_mask:0xf bank_mask:0xf bound_ctrl:1
s_nop 0
v_mfma_f32_16x16x32_bf16 a[32:35], a[164:167], a[132:135], a[32:35]
v_add_f32_dpp v52, v52, v52 row_shr:2 row_mask:0xf bank_mask:0xf bound_ctrl:1
v_add_f32_dpp v53, v53, v53 row_shr:2 row_mask:0xf bank_mask:0xf bound_ctrl:1
v_mfma_f32_16x16x32_bf16 a[40:43], a[164:167], a[128:131], a[40:43]
s_nop 0
v_add_f32_dpp v52, v52, v52 row_shr:4 row_mask:0xf bank_mask:0xf bound_ctrl:1
v_mfma_f32_16x16x32_bf16 a[48:51], a[164:167], a[124:127], a[48:51]
v_add_f32_dpp v53, v53, v53 row_shr:4 row_mask:0xf bank_mask:0xf bound_ctrl:1
s_nop 0
v_mfma_f32_16x16x32_bf16 a[56:59], a[164:167], a[120:123], a[56:59]
ds_read_b128 a[164:167], v17 offset:1024
s_waitcnt lgkmcnt(1)
v_mfma_f32_16x16x32_bf16 v[220:223], a[168:171], a[120:123], v[220:223]
v_add_f32_dpp v52, v52, v52 row_shr:8 row_mask:0xf bank_mask:0xf bound_ctrl:1
v_add_f32_dpp v53, v53, v53 row_shr:8 row_mask:0xf bank_mask:0xf bound_ctrl:1
v_mfma_f32_16x16x32_bf16 v[228:231], a[168:171], a[124:127], v[228:231]
s_nop 0
v_add_f32_dpp v52, v52, v52 row_bcast:15 row_mask:0xa bank_mask:0xf
v_mfma_f32_16x16x32_bf16 v[236:239], a[168:171], a[128:131], v[236:239]
v_add_f32_dpp v53, v53, v53 row_bcast:15 row_mask:0xa bank_mask:0xf
s_nop 0
v_mfma_f32_16x16x32_bf16 v[244:247], a[168:171], a[132:135], v[244:247]
v_add_f32_dpp v52, v52, v52 row_bcast:31 row_mask:0xc bank_mask:0xf
v_add_f32_dpp v53, v53, v53 row_bcast:31 row_mask:0xc bank_mask:0xf
v_mfma_f32_16x16x32_bf16 v[252:255], a[168:171], a[136:139], v[252:255]
s_nop 0
v_readlane_b32 s94, v52, 63
v_mfma_f32_16x16x32_bf16 a[84:87], a[168:171], a[140:143], a[84:87]
v_readlane_b32 s95, v53, 63
s_nop 1
v_mfma_f32_16x16x32_bf16 a[76:79], a[168:171], a[144:147], a[76:79]
v_mov_b32 v52, s94
v_writelane_b32 v52, s95, 1
v_mfma_f32_16x16x32_bf16 a[68:71], a[168:171], a[148:151], a[68:71]
ds_read_b128 a[168:171], v17 offset:11264
v_mfma_f32_16x16x32_bf16 a[4:7], a[152:155], a[148:151], a[4:7]
v_cvt_pk_bf16_f32 v52, v52, v52
v_and_b32 v52, 0xffff0000, v52
v_mfma_f32_16x16x32_bf16 a[12:15], a[152:155], a[144:147], a[12:15]
v_sub_f32 v24, 0, v52
v_min_f32 v24, 0x42b00000, v24
v_mfma_f32_16x16x32_bf16 a[20:23], a[152:155], a[140:143], a[20:23]
v_max_f32 v24, 0xc2f00000, v24
s_mov_b32 s94, 0x3fb8aa3b
v_mfma_f32_16x16x32_bf16 a[28:31], a[152:155], a[136:139], a[28:31]
s_mov_b32 s95, 0x32a57060
v_mul_f32 v25, s94, v24
v_mfma_f32_16x16x32_bf16 a[36:39], a[152:155], a[132:135], a[36:39]
v_fma_f32 v26, v24, s94, -v25
v_fma_f32 v26, v24, s95, v26
v_mfma_f32_16x16x32_bf16 a[44:47], a[152:155], a[128:131], a[44:47]
v_exp_f32 v25, v25
v_mfma_f32_16x16x32_bf16 a[52:55], a[152:155], a[124:127], a[52:55]
v_mul_f32 v26, 0x3f317218, v26
v_fma_f32 v24, v25, v26, v25
v_mfma_f32_16x16x32_bf16 a[60:63], a[152:155], a[120:123], a[60:63]
v_add_f32 v24, 1.0, v24
v_mfma_f32_16x16x32_bf16 v[88:91], a[120:123], a[156:159], v[88:91]
v_rcp_f32 v25, v24
v_mfma_f32_16x16x32_bf16 v[96:99], a[124:127], a[156:159], v[96:99]
s_nop 0
v_fma_f32 v26, -v24, v25, 1.0
v_mfma_f32_16x16x32_bf16 v[104:107], a[128:131], a[156:159], v[104:107]
v_fma_f32 v25, v25, v26, v25
v_cvt_pk_bf16_f32 v52, v25, v25
v_mfma_f32_16x16x32_bf16 v[112:115], a[132:135], a[156:159], v[112:115]
v_and_b32 v52, 0xffff0000, v52
s_add_u32 s98, s98, 1
v_mfma_f32_16x16x32_bf16 v[120:123], a[136:139], a[156:159], v[120:123]
v_mov_b32 v53, s98
v_lshrrev_b32 v39, 1, v1
v_mfma_f32_16x16x32_bf16 v[128:131], a[140:143], a[156:159], v[128:131]
s_mov_b64 exec, 3
buffer_store_dwordx2 v[52:53], v39, s[64:67], s92 offen sc0 sc1
s_mov_b64 exec, -1
s_nop 1
v_mfma_f32_16x16x32_bf16 v[136:139], a[144:147], a[156:159], v[136:139]
v_mfma_f32_16x16x32_bf16 v[144:147], a[148:151], a[156:159], v[144:147]
s_waitcnt vmcnt(3) lgkmcnt(0)
s_barrier
s_mov_b32 s10, 7
.p2align 3
L1B_loop:
s_add_u32 s52, s52, 128
s_addc_u32 s53, s53, 0
v_mfma_f32_16x16x32_bf16 v[148:151], a[148:151], a[160:163], v[148:151]
s_add_u32 s56, s56, 458752
s_addc_u32 s57, s57, 0
v_mfma_f32_16x16x32_bf16 v[140:143], a[144:147], a[160:163], v[140:143]
s_add_u32 s60, s60, 128
s_addc_u32 s61, s61, 0
v_mfma_f32_16x16x32_bf16 v[132:135], a[140:143], a[160:163], v[132:135]
s_add_u32 m0, s89, 0
ds_read_b128 a[152:155], v14 offset:24576
v_mfma_f32_16x16x32_bf16 v[124:127], a[136:139], a[160:163], v[124:127]
ds_read_b128 a[88:91], v6 offset:32768
ds_read_b128 a[92:95], v6 offset:34816
v_mfma_f32_16x16x32_bf16 v[116:119], a[132:135], a[160:163], v[116:119]
ds_read_b128 a[96:99], v6 offset:36864
ds_read_b128 a[100:103], v6 offset:38912
v_mfma_f32_16x16x32_bf16 v[108:111], a[128:131], a[160:163], v[108:111]
ds_read_b128 a[156:159], v14 offset:34816
v_mfma_f32_16x16x32_bf16 v[100:103], a[124:127], a[160:163], v[100:103]
v_mfma_f32_16x16x32_bf16 v[92:95], a[120:123], a[160:163], v[92:95]
ds_read_b64_tr_b16 a[160:161], v10 offset:16384
ds_read_b64_tr_b16 a[162:163], v10 offset:17408
v_mfma_f32_16x16x32_bf16 v[152:155], a[120:123], a[164:167], v[152:155]
ds_read_b128 a[104:107], v7 offset:32768
ds_read_b128 a[108:111], v7 offset:34816
v_mfma_f32_16x16x32_bf16 v[160:163], a[124:127], a[164:167], v[160:163]
ds_read_b128 a[112:115], v7 offset:36864
ds_read_b128 a[116:119], v7 offset:38912
v_mfma_f32_16x16x32_bf16 v[168:171], a[128:131], a[164:167], v[168:171]
v_mfma_f32_16x16x32_bf16 v[176:179], a[132:135], a[164:167], v[176:179]
v_mfma_f32_16x16x32_bf16 v[184:187], a[136:139], a[164:167], v[184:187]
buffer_load_dwordx4 v2, s[52:55], s68 offen offset:0 lds
v_mfma_f32_16x16x32_bf16 v[192:195], a[140:143], a[164:167], v[192:195]
v_mfma_f32_16x16x32_bf16 v[200:203], a[144:147], a[164:167], v[200:203]
v_mfma_f32_16x16x32_bf16 v[208:211], a[148:151], a[164:167], v[208:211]
ds_read_b64_tr_b16 a[164:165], v10 offset:24576
ds_read_b64_tr_b16 a[166:167], v10 offset:25600
v_mfma_f32_16x16x32_bf16 v[212:215], a[148:151], a[168:171], v[212:215]
buffer_load_dwordx4 v3, s[52:55], s69 offen offset:1024 lds
v_mfma_f32_16x16x32_bf16 v[204:207], a[144:147], a[168:171], v[204:207]
v_mfma_f32_16x16x32_bf16 v[196:199], a[140:143], a[168:171], v[196:199]
v_mfma_f32_16x16x32_bf16 v[188:191], a[136:139], a[168:171], v[188:191]
v_mfma_f32_16x16x32_bf16 v[180:183], a[132:135], a[168:171], v[180:183]
buffer_load_dwordx4 v2, s[52:55], s70 offen offset:2048 lds
v_mfma_f32_16x16x32_bf16 v[172:175], a[128:131], a[168:171], v[172:175]
v_mfma_f32_16x16x32_bf16 v[164:167], a[124:127], a[168:171], v[164:167]
v_mfma_f32_16x16x32_bf16 v[156:159], a[120:123], a[168:171], v[156:159]
ds_read_b64_tr_b16 a[168:169], v11 offset:16384
s_waitcnt lgkmcnt(1)
v_mfma_f32_16x16x32_bf16 v[56:59], a[88:91], a[152:155], v[56:59]
buffer_load_dwordx4 v3, s[52:55], s71 offen offset:3072 lds
v_mfma_f32_16x16x32_bf16 v[64:67], a[92:95], a[152:155], v[64:67]
s_add_u32 m0, s89, 4096
ds_read_b64_tr_b16 a[170:171], v11 offset:17408
v_mfma_f32_16x16x32_bf16 v[72:75], a[96:99], a[152:155], v[72:75]
v_mfma_f32_16x16x32_bf16 v[80:83], a[100:103], a[152:155], v[80:83]
ds_read_b64_tr_b16 a[152:153], v11 offset:24576
v_mfma_f32_16x16x32_bf16 v[84:87], a[100:103], a[156:159], v[84:87]
buffer_load_dwordx4 v2, s[52:55], s72 offen offset:0 lds
v_mfma_f32_16x16x32_bf16 v[76:79], a[96:99], a[156:159], v[76:79]
ds_read_b64_tr_b16 a[154:155], v11 offset:25600
v_mfma_f32_16x16x32_bf16 v[68:71], a[92:95], a[156:159], v[68:71]
v_mfma_f32_16x16x32_bf16 v[60:63], a[88:91], a[156:159], v[60:63]
ds_read_b128 a[156:159], v16 offset:20480
v_mfma_f32_16x16x32_bf16 v[216:219], a[160:163], a[88:91], v[216:219]
buffer_load_dwordx4 v3, s[52:55], s73 offen offset:1024 lds
v_mfma_f32_16x16x32_bf16 v[224:227], a[160:163], a[92:95], v[224:227]
v_mfma_f32_16x16x32_bf16 v[232:235], a[160:163], a[96:99], v[232:235]
v_mfma_f32_16x16x32_bf16 v[240:243], a[160:163], a[100:103], v[240:243]
v_mfma_f32_16x16x32_bf16 v[248:251], a[160:163], a[104:107], v[248:251]
buffer_load_dwordx4 v2, s[52:55], s74 offen offset:2048 lds
v_mfma_f32_16x16x32_bf16 a[80:83], a[160:163], a[108:111], a[80:83]
v_mfma_f32_16x16x32_bf16 a[72:75], a[160:163], a[112:115], a[72:75]
v_mfma_f32_16x16x32_bf16 a[64:67], a[160:163], a[116:119], a[64:67]
ds_read_b128 a[160:163], v16 offset:30720
v_mfma_f32_16x16x32_bf16 a[0:3], a[164:167], a[116:119], a[0:3]
buffer_load_dwordx4 v3, s[52:55], s75 offen offset:3072 lds
v_mfma_f32_16x16x32_bf16 a[8:11], a[164:167], a[112:115], a[8:11]
s_add_u32 m0, s90, 0
v_mfma_f32_16x16x32_bf16 a[16:19], a[164:167], a[108:111], a[16:19]
v_mfma_f32_16x16x32_bf16 a[24:27], a[164:167], a[104:107], a[24:27]
v_mfma_f32_16x16x32_bf16 a[32:35], a[164:167], a[100:103], a[32:35]
buffer_load_dwordx4 v4, s[56:59], s76 offen offset:0 lds
v_mfma_f32_16x16x32_bf16 a[40:43], a[164:167], a[96:99], a[40:43]
v_mfma_f32_16x16x32_bf16 a[48:51], a[164:167], a[92:95], a[48:51]
v_mfma_f32_16x16x32_bf16 a[56:59], a[164:167], a[88:91], a[56:59]
ds_read_b128 a[164:167], v16 offset:21504
s_waitcnt lgkmcnt(1)
v_mfma_f32_16x16x32_bf16 v[220:223], a[168:171], a[88:91], v[220:223]
buffer_load_dwordx4 v4, s[56:59], s77 offen offset:1024 lds
v_mfma_f32_16x16x32_bf16 v[228:231], a[168:171], a[92:95], v[228:231]
v_mfma_f32_16x16x32_bf16 v[236:239], a[168:171], a[96:99], v[236:239]
v_mfma_f32_16x16x32_bf16 v[244:247], a[168:171], a[100:103], v[244:247]
v_mfma_f32_16x16x32_bf16 v[252:255], a[168:171], a[104:107], v[252:255]
buffer_load_dwordx4 v4, s[56:59], s78 offen offset:2048 lds
v_mfma_f32_16x16x32_bf16 a[84:87], a[168:171], a[108:111], a[84:87]
v_mfma_f32_16x16x32_bf16 a[76:79], a[168:171], a[112:115], a[76:79]
v_mfma_f32_16x16x32_bf16 a[68:71], a[168:171], a[116:119], a[68:71]
ds_read_b128 a[168:171], v16 offset:31744
v_mfma_f32_16x16x32_bf16 a[4:7], a[152:155], a[116:119], a[4:7]
buffer_load_dwordx4 v4, s[56:59], s79 offen offset:3072 lds
v_mfma_f32_16x16x32_bf16 a[12:15], a[152:155], a[112:115], a[12:15]
s_add_u32 m0, s91, 0
v_mfma_f32_16x16x32_bf16 a[20:23], a[152:155], a[108:111], a[20:23]
v_mfma_f32_16x16x32_bf16 a[28:31], a[152:155], a[104:107], a[28:31]
v_mfma_f32_16x16x32_bf16 a[36:39], a[152:155], a[100:103], a[36:39]
buffer_load_dwordx4 v5, s[60:63], s84 offen offset:0 lds
v_mfma_f32_16x16x32_bf16 a[44:47], a[152:155], a[96:99], a[44:47]
v_mfma_f32_16x16x32_bf16 a[52:55], a[152:155], a[92:95], a[52:55]
v_mfma_f32_16x16x32_bf16 a[60:63], a[152:155], a[88:91], a[60:63]
ds_read_b128 a[152:155], v15 offset:24576
v_mfma_f32_16x16x32_bf16 v[88:91], a[88:91], a[156:159], v[88:91]
buffer_load_dwordx4 v5, s[60:63], s85 offen offset:1024 lds
v_mfma_f32_16x16x32_bf16 v[96:99], a[92:95], a[156:159], v[96:99]
ds_read_b128 a[120:123], v8 offset:32768
ds_read_b128 a[124:127], v8 offset:34816
v_mfma_f32_16x16x32_bf16 v[104:107], a[96:99], a[156:159], v[104:107]
ds_read_b128 a[128:131], v8 offset:36864
ds_read_b128 a[132:135], v8 offset:38912
v_mfma_f32_16x16x32_bf16 v[112:115], a[100:103], a[156:159], v[112:115]
v_mfma_f32_16x16x32_bf16 v[120:123], a[104:107], a[156:159], v[120:123]
buffer_load_dwordx4 v5, s[60:63], s86 offen offset:2048 lds
v_mfma_f32_16x16x32_bf16 v[128:131], a[108:111], a[156:159], v[128:131]
v_mfma_f32_16x16x32_bf16 v[136:139], a[112:115], a[156:159], v[136:139]
v_mfma_f32_16x16x32_bf16 v[144:147], a[116:119], a[156:159], v[144:147]
ds_read_b128 a[156:159], v15 offset:34816
v_mfma_f32_16x16x32_bf16 v[148:151], a[116:119], a[160:163], v[148:151]
buffer_load_dwordx4 v5, s[60:63], s87 offen offset:3072 lds
v_mfma_f32_16x16x32_bf16 v[140:143], a[112:115], a[160:163], v[140:143]
s_add_u32 m0, s91, 4096
v_mfma_f32_16x16x32_bf16 v[132:135], a[108:111], a[160:163], v[132:135]
v_mfma_f32_16x16x32_bf16 v[124:127], a[104:107], a[160:163], v[124:127]
v_mfma_f32_16x16x32_bf16 v[116:119], a[100:103], a[160:163], v[116:119]
buffer_load_dwordx4 v5, s[60:63], s88 offen offset:0 lds
v_mfma_f32_16x16x32_bf16 v[108:111], a[96:99], a[160:163], v[108:111]
v_mfma_f32_16x16x32_bf16 v[100:103], a[92:95], a[160:163], v[100:103]
v_mfma_f32_16x16x32_bf16 v[92:95], a[88:91], a[160:163], v[92:95]
buffer_load_dword v22, v20, s[20:23], 0 offen
s_waitcnt lgkmcnt(0)
v_mfma_f32_16x16x32_bf16 v[152:155], a[88:91], a[164:167], v[152:155]
v_add_u32 v20, s28, v20
ds_read_b64_tr_b16 a[160:161], v10 offset:20480
v_mfma_f32_16x16x32_bf16 v[160:163], a[92:95], a[164:167], v[160:163]
ds_read_b64_tr_b16 a[162:163], v10 offset:21504
ds_read_b128 a[136:139], v9 offset:32768
v_mfma_f32_16x16x32_bf16 v[168:171], a[96:99], a[164:167], v[168:171]
buffer_load_dword v22, v21, s[24:27], 0 offen
v_mfma_f32_16x16x32_bf16 v[176:179], a[100:103], a[164:167], v[176:179]
v_add_u32 v21, s29, v21
ds_read_b128 a[140:143], v9 offset:34816
v_mfma_f32_16x16x32_bf16 v[184:187], a[104:107], a[164:167], v[184:187]
ds_read_b128 a[144:147], v9 offset:36864
ds_read_b128 a[148:151], v9 offset:38912
v_mfma_f32_16x16x32_bf16 v[192:195], a[108:111], a[164:167], v[192:195]
v_mfma_f32_16x16x32_bf16 v[200:203], a[112:115], a[164:167], v[200:203]
v_mfma_f32_16x16x32_bf16 v[208:211], a[116:119], a[164:167], v[208:211]
ds_read_b64_tr_b16 a[164:165], v10 offset:28672
v_mfma_f32_16x16x32_bf16 v[212:215], a[116:119], a[168:171], v[212:215]
ds_read_b64_tr_b16 a[166:167], v10 offset:29696
v_mfma_f32_16x16x32_bf16 v[204:207], a[112:115], a[168:171], v[204:207]
v_mfma_f32_16x16x32_bf16 v[196:199], a[108:111], a[168:171], v[196:199]
v_mfma_f32_16x16x32_bf16 v[188:191], a[104:107], a[168:171], v[188:191]
v_mfma_f32_16x16x32_bf16 v[180:183], a[100:103], a[168:171], v[180:183]
v_mfma_f32_16x16x32_bf16 v[172:175], a[96:99], a[168:171], v[172:175]
v_mfma_f32_16x16x32_bf16 v[164:167], a[92:95], a[168:171], v[164:167]
v_mfma_f32_16x16x32_bf16 v[156:159], a[88:91], a[168:171], v[156:159]
ds_read_b64_tr_b16 a[168:169], v11 offset:20480
v_mfma_f32_16x16x32_bf16 v[56:59], a[120:123], a[152:155], v[56:59]
ds_read_b64_tr_b16 a[170:171], v11 offset:21504
v_mfma_f32_16x16x32_bf16 v[64:67], a[124:127], a[152:155], v[64:67]
v_mfma_f32_16x16x32_bf16 v[72:75], a[128:131], a[152:155], v[72:75]
v_mfma_f32_16x16x32_bf16 v[80:83], a[132:135], a[152:155], v[80:83]
ds_read_b64_tr_b16 a[152:153], v11 offset:28672
v_mfma_f32_16x16x32_bf16 v[84:87], a[132:135], a[156:159], v[84:87]
ds_read_b64_tr_b16 a[154:155], v11 offset:29696
v_mfma_f32_16x16x32_bf16 v[76:79], a[128:131], a[156:159], v[76:79]
v_mfma_f32_16x16x32_bf16 v[68:71], a[124:127], a[156:159], v[68:71]
v_mfma_f32_16x16x32_bf16 v[60:63], a[120:123], a[156:159], v[60:63]
ds_read_b128 a[156:159], v17 offset:20480
s_waitcnt lgkmcnt(4)
v_mfma_f32_16x16x32_bf16 v[216:219], a[160:163], a[120:123], v[216:219]
v_mfma_f32_16x16x32_bf16 v[224:227], a[160:163], a[124:127], v[224:227]
v_mfma_f32_16x16x32_bf16 v[232:235], a[160:163], a[128:131], v[232:235]
v_mfma_f32_16x16x32_bf16 v[240:243], a[160:163], a[132:135], v[240:243]
v_mfma_f32_16x16x32_bf16 v[248:251], a[160:163], a[136:139], v[248:251]
v_mfma_f32_16x16x32_bf16 a[80:83], a[160:163], a[140:143], a[80:83]
v_mfma_f32_16x16x32_bf16 a[72:75], a[160:163], a[144:147], a[72:75]
v_mfma_f32_16x16x32_bf16 a[64:67], a[160:163], a[148:151], a[64:67]
ds_read_b128 a[160:163], v17 offset:30720
v_mfma_f32_16x16x32_bf16 a[0:3], a[164:167], a[148:151], a[0:3]
v_mfma_f32_16x16x32_bf16 a[8:11], a[164:167], a[144:147], a[8:11]
v_mfma_f32_16x16x32_bf16 a[16:19], a[164:167], a[140:143], a[16:19]
v_mfma_f32_16x16x32_bf16 a[24:27], a[164:167], a[136:139], a[24:27]
v_mfma_f32_16x16x32_bf16 a[32:35], a[164:167], a[132:135], a[32:35]
v_mfma_f32_16x16x32_bf16 a[40:43], a[164:167], a[128:131], a[40:43]
v_mfma_f32_16x16x32_bf16 a[48:51], a[164:167], a[124:127], a[48:51]
v_mfma_f32_16x16x32_bf16 a[56:59], a[164:167], a[120:123], a[56:59]
ds_read_b128 a[164:167], v17 offset:21504
s_waitcnt lgkmcnt(1)
v_mfma_f32_16x16x32_bf16 v[220:223], a[168:171], a[120:123], v[220:223]
v_mfma_f32_16x16x32_bf16 v[228:231], a[168:171], a[124:127], v[228:231]
v_mfma_f32_16x16x32_bf16 v[236:239], a[168:171], a[128:131], v[236:239]
v_mfma_f32_16x16x32_bf16 v[244:247], a[168:171], a[132:135], v[244:247]
v_mfma_f32_16x16x32_bf16 v[252:255], a[168:171], a[136:139], v[252:255]
v_mfma_f32_16x16x32_bf16 a[84:87], a[168:171], a[140:143], a[84:87]
v_mfma_f32_16x16x32_bf16 a[76:79], a[168:171], a[144:147], a[76:79]
v_mfma_f32_16x16x32_bf16 a[68:71], a[168:171], a[148:151], a[68:71]
ds_read_b128 a[168:171], v17 offset:31744
v_mfma_f32_16x16x32_bf16 a[4:7], a[152:155], a[148:151], a[4:7]
v_mfma_f32_16x16x32_bf16 a[12:15], a[152:155], a[144:147], a[12:15]
v_mfma_f32_16x16x32_bf16 a[20:23], a[152:155], a[140:143], a[20:23]
v_mfma_f32_16x16x32_bf16 a[28:31], a[152:155], a[136:139], a[28:31]
v_mfma_f32_16x16x32_bf16 a[36:39], a[152:155], a[132:135], a[36:39]
v_mfma_f32_16x16x32_bf16 a[44:47], a[152:155], a[128:131], a[44:47]
v_mfma_f32_16x16x32_bf16 a[52:55], a[152:155], a[124:127], a[52:55]
v_mfma_f32_16x16x32_bf16 a[60:63], a[152:155], a[120:123], a[60:63]
v_mfma_f32_16x16x32_bf16 v[88:91], a[120:123], a[156:159], v[88:91]
v_mfma_f32_16x16x32_bf16 v[96:99], a[124:127], a[156:159], v[96:99]
v_mfma_f32_16x16x32_bf16 v[104:107], a[128:131], a[156:159], v[104:107]
v_mfma_f32_16x16x32_bf16 v[112:115], a[132:135], a[156:159], v[112:115]
v_mfma_f32_16x16x32_bf16 v[120:123], a[136:139], a[156:159], v[120:123]
v_mfma_f32_16x16x32_bf16 v[128:131], a[140:143], a[156:159], v[128:131]
v_mfma_f32_16x16x32_bf16 v[136:139], a[144:147], a[156:159], v[136:139]
v_mfma_f32_16x16x32_bf16 v[144:147], a[148:151], a[156:159], v[144:147]
s_waitcnt vmcnt(2) lgkmcnt(0)
s_barrier
s_add_u32 s52, s52, 128
s_addc_u32 s53, s53, 0
v_mfma_f32_16x16x32_bf16 v[148:151], a[148:151], a[160:163], v[148:151]
s_add_u32 s56, s56, 458752
s_addc_u32 s57, s57, 0
v_mfma_f32_16x16x32_bf16 v[140:143], a[144:147], a[160:163], v[140:143]
s_add_u32 s60, s60, 128
s_addc_u32 s61, s61, 0
v_mfma_f32_16x16x32_bf16 v[132:135], a[140:143], a[160:163], v[132:135]
s_add_u32 m0, s89, 32768
ds_read_b128 a[152:155], v14 offset:4096
v_mfma_f32_16x16x32_bf16 v[124:127], a[136:139], a[160:163], v[124:127]
ds_read_b128 a[88:91], v6 offset:0
ds_read_b128 a[92:95], v6 offset:2048
v_mfma_f32_16x16x32_bf16 v[116:119], a[132:135], a[160:163], v[116:119]
ds_read_b128 a[96:99], v6 offset:4096
ds_read_b128 a[100:103], v6 offset:6144
v_mfma_f32_16x16x32_bf16 v[108:111], a[128:131], a[160:163], v[108:111]
ds_read_b128 a[156:159], v14 offset:14336
v_mfma_f32_16x16x32_bf16 v[100:103], a[124:127], a[160:163], v[100:103]
v_mfma_f32_16x16x32_bf16 v[92:95], a[120:123], a[160:163], v[92:95]
ds_read_b64_tr_b16 a[160:161], v10 offset:0
ds_read_b64_tr_b16 a[162:163], v10 offset:1024
v_mfma_f32_16x16x32_bf16 v[152:155], a[120:123], a[164:167], v[152:155]
ds_read_b128 a[104:107], v7 offset:0
ds_read_b128 a[108:111], v7 offset:2048
v_mfma_f32_16x16x32_bf16 v[160:163], a[124:127], a[164:167], v[160:163]
ds_read_b128 a[112:115], v7 offset:4096
ds_read_b128 a[116:119], v7 offset:6144
v_mfma_f32_16x16x32_bf16 v[168:171], a[128:131], a[164:167], v[168:171]
v_mfma_f32_16x16x32_bf16 v[176:179], a[132:135], a[164:167], v[176:179]
v_mfma_f32_16x16x32_bf16 v[184:187], a[136:139], a[164:167], v[184:187]
buffer_load_dwordx4 v2, s[52:55], s68 offen offset:0 lds
v_mfma_f32_16x16x32_bf16 v[192:195], a[140:143], a[164:167], v[192:195]
v_mfma_f32_16x16x32_bf16 v[200:203], a[144:147], a[164:167], v[200:203]
v_mfma_f32_16x16x32_bf16 v[208:211], a[148:151], a[164:167], v[208:211]
ds_read_b64_tr_b16 a[164:165], v10 offset:8192
ds_read_b64_tr_b16 a[166:167], v10 offset:9216
v_mfma_f32_16x16x32_bf16 v[212:215], a[148:151], a[168:171], v[212:215]
buffer_load_dwordx4 v3, s[52:55], s69 offen offset:1024 lds
v_mfma_f32_16x16x32_bf16 v[204:207], a[144:147], a[168:171], v[204:207]
v_mfma_f32_16x16x32_bf16 v[196:199], a[140:143], a[168:171], v[196:199]
v_mfma_f32_16x16x32_bf16 v[188:191], a[136:139], a[168:171], v[188:191]
v_mfma_f32_16x16x32_bf16 v[180:183], a[132:135], a[168:171], v[180:183]
buffer_load_dwordx4 v2, s[52:55], s70 offen offset:2048 lds
v_mfma_f32_16x16x32_bf16 v[172:175], a[128:131], a[168:171], v[172:175]
v_mfma_f32_16x16x32_bf16 v[164:167], a[124:127], a[168:171], v[164:167]
v_mfma_f32_16x16x32_bf16 v[156:159], a[120:123], a[168:171], v[156:159]
ds_read_b64_tr_b16 a[168:169], v11 offset:0
s_waitcnt lgkmcnt(1)
v_mfma_f32_16x16x32_bf16 v[56:59], a[88:91], a[152:155], v[56:59]
buffer_load_dwordx4 v3, s[52:55], s71 offen offset:3072 lds
v_mfma_f32_16x16x32_bf16 v[64:67], a[92:95], a[152:155], v[64:67]
s_add_u32 m0, s89, 36864
ds_read_b64_tr_b16 a[170:171], v11 offset:1024
v_mfma_f32_16x16x32_bf16 v[72:75], a[96:99], a[152:155], v[72:75]
v_mfma_f32_16x16x32_bf16 v[80:83], a[100:103], a[152:155], v[80:83]
ds_read_b64_tr_b16 a[152:153], v11 offset:8192
v_mfma_f32_16x16x32_bf16 v[84:87], a[100:103], a[156:159], v[84:87]
buffer_load_dwordx4 v2, s[52:55], s72 offen offset:0 lds
v_mfma_f32_16x16x32_bf16 v[76:79], a[96:99], a[156:159], v[76:79]
ds_read_b64_tr_b16 a[154:155], v11 offset:9216
v_mfma_f32_16x16x32_bf16 v[68:71], a[92:95], a[156:159], v[68:71]
v_mfma_f32_16x16x32_bf16 v[60:63], a[88:91], a[156:159], v[60:63]
ds_read_b128 a[156:159], v16 offset:0
v_mfma_f32_16x16x32_bf16 v[216:219], a[160:163], a[88:91], v[216:219]
buffer_load_dwordx4 v3, s[52:55], s73 offen offset:1024 lds
v_mfma_f32_16x16x32_bf16 v[224:227], a[160:163], a[92:95], v[224:227]
v_mfma_f32_16x16x32_bf16 v[232:235], a[160:163], a[96:99], v[232:235]
v_mfma_f32_16x16x32_bf16 v[240:243], a[160:163], a[100:103], v[240:243]
v_mfma_f32_16x16x32_bf16 v[248:251], a[160:163], a[104:107], v[248:251]
buffer_load_dwordx4 v2, s[52:55], s74 offen offset:2048 lds
v_mfma_f32_16x16x32_bf16 a[80:83], a[160:163], a[108:111], a[80:83]
v_mfma_f32_16x16x32_bf16 a[72:75], a[160:163], a[112:115], a[72:75]
v_mfma_f32_16x16x32_bf16 a[64:67], a[160:163], a[116:119], a[64:67]
ds_read_b128 a[160:163], v16 offset:10240
v_mfma_f32_16x16x32_bf16 a[0:3], a[164:167], a[116:119], a[0:3]
buffer_load_dwordx4 v3, s[52:55], s75 offen offset:3072 lds
v_mfma_f32_16x16x32_bf16 a[8:11], a[164:167], a[112:115], a[8:11]
s_add_u32 m0, s90, 16384
v_mfma_f32_16x16x32_bf16 a[16:19], a[164:167], a[108:111], a[16:19]
v_mfma_f32_16x16x32_bf16 a[24:27], a[164:167], a[104:107], a[24:27]
v_mfma_f32_16x16x32_bf16 a[32:35], a[164:167], a[100:103], a[32:35]
buffer_load_dwordx4 v4, s[56:59], s76 offen offset:0 lds
v_mfma_f32_16x16x32_bf16 a[40:43], a[164:167], a[96:99], a[40:43]
v_mfma_f32_16x16x32_bf16 a[48:51], a[164:167], a[92:95], a[48:51]
v_mfma_f32_16x16x32_bf16 a[56:59], a[164:167], a[88:91], a[56:59]
ds_read_b128 a[164:167], v16 offset:1024
s_waitcnt lgkmcnt(1)
v_mfma_f32_16x16x32_bf16 v[220:223], a[168:171], a[88:91], v[220:223]
buffer_load_dwordx4 v4, s[56:59], s77 offen offset:1024 lds
v_mfma_f32_16x16x32_bf16 v[228:231], a[168:171], a[92:95], v[228:231]
v_mfma_f32_16x16x32_bf16 v[236:239], a[168:171], a[96:99], v[236:239]
v_mfma_f32_16x16x32_bf16 v[244:247], a[168:171], a[100:103], v[244:247]
v_mfma_f32_16x16x32_bf16 v[252:255], a[168:171], a[104:107], v[252:255]
buffer_load_dwordx4 v4, s[56:59], s78 offen offset:2048 lds
v_mfma_f32_16x16x32_bf16 a[84:87], a[168:171], a[108:111], a[84:87]
v_mfma_f32_16x16x32_bf16 a[76:79], a[168:171], a[112:115], a[76:79]
v_mfma_f32_16x16x32_bf16 a[68:71], a[168:171], a[116:119], a[68:71]
ds_read_b128 a[168:171], v16 offset:11264
v_mfma_f32_16x16x32_bf16 a[4:7], a[152:155], a[116:119], a[4:7]
buffer_load_dwordx4 v4, s[56:59], s79 offen offset:3072 lds
v_mfma_f32_16x16x32_bf16 a[12:15], a[152:155], a[112:115], a[12:15]
s_add_u32 m0, s91, 20480
v_mfma_f32_16x16x32_bf16 a[20:23], a[152:155], a[108:111], a[20:23]
v_mfma_f32_16x16x32_bf16 a[28:31], a[152:155], a[104:107], a[28:31]
s_sub_u32 s10, s10, 1
v_mfma_f32_16x16x32_bf16 a[36:39], a[152:155], a[100:103], a[36:39]
buffer_load_dwordx4 v5, s[60:63], s84 offen offset:0 lds
v_mfma_f32_16x16x32_bf16 a[44:47], a[152:155], a[96:99], a[44:47]
v_mfma_f32_16x16x32_bf16 a[52:55], a[152:155], a[92:95], a[52:55]
v_mfma_f32_16x16x32_bf16 a[60:63], a[152:155], a[88:91], a[60:63]
ds_read_b128 a[152:155], v15 offset:4096
v_mfma_f32_16x16x32_bf16 v[88:91], a[88:91], a[156:159], v[88:91]
buffer_load_dwordx4 v5, s[60:63], s85 offen offset:1024 lds
v_mfma_f32_16x16x32_bf16 v[96:99], a[92:95], a[156:159], v[96:99]
ds_read_b128 a[120:123], v8 offset:0
ds_read_b128 a[124:127], v8 offset:2048
v_mfma_f32_16x16x32_bf16 v[104:107], a[96:99], a[156:159], v[104:107]
ds_read_b128 a[128:131], v8 offset:4096
ds_read_b128 a[132:135], v8 offset:6144
v_mfma_f32_16x16x32_bf16 v[112:115], a[100:103], a[156:159], v[112:115]
v_mfma_f32_16x16x32_bf16 v[120:123], a[104:107], a[156:159], v[120:123]
buffer_load_dwordx4 v5, s[60:63], s86 offen offset:2048 lds
v_mfma_f32_16x16x32_bf16 v[128:131], a[108:111], a[156:159], v[128:131]
v_mfma_f32_16x16x32_bf16 v[136:139], a[112:115], a[156:159], v[136:139]
v_mfma_f32_16x16x32_bf16 v[144:147], a[116:119], a[156:159], v[144:147]
ds_read_b128 a[156:159], v15 offset:14336
v_mfma_f32_16x16x32_bf16 v[148:151], a[116:119], a[160:163], v[148:151]
buffer_load_dwordx4 v5, s[60:63], s87 offen offset:3072 lds
v_mfma_f32_16x16x32_bf16 v[140:143], a[112:115], a[160:163], v[140:143]
s_add_u32 m0, s91, 24576
v_mfma_f32_16x16x32_bf16 v[132:135], a[108:111], a[160:163], v[132:135]
v_mfma_f32_16x16x32_bf16 v[124:127], a[104:107], a[160:163], v[124:127]
v_mfma_f32_16x16x32_bf16 v[116:119], a[100:103], a[160:163], v[116:119]
buffer_load_dwordx4 v5, s[60:63], s88 offen offset:0 lds
v_mfma_f32_16x16x32_bf16 v[108:111], a[96:99], a[160:163], v[108:111]
v_mfma_f32_16x16x32_bf16 v[100:103], a[92:95], a[160:163], v[100:103]
v_mfma_f32_16x16x32_bf16 v[92:95], a[88:91], a[160:163], v[92:95]
buffer_load_dword v22, v20, s[20:23], 0 offen
s_waitcnt lgkmcnt(0)
v_mfma_f32_16x16x32_bf16 v[152:155], a[88:91], a[164:167], v[152:155]
v_add_u32 v20, s28, v20
ds_read_b64_tr_b16 a[160:161], v10 offset:4096
v_mfma_f32_16x16x32_bf16 v[160:163], a[92:95], a[164:167], v[160:163]
ds_read_b64_tr_b16 a[162:163], v10 offset:5120
ds_read_b128 a[136:139], v9 offset:0
v_mfma_f32_16x16x32_bf16 v[168:171], a[96:99], a[164:167], v[168:171]
buffer_load_dword v22, v21, s[24:27], 0 offen
v_mfma_f32_16x16x32_bf16 v[176:179], a[100:103], a[164:167], v[176:179]
v_add_u32 v21, s29, v21
ds_read_b128 a[140:143], v9 offset:2048
v_mfma_f32_16x16x32_bf16 v[184:187], a[104:107], a[164:167], v[184:187]
ds_read_b128 a[144:147], v9 offset:4096
ds_read_b128 a[148:151], v9 offset:6144
v_mfma_f32_16x16x32_bf16 v[192:195], a[108:111], a[164:167], v[192:195]
v_mfma_f32_16x16x32_bf16 v[200:203], a[112:115], a[164:167], v[200:203]
v_mfma_f32_16x16x32_bf16 v[208:211], a[116:119], a[164:167], v[208:211]
ds_read_b64_tr_b16 a[164:165], v10 offset:12288
v_mfma_f32_16x16x32_bf16 v[212:215], a[116:119], a[168:171], v[212:215]
ds_read_b64_tr_b16 a[166:167], v10 offset:13312
v_mfma_f32_16x16x32_bf16 v[204:207], a[112:115], a[168:171], v[204:207]
v_mfma_f32_16x16x32_bf16 v[196:199], a[108:111], a[168:171], v[196:199]
v_mfma_f32_16x16x32_bf16 v[188:191], a[104:107], a[168:171], v[188:191]
v_mfma_f32_16x16x32_bf16 v[180:183], a[100:103], a[168:171], v[180:183]
v_mfma_f32_16x16x32_bf16 v[172:175], a[96:99], a[168:171], v[172:175]
v_mfma_f32_16x16x32_bf16 v[164:167], a[92:95], a[168:171], v[164:167]
v_mfma_f32_16x16x32_bf16 v[156:159], a[88:91], a[168:171], v[156:159]
ds_read_b64_tr_b16 a[168:169], v11 offset:4096
v_mfma_f32_16x16x32_bf16 v[56:59], a[120:123], a[152:155], v[56:59]
ds_read_b64_tr_b16 a[170:171], v11 offset:5120
v_mfma_f32_16x16x32_bf16 v[64:67], a[124:127], a[152:155], v[64:67]
v_mfma_f32_16x16x32_bf16 v[72:75], a[128:131], a[152:155], v[72:75]
v_mfma_f32_16x16x32_bf16 v[80:83], a[132:135], a[152:155], v[80:83]
ds_read_b64_tr_b16 a[152:153], v11 offset:12288
v_mfma_f32_16x16x32_bf16 v[84:87], a[132:135], a[156:159], v[84:87]
ds_read_b64_tr_b16 a[154:155], v11 offset:13312
v_mfma_f32_16x16x32_bf16 v[76:79], a[128:131], a[156:159], v[76:79]
v_mfma_f32_16x16x32_bf16 v[68:71], a[124:127], a[156:159], v[68:71]
v_mfma_f32_16x16x32_bf16 v[60:63], a[120:123], a[156:159], v[60:63]
ds_read_b128 a[156:159], v17 offset:0
s_waitcnt lgkmcnt(4)
v_mfma_f32_16x16x32_bf16 v[216:219], a[160:163], a[120:123], v[216:219]
v_mfma_f32_16x16x32_bf16 v[224:227], a[160:163], a[124:127], v[224:227]
v_mfma_f32_16x16x32_bf16 v[232:235], a[160:163], a[128:131], v[232:235]
v_mfma_f32_16x16x32_bf16 v[240:243], a[160:163], a[132:135], v[240:243]
v_mfma_f32_16x16x32_bf16 v[248:251], a[160:163], a[136:139], v[248:251]
v_mfma_f32_16x16x32_bf16 a[80:83], a[160:163], a[140:143], a[80:83]
v_mfma_f32_16x16x32_bf16 a[72:75], a[160:163], a[144:147], a[72:75]
v_mfma_f32_16x16x32_bf16 a[64:67], a[160:163], a[148:151], a[64:67]
ds_read_b128 a[160:163], v17 offset:10240
v_mfma_f32_16x16x32_bf16 a[0:3], a[164:167], a[148:151], a[0:3]
v_mfma_f32_16x16x32_bf16 a[8:11], a[164:167], a[144:147], a[8:11]
v_mfma_f32_16x16x32_bf16 a[16:19], a[164:167], a[140:143], a[16:19]
v_mfma_f32_16x16x32_bf16 a[24:27], a[164:167], a[136:139], a[24:27]
v_mfma_f32_16x16x32_bf16 a[32:35], a[164:167], a[132:135], a[32:35]
v_mfma_f32_16x16x32_bf16 a[40:43], a[164:167], a[128:131], a[40:43]
v_mfma_f32_16x16x32_bf16 a[48:51], a[164:167], a[124:127], a[48:51]
v_mfma_f32_16x16x32_bf16 a[56:59], a[164:167], a[120:123], a[56:59]
ds_read_b128 a[164:167], v17 offset:1024
s_waitcnt lgkmcnt(1)
v_mfma_f32_16x16x32_bf16 v[220:223], a[168:171], a[120:123], v[220:223]
v_mfma_f32_16x16x32_bf16 v[228:231], a[168:171], a[124:127], v[228:231]
v_mfma_f32_16x16x32_bf16 v[236:239], a[168:171], a[128:131], v[236:239]
v_mfma_f32_16x16x32_bf16 v[244:247], a[168:171], a[132:135], v[244:247]
v_mfma_f32_16x16x32_bf16 v[252:255], a[168:171], a[136:139], v[252:255]
v_mfma_f32_16x16x32_bf16 a[84:87], a[168:171], a[140:143], a[84:87]
v_mfma_f32_16x16x32_bf16 a[76:79], a[168:171], a[144:147], a[76:79]
v_mfma_f32_16x16x32_bf16 a[68:71], a[168:171], a[148:151], a[68:71]
ds_read_b128 a[168:171], v17 offset:11264
v_mfma_f32_16x16x32_bf16 a[4:7], a[152:155], a[148:151], a[4:7]
v_mfma_f32_16x16x32_bf16 a[12:15], a[152:155], a[144:147], a[12:15]
v_mfma_f32_16x16x32_bf16 a[20:23], a[152:155], a[140:143], a[20:23]
v_mfma_f32_16x16x32_bf16 a[28:31], a[152:155], a[136:139], a[28:31]
v_mfma_f32_16x16x32_bf16 a[36:39], a[152:155], a[132:135], a[36:39]
v_mfma_f32_16x16x32_bf16 a[44:47], a[152:155], a[128:131], a[44:47]
v_mfma_f32_16x16x32_bf16 a[52:55], a[152:155], a[124:127], a[52:55]
v_mfma_f32_16x16x32_bf16 a[60:63], a[152:155], a[120:123], a[60:63]
v_mfma_f32_16x16x32_bf16 v[88:91], a[120:123], a[156:159], v[88:91]
v_mfma_f32_16x16x32_bf16 v[96:99], a[124:127], a[156:159], v[96:99]
v_mfma_f32_16x16x32_bf16 v[104:107], a[128:131], a[156:159], v[104:107]
v_mfma_f32_16x16x32_bf16 v[112:115], a[132:135], a[156:159], v[112:115]
v_mfma_f32_16x16x32_bf16 v[120:123], a[136:139], a[156:159], v[120:123]
v_mfma_f32_16x16x32_bf16 v[128:131], a[140:143], a[156:159], v[128:131]
v_mfma_f32_16x16x32_bf16 v[136:139], a[144:147], a[156:159], v[136:139]
v_mfma_f32_16x16x32_bf16 v[144:147], a[148:151], a[156:159], v[144:147]
s_waitcnt vmcnt(2) lgkmcnt(0)
s_barrier
s_cmp_lg_u32 s10, 0
s_cbranch_scc1 L1B_loop
v_mfma_f32_16x16x32_bf16 v[148:151], a[148:151], a[160:163], v[148:151]
ds_read_b128 a[152:155], v14 offset:24576
ds_read_b128 a[88:91], v6 offset:32768
v_mfma_f32_16x16x32_bf16 v[140:143], a[144:147], a[160:163], v[140:143]
ds_read_b128 a[92:95], v6 offset:34816
ds_read_b128 a[96:99], v6 offset:36864
v_mfma_f32_16x16x32_bf16 v[132:135], a[140:143], a[160:163], v[132:135]
ds_read_b128 a[100:103], v6 offset:38912
ds_read_b128 a[156:159], v14 offset:34816
v_mfma_f32_16x16x32_bf16 v[124:127], a[136:139], a[160:163], v[124:127]
v_mfma_f32_16x16x32_bf16 v[116:119], a[132:135], a[160:163], v[116:119]
v_mfma_f32_16x16x32_bf16 v[108:111], a[128:131], a[160:163], v[108:111]
v_mfma_f32_16x16x32_bf16 v[100:103], a[124:127], a[160:163], v[100:103]
v_mfma_f32_16x16x32_bf16 v[92:95], a[120:123], a[160:163], v[92:95]
ds_read_b64_tr_b16 a[160:161], v10 offset:16384
ds_read_b64_tr_b16 a[162:163], v10 offset:17408
v_mfma_f32_16x16x32_bf16 v[152:155], a[120:123], a[164:167], v[152:155]
ds_read_b128 a[104:107], v7 offset:32768
ds_read_b128 a[108:111], v7 offset:34816
v_mfma_f32_16x16x32_bf16 v[160:163], a[124:127], a[164:167], v[160:163]
ds_read_b128 a[112:115], v7 offset:36864
ds_read_b128 a[116:119], v7 offset:38912
v_mfma_f32_16x16x32_bf16 v[168:171], a[128:131], a[164:167], v[168:171]
v_mfma_f32_16x16x32_bf16 v[176:179], a[132:135], a[164:167], v[176:179]
v_mfma_f32_16x16x32_bf16 v[184:187], a[136:139], a[164:167], v[184:187]
v_mfma_f32_16x16x32_bf16 v[192:195], a[140:143], a[164:167], v[192:195]
s_getpc_b64 s[92:93]
L1B_pc0:
s_add_u32 s92, s92, L1B_epi-L1B_pc0
s_addc_u32 s93, s93, 0
global_load_dword v22, v43, s[92:93]
v_mfma_f32_16x16x32_bf16 v[200:203], a[144:147], a[164:167], v[200:203]
v_mfma_f32_16x16x32_bf16 v[208:211], a[148:151], a[164:167], v[208:211]
ds_read_b64_tr_b16 a[164:165], v10 offset:24576
ds_read_b64_tr_b16 a[166:167], v10 offset:25600
v_mfma_f32_16x16x32_bf16 v[212:215], a[148:151], a[168:171], v[212:215]
v_mfma_f32_16x16x32_bf16 v[204:207], a[144:147], a[168:171], v[204:207]
v_mfma_f32_16x16x32_bf16 v[196:199], a[140:143], a[168:171], v[196:199]
v_mfma_f32_16x16x32_bf16 v[188:191], a[136:139], a[168:171], v[188:191]
s_getpc_b64 s[92:93]
L1B_pc1:
s_add_u32 s92, s92, L2_start-L1B_pc1
s_addc_u32 s93, s93, 0
global_load_dword v22, v43, s[92:93]
v_mfma_f32_16x16x32_bf16 v[180:183], a[132:135], a[168:171], v[180:183]
v_mfma_f32_16x16x32_bf16 v[172:175], a[128:131], a[168:171], v[172:175]
v_mfma_f32_16x16x32_bf16 v[164:167], a[124:127], a[168:171], v[164:167]
v_mfma_f32_16x16x32_bf16 v[156:159], a[120:123], a[168:171], v[156:159]
ds_read_b64_tr_b16 a[168:169], v11 offset:16384
s_waitcnt lgkmcnt(1)
v_mfma_f32_16x16x32_bf16 v[56:59], a[88:91], a[152:155], v[56:59]
ds_read_b64_tr_b16 a[170:171], v11 offset:17408
v_mfma_f32_16x16x32_bf16 v[64:67], a[92:95], a[152:155], v[64:67]
v_mfma_f32_16x16x32_bf16 v[72:75], a[96:99], a[152:155], v[72:75]
v_mfma_f32_16x16x32_bf16 v[80:83], a[100:103], a[152:155], v[80:83]
ds_read_b64_tr_b16 a[152:153], v11 offset:24576
v_mfma_f32_16x16x32_bf16 v[84:87], a[100:103], a[156:159], v[84:87]
ds_read_b64_tr_b16 a[154:155], v11 offset:25600
v_mfma_f32_16x16x32_bf16 v[76:79], a[96:99], a[156:159], v[76:79]
s_bfe_u32 s11, s2, 0x10001
s_lshl_b32 s11, s11, 3
s_add_u32 s80, s11, s4
s_and_b32 s11, s2, 4
s_add_u32 s81, s11, s5
v_mfma_f32_16x16x32_bf16 v[68:71], a[92:95], a[156:159], v[68:71]
v_mov_b32 v24, -1
v_mov_b32 v25, -1
v_mfma_f32_16x16x32_bf16 v[60:63], a[88:91], a[156:159], v[60:63]
v_mov_b32 v26, -1
v_mfma_f32_16x16x32_bf16 v[216:219], a[160:163], a[88:91], v[216:219]
v_mov_b32 v27, -1
ds_read_b128 a[156:159], v16 offset:20480
v_mfma_f32_16x16x32_bf16 v[224:227], a[160:163], a[92:95], v[224:227]
v_mfma_f32_16x16x32_bf16 v[232:235], a[160:163], a[96:99], v[232:235]
v_mfma_f32_16x16x32_bf16 v[240:243], a[160:163], a[100:103], v[240:243]
s_lshl_b32 s11, s80, 3
s_add_u32 s11, s11, s81
s_lshl_b32 s11, s11, 1
s_add_u32 s11, s11, s15
v_mfma_f32_16x16x32_bf16 v[248:251], a[160:163], a[104:107], v[248:251]
v_mfma_f32_16x16x32_bf16 a[80:83], a[160:163], a[108:111], a[80:83]
v_mfma_f32_16x16x32_bf16 a[72:75], a[160:163], a[112:115], a[72:75]
v_mfma_f32_16x16x32_bf16 a[64:67], a[160:163], a[116:119], a[64:67]
ds_read_b128 a[160:163], v16 offset:30720
v_mfma_f32_16x16x32_bf16 a[0:3], a[164:167], a[116:119], a[0:3]
v_mfma_f32_16x16x32_bf16 a[8:11], a[164:167], a[112:115], a[8:11]
s_lshl_b32 s11, s11, 2
s_add_u32 s83, s11, s3
s_xor_b32 s11, s83, 4
s_lshl_b32 s11, s11, 12
v_mfma_f32_16x16x32_bf16 a[16:19], a[164:167], a[108:111], a[16:19]
v_mfma_f32_16x16x32_bf16 a[24:27], a[164:167], a[104:107], a[24:27]
v_mfma_f32_16x16x32_bf16 a[32:35], a[164:167], a[100:103], a[32:35]
v_mfma_f32_16x16x32_bf16 a[40:43], a[164:167], a[96:99], a[40:43]
v_mfma_f32_16x16x32_bf16 a[48:51], a[164:167], a[92:95], a[48:51]
v_mfma_f32_16x16x32_bf16 a[56:59], a[164:167], a[88:91], a[56:59]
ds_read_b128 a[164:167], v16 offset:21504
s_waitcnt lgkmcnt(1)
v_mfma_f32_16x16x32_bf16 v[220:223], a[168:171], a[88:91], v[220:223]
s_add_u32 s64, s48, 25165824
s_addc_u32 s65, s49, 0
s_mov_b32 s66, 4194304
v_mfma_f32_16x16x32_bf16 v[228:231], a[168:171], a[92:95], v[228:231]
s_mul_i32 s94, s15, 28
s_add_u32 s94, s94, s8
v_mfma_f32_16x16x32_bf16 v[236:239], a[168:171], a[96:99], v[236:239]
s_lshl_b32 s94, s94, 17
s_xor_b32 s95, s7, s15
v_mfma_f32_16x16x32_bf16 v[244:247], a[168:171], a[100:103], v[244:247]
s_lshl_b32 s84, s81, 1
s_add_u32 s95, s95, s84
v_mfma_f32_16x16x32_bf16 v[252:255], a[168:171], a[104:107], v[252:255]
s_lshl_b32 s95, s95, 7
s_add_u32 s94, s94, s95
v_mfma_f32_16x16x32_bf16 a[84:87], a[168:171], a[108:111], a[84:87]
s_add_u32 s52, s40, s94
s_addc_u32 s53, s41, 0
v_mfma_f32_16x16x32_bf16 a[76:79], a[168:171], a[112:115], a[76:79]
s_sub_u32 s52, s52, 3072
s_subb_u32 s53, s53, 0
v_mfma_f32_16x16x32_bf16 a[68:71], a[168:171], a[116:119], a[68:71]
buffer_store_dwordx4 v[24:27], v1, s[64:67], s11 offen offset:0 sc0 sc1
v_mfma_f32_16x16x32_bf16 a[4:7], a[152:155], a[116:119], a[4:7]
ds_read_b128 a[168:171], v16 offset:31744
s_mov_b32 s54, 134144
v_mfma_f32_16x16x32_bf16 a[12:15], a[152:155], a[112:115], a[12:15]
s_mov_b32 s77, 262144
s_lshl_b32 s76, s3, 13
v_mfma_f32_16x16x32_bf16 a[20:23], a[152:155], a[108:111], a[20:23]
v_lshrrev_b32 v28, 4, v1
v_lshrrev_b32 v29, 4, v28
v_mfma_f32_16x16x32_bf16 a[28:31], a[152:155], a[104:107], a[28:31]
v_bfe_u32 v30, v28, 3, 1
v_lshl_add_u32 v30, v30, 2, v29
v_mfma_f32_16x16x32_bf16 a[36:39], a[152:155], a[100:103], a[36:39]
v_bfe_u32 v31, v28, 1, 2
v_xor_b32 v31, v31, v29
v_mfma_f32_16x16x32_bf16 a[44:47], a[152:155], a[96:99], a[44:47]
buffer_store_dwordx4 v[24:27], v1, s[64:67], s11 offen offset:1024 sc0 sc1
v_mfma_f32_16x16x32_bf16 a[52:55], a[152:155], a[92:95], a[52:55]
v_lshlrev_b32 v31, 5, v31
v_and_b32 v28, 1, v28
v_mfma_f32_16x16x32_bf16 a[60:63], a[152:155], a[88:91], a[60:63]
v_lshl_add_u32 v31, v28, 4, v31
v_mfma_f32_16x16x32_bf16 v[88:91], a[88:91], a[156:159], v[88:91]
v_lshl_add_u32 v0, v30, 11, v31
s_mov_b32 s68, 3072
v_mfma_f32_16x16x32_bf16 v[96:99], a[92:95], a[156:159], v[96:99]
s_mov_b32 s69, 18432
s_mov_b32 s70, 33792
v_mfma_f32_16x16x32_bf16 v[104:107], a[96:99], a[156:159], v[104:107]
s_mov_b32 s71, 49152
s_mov_b32 s72, 68608
v_mfma_f32_16x16x32_bf16 v[112:115], a[100:103], a[156:159], v[112:115]
buffer_store_dwordx4 v[24:27], v1, s[64:67], s11 offen offset:2048 sc0 sc1
v_mfma_f32_16x16x32_bf16 v[120:123], a[104:107], a[156:159], v[120:123]
s_mov_b32 s73, 83968
s_mov_b32 s74, 99328
v_mfma_f32_16x16x32_bf16 v[128:131], a[108:111], a[156:159], v[128:131]
s_mov_b32 s75, 114688
ds_read_b128 a[152:155], v15 offset:24576
v_mfma_f32_16x16x32_bf16 v[136:139], a[112:115], a[156:159], v[136:139]
ds_read_b128 a[120:123], v8 offset:32768
ds_read_b128 a[124:127], v8 offset:34816
v_mfma_f32_16x16x32_bf16 v[144:147], a[116:119], a[156:159], v[144:147]
ds_read_b128 a[128:131], v8 offset:36864
v_mfma_f32_16x16x32_bf16 v[148:151], a[116:119], a[160:163], v[148:151]
ds_read_b128 a[132:135], v8 offset:38912
ds_read_b128 a[156:159], v15 offset:34816
v_mfma_f32_16x16x32_bf16 v[140:143], a[112:115], a[160:163], v[140:143]
buffer_store_dwordx4 v[24:27], v1, s[64:67], s11 offen offset:3072 sc0 sc1
v_mfma_f32_16x16x32_bf16 v[132:135], a[108:111], a[160:163], v[132:135]
v_mfma_f32_16x16x32_bf16 v[124:127], a[104:107], a[160:163], v[124:127]
v_mfma_f32_16x16x32_bf16 v[116:119], a[100:103], a[160:163], v[116:119]
v_mfma_f32_16x16x32_bf16 v[108:111], a[96:99], a[160:163], v[108:111]
v_mfma_f32_16x16x32_bf16 v[100:103], a[92:95], a[160:163], v[100:103]
v_mfma_f32_16x16x32_bf16 v[92:95], a[88:91], a[160:163], v[92:95]
ds_read_b64_tr_b16 a[160:161], v10 offset:20480
s_waitcnt lgkmcnt(3)
v_mfma_f32_16x16x32_bf16 v[152:155], a[88:91], a[164:167], v[152:155]
ds_read_b64_tr_b16 a[162:163], v10 offset:21504
ds_read_b128 a[136:139], v9 offset:32768
v_mfma_f32_16x16x32_bf16 v[160:163], a[92:95], a[164:167], v[160:163]
ds_read_b128 a[140:143], v9 offset:34816
ds_read_b128 a[144:147], v9 offset:36864
v_mfma_f32_16x16x32_bf16 v[168:171], a[96:99], a[164:167], v[168:171]
ds_read_b128 a[148:151], v9 offset:38912
v_mfma_f32_16x16x32_bf16 v[176:179], a[100:103], a[164:167], v[176:179]
v_mfma_f32_16x16x32_bf16 v[184:187], a[104:107], a[164:167], v[184:187]
v_mfma_f32_16x16x32_bf16 v[192:195], a[108:111], a[164:167], v[192:195]
v_mfma_f32_16x16x32_bf16 v[200:203], a[112:115], a[164:167], v[200:203]
s_add_u32 m0, s76, 0
v_mfma_f32_16x16x32_bf16 v[208:211], a[116:119], a[164:167], v[208:211]
buffer_load_dwordx4 v0, s[52:55], s68 offen offset:0  lds
v_mfma_f32_16x16x32_bf16 v[212:215], a[116:119], a[168:171], v[212:215]
ds_read_b64_tr_b16 a[164:165], v10 offset:28672
ds_read_b64_tr_b16 a[166:167], v10 offset:29696
v_mfma_f32_16x16x32_bf16 v[204:207], a[112:115], a[168:171], v[204:207]
v_mfma_f32_16x16x32_bf16 v[196:199], a[108:111], a[168:171], v[196:199]
v_mfma_f32_16x16x32_bf16 v[188:191], a[104:107], a[168:171], v[188:191]
v_mfma_f32_16x16x32_bf16 v[180:183], a[100:103], a[168:171], v[180:183]
buffer_load_dwordx4 v0, s[52:55], s69 offen offset:1024  lds
v_mfma_f32_16x16x32_bf16 v[172:175], a[96:99], a[168:171], v[172:175]
v_mfma_f32_16x16x32_bf16 v[164:167], a[92:95], a[168:171], v[164:167]
v_mfma_f32_16x16x32_bf16 v[156:159], a[88:91], a[168:171], v[156:159]
ds_read_b64_tr_b16 a[168:169], v11 offset:20480
v_mfma_f32_16x16x32_bf16 v[56:59], a[120:123], a[152:155], v[56:59]
ds_read_b64_tr_b16 a[170:171], v11 offset:21504
v_mfma_f32_16x16x32_bf16 v[64:67], a[124:127], a[152:155], v[64:67]
buffer_load_dwordx4 v0, s[52:55], s70 offen offset:2048  lds
v_mfma_f32_16x16x32_bf16 v[72:75], a[128:131], a[152:155], v[72:75]
s_waitcnt lgkmcnt(2)
v_mfma_f32_16x16x32_bf16 v[80:83], a[132:135], a[152:155], v[80:83]
ds_read_b64_tr_b16 a[152:153], v11 offset:28672
v_mfma_f32_16x16x32_bf16 v[84:87], a[132:135], a[156:159], v[84:87]
ds_read_b64_tr_b16 a[154:155], v11 offset:29696
v_mfma_f32_16x16x32_bf16 v[76:79], a[128:131], a[156:159], v[76:79]
v_mfma_f32_16x16x32_bf16 v[68:71], a[124:127], a[156:159], v[68:71]
buffer_load_dwordx4 v0, s[52:55], s71 offen offset:3072  lds
v_mfma_f32_16x16x32_bf16 v[60:63], a[120:123], a[156:159], v[60:63]
ds_read_b128 a[156:159], v17 offset:20480
v_mfma_f32_16x16x32_bf16 v[216:219], a[160:163], a[120:123], v[216:219]
v_mfma_f32_16x16x32_bf16 v[224:227], a[160:163], a[124:127], v[224:227]
v_mfma_f32_16x16x32_bf16 v[232:235], a[160:163], a[128:131], v[232:235]
s_add_u32 m0, s76, 4096
v_mfma_f32_16x16x32_bf16 v[240:243], a[160:163], a[132:135], v[240:243]
buffer_load_dwordx4 v0, s[52:55], s72 offen offset:0  lds
v_mfma_f32_16x16x32_bf16 v[248:251], a[160:163], a[136:139], v[248:251]
v_mfma_f32_16x16x32_bf16 a[80:83], a[160:163], a[140:143], a[80:83]
v_mfma_f32_16x16x32_bf16 a[72:75], a[160:163], a[144:147], a[72:75]
v_mfma_f32_16x16x32_bf16 a[64:67], a[160:163], a[148:151], a[64:67]
ds_read_b128 a[160:163], v17 offset:30720
v_mfma_f32_16x16x32_bf16 a[0:3], a[164:167], a[148:151], a[0:3]
buffer_load_dwordx4 v0, s[52:55], s73 offen offset:1024  lds
v_mfma_f32_16x16x32_bf16 a[8:11], a[164:167], a[144:147], a[8:11]
v_mfma_f32_16x16x32_bf16 a[16:19], a[164:167], a[140:143], a[16:19]
v_mfma_f32_16x16x32_bf16 a[24:27], a[164:167], a[136:139], a[24:27]
v_mfma_f32_16x16x32_bf16 a[32:35], a[164:167], a[132:135], a[32:35]
v_mfma_f32_16x16x32_bf16 a[40:43], a[164:167], a[128:131], a[40:43]
buffer_load_dwordx4 v0, s[52:55], s74 offen offset:2048  lds
v_mfma_f32_16x16x32_bf16 a[48:51], a[164:167], a[124:127], a[48:51]
v_mfma_f32_16x16x32_bf16 a[56:59], a[164:167], a[120:123], a[56:59]
ds_read_b128 a[164:167], v17 offset:21504
s_waitcnt lgkmcnt(1)
v_mfma_f32_16x16x32_bf16 v[220:223], a[168:171], a[120:123], v[220:223]
v_mfma_f32_16x16x32_bf16 v[228:231], a[168:171], a[124:127], v[228:231]
v_mfma_f32_16x16x32_bf16 v[236:239], a[168:171], a[128:131], v[236:239]
buffer_load_dwordx4 v0, s[52:55], s75 offen offset:3072  lds
v_mfma_f32_16x16x32_bf16 v[244:247], a[168:171], a[132:135], v[244:247]
v_mfma_f32_16x16x32_bf16 v[252:255], a[168:171], a[136:139], v[252:255]
v_mfma_f32_16x16x32_bf16 a[84:87], a[168:171], a[140:143], a[84:87]
v_mfma_f32_16x16x32_bf16 a[76:79], a[168:171], a[144:147], a[76:79]
v_mfma_f32_16x16x32_bf16 a[68:71], a[168:171], a[148:151], a[68:71]
ds_read_b128 a[168:171], v17 offset:31744
v_mfma_f32_16x16x32_bf16 a[4:7], a[152:155], a[148:151], a[4:7]
v_mfma_f32_16x16x32_bf16 a[12:15], a[152:155], a[144:147], a[12:15]
v_mfma_f32_16x16x32_bf16 a[20:23], a[152:155], a[140:143], a[20:23]
v_mfma_f32_16x16x32_bf16 a[28:31], a[152:155], a[136:139], a[28:31]
v_mfma_f32_16x16x32_bf16 a[36:39], a[152:155], a[132:135], a[36:39]
v_mfma_f32_16x16x32_bf16 a[44:47], a[152:155], a[128:131], a[44:47]
v_mfma_f32_16x16x32_bf16 a[52:55], a[152:155], a[124:127], a[52:55]
v_mfma_f32_16x16x32_bf16 a[60:63], a[152:155], a[120:123], a[60:63]
v_mfma_f32_16x16x32_bf16 v[88:91], a[120:123], a[156:159], v[88:91]
v_mfma_f32_16x16x32_bf16 v[96:99], a[124:127], a[156:159], v[96:99]
v_mfma_f32_16x16x32_bf16 v[104:107], a[128:131], a[156:159], v[104:107]
v_mfma_f32_16x16x32_bf16 v[112:115], a[132:135], a[156:159], v[112:115]
v_mfma_f32_16x16x32_bf16 v[120:123], a[136:139], a[156:159], v[120:123]
v_mfma_f32_16x16x32_bf16 v[128:131], a[140:143], a[156:159], v[128:131]
v_mfma_f32_16x16x32_bf16 v[136:139], a[144:147], a[156:159], v[136:139]
v_mfma_f32_16x16x32_bf16 v[144:147], a[148:151], a[156:159], v[144:147]
s_waitcnt vmcnt(8) lgkmcnt(0)
s_barrier
    s_add_u32 s64, s48, 23396352
    s_addc_u32 s65, s49, 0
    s_mov_b32 s66, 65536
    s_lshl_b32 s11, s83, 6
    v_mov_b32 v52, v53
    s_mov_b64 exec, 1
    buffer_store_dwordx2 v[52:53], v23, s[64:67], s11 offen sc0 sc1
    s_mov_b64 exec, -1
s_load_dwordx16 s[16:31], s[0:1], 0
s_load_dwordx16 s[32:47], s[0:1], 64
s_load_dwordx2 s[48:49], s[0:1], 128
v_mfma_f32_16x16x32_bf16 v[148:151], a[148:151], a[160:163], v[148:151]
v_mfma_f32_16x16x32_bf16 v[140:143], a[144:147], a[160:163], v[140:143]
v_mfma_f32_16x16x32_bf16 v[132:135], a[140:143], a[160:163], v[132:135]
v_mfma_f32_16x16x32_bf16 v[124:127], a[136:139], a[160:163], v[124:127]
v_mfma_f32_16x16x32_bf16 v[116:119], a[132:135], a[160:163], v[116:119]
v_mfma_f32_16x16x32_bf16 v[108:111], a[128:131], a[160:163], v[108:111]
v_mfma_f32_16x16x32_bf16 v[100:103], a[124:127], a[160:163], v[100:103]
v_mfma_f32_16x16x32_bf16 v[92:95], a[120:123], a[160:163], v[92:95]
v_mfma_f32_16x16x32_bf16 v[152:155], a[120:123], a[164:167], v[152:155]
v_mfma_f32_16x16x32_bf16 v[160:163], a[124:127], a[164:167], v[160:163]
v_mfma_f32_16x16x32_bf16 v[168:171], a[128:131], a[164:167], v[168:171]
v_mfma_f32_16x16x32_bf16 v[176:179], a[132:135], a[164:167], v[176:179]
v_mfma_f32_16x16x32_bf16 v[184:187], a[136:139], a[164:167], v[184:187]
v_mfma_f32_16x16x32_bf16 v[192:195], a[140:143], a[164:167], v[192:195]
v_mfma_f32_16x16x32_bf16 v[200:203], a[144:147], a[164:167], v[200:203]
v_mfma_f32_16x16x32_bf16 v[208:211], a[148:151], a[164:167], v[208:211]
v_mfma_f32_16x16x32_bf16 v[212:215], a[148:151], a[168:171], v[212:215]
v_mfma_f32_16x16x32_bf16 v[204:207], a[144:147], a[168:171], v[204:207]
v_mfma_f32_16x16x32_bf16 v[196:199], a[140:143], a[168:171], v[196:199]
v_mfma_f32_16x16x32_bf16 v[188:191], a[136:139], a[168:171], v[188:191]
v_mfma_f32_16x16x32_bf16 v[180:183], a[132:135], a[168:171], v[180:183]
v_mfma_f32_16x16x32_bf16 v[172:175], a[128:131], a[168:171], v[172:175]
v_mfma_f32_16x16x32_bf16 v[164:167], a[124:127], a[168:171], v[164:167]
v_mfma_f32_16x16x32_bf16 v[156:159], a[120:123], a[168:171], v[156:159]
s_branch L1B_epi
L1A_epi:
v_lshrrev_b32 v50, 4, v1
v_and_b32 v51, 15, v50
v_lshlrev_b32 v52, 5, v51
v_add_u32 v52, 139264, v52
ds_read_b128 v[20:23], v52
    v_lshrrev_b32 v50, 4, v50
    v_lshlrev_b32 v50, 7, v50
    v_lshl_add_u32 v50, v51, 3, v50
    s_lshl_b32 s11, s7, 10
    s_lshl_b32 s12, s8, 9
    s_add_u32 s11, s11, s12
    s_add_u32 s11, s11, 142336
    s_xor_b32 s12, s11, 512
    s_lshl_b32 s13, s8, 12
    v_add_u32 v51, s11, v50
    s_add_u32 s11, s11, s13
    s_add_u32 s12, s12, s13
    v_add_u32 v52, s11, v50
    v_add_u32 v53, s12, v50
    s_waitcnt lgkmcnt(0)
v_pk_mul_f32 v[32:33], v[22:23], v[56:57] op_sel:[0,0] op_sel_hi:[1,0]
v_pk_mul_f32 v[34:35], v[22:23], v[56:57] op_sel:[0,1] op_sel_hi:[1,1]
v_pk_mul_f32 v[36:37], v[22:23], v[58:59] op_sel:[0,0] op_sel_hi:[1,0]
v_pk_mul_f32 v[38:39], v[22:23], v[58:59] op_sel:[0,1] op_sel_hi:[1,1]
v_pk_fma_f32 v[32:33], v[22:23], v[60:61], v[32:33] op_sel:[1,0,0] op_sel_hi:[0,0,1] neg_lo:[1,0,0]
v_pk_fma_f32 v[34:35], v[22:23], v[60:61], v[34:35] op_sel:[1,1,0] op_sel_hi:[0,1,1] neg_lo:[1,0,0]
v_pk_fma_f32 v[36:37], v[22:23], v[62:63], v[36:37] op_sel:[1,0,0] op_sel_hi:[0,0,1] neg_lo:[1,0,0]
v_pk_fma_f32 v[38:39], v[22:23], v[62:63], v[38:39] op_sel:[1,1,0] op_sel_hi:[0,1,1] neg_lo:[1,0,0]
v_pk_mul_f32 v[56:57], v[22:23], v[64:65] op_sel:[0,0] op_sel_hi:[1,0]
v_pk_mul_f32 v[58:59], v[22:23], v[64:65] op_sel:[0,1] op_sel_hi:[1,1]
v_pk_mul_f32 v[60:61], v[22:23], v[66:67] op_sel:[0,0] op_sel_hi:[1,0]
v_pk_mul_f32 v[62:63], v[22:23], v[66:67] op_sel:[0,1] op_sel_hi:[1,1]
v_pk_fma_f32 v[56:57], v[22:23], v[68:69], v[56:57] op_sel:[1,0,0] op_sel_hi:[0,0,1] neg_lo:[1,0,0]
v_pk_fma_f32 v[58:59], v[22:23], v[68:69], v[58:59] op_sel:[1,1,0] op_sel_hi:[0,1,1] neg_lo:[1,0,0]
v_pk_fma_f32 v[60:61], v[22:23], v[70:71], v[60:61] op_sel:[1,0,0] op_sel_hi:[0,0,1] neg_lo:[1,0,0]
v_pk_fma_f32 v[62:63], v[22:23], v[70:71], v[62:63] op_sel:[1,1,0] op_sel_hi:[0,1,1] neg_lo:[1,0,0]
v_pk_mul_f32 v[64:65], v[22:23], v[72:73] op_sel:[0,0] op_sel_hi:[1,0]
v_pk_mul_f32 v[66:67], v[22:23], v[72:73] op_sel:[0,1] op_sel_hi:[1,1]
v_pk_mul_f32 v[68:69], v[22:23], v[74:75] op_sel:[0,0] op_sel_hi:[1,0]
v_pk_mul_f32 v[70:71], v[22:23], v[74:75] op_sel:[0,1] op_sel_hi:[1,1]
v_pk_fma_f32 v[64:65], v[22:23], v[76:77], v[64:65] op_sel:[1,0,0] op_sel_hi:[0,0,1] neg_lo:[1,0,0]
v_pk_fma_f32 v[66:67], v[22:23], v[76:77], v[66:67] op_sel:[1,1,0] op_sel_hi:[0,1,1] neg_lo:[1,0,0]
v_pk_fma_f32 v[68:69], v[22:23], v[78:79], v[68:69] op_sel:[1,0,0] op_sel_hi:[0,0,1] neg_lo:[1,0,0]
v_pk_fma_f32 v[70:71], v[22:23], v[78:79], v[70:71] op_sel:[1,1,0] op_sel_hi:[0,1,1] neg_lo:[1,0,0]
v_pk_mul_f32 v[72:73], v[22:23], v[80:81] op_sel:[0,0] op_sel_hi:[1,0]
v_pk_mul_f32 v[74:75], v[22:23], v[80:81] op_sel:[0,1] op_sel_hi:[1,1]
v_pk_mul_f32 v[76:77], v[22:23], v[82:83] op_sel:[0,0] op_sel_hi:[1,0]
v_pk_mul_f32 v[78:79], v[22:23], v[82:83] op_sel:[0,1] op_sel_hi:[1,1]
v_pk_fma_f32 v[72:73], v[22:23], v[84:85], v[72:73] op_sel:[1,0,0] op_sel_hi:[0,0,1] neg_lo:[1,0,0]
v_pk_fma_f32 v[74:75], v[22:23], v[84:85], v[74:75] op_sel:[1,1,0] op_sel_hi:[0,1,1] neg_lo:[1,0,0]
v_pk_fma_f32 v[76:77], v[22:23], v[86:87], v[76:77] op_sel:[1,0,0] op_sel_hi:[0,0,1] neg_lo:[1,0,0]
v_pk_fma_f32 v[78:79], v[22:23], v[86:87], v[78:79] op_sel:[1,1,0] op_sel_hi:[0,1,1] neg_lo:[1,0,0]
v_pk_fma_f32 v[80:81], v[20:21], v[32:33], v[34:35] op_sel:[1,1,0] op_sel_hi:[1,0,1] neg_lo:[1,0,0]
v_pk_fma_f32 v[40:41], v[20:21], v[32:33], v[80:81] op_sel:[0,0,0] op_sel_hi:[0,1,1]
v_pk_fma_f32 v[80:81], v[20:21], v[40:41], v[36:37] op_sel:[1,1,0] op_sel_hi:[1,0,1] neg_lo:[1,0,0]
v_pk_fma_f32 v[40:41], v[20:21], v[40:41], v[80:81] op_sel:[0,0,0] op_sel_hi:[0,1,1]
v_pk_fma_f32 v[80:81], v[20:21], v[40:41], v[38:39] op_sel:[1,1,0] op_sel_hi:[1,0,1] neg_lo:[1,0,0]
v_pk_fma_f32 v[40:41], v[20:21], v[40:41], v[80:81] op_sel:[0,0,0] op_sel_hi:[0,1,1]
v_pk_fma_f32 v[80:81], v[20:21], v[40:41], v[56:57] op_sel:[1,1,0] op_sel_hi:[1,0,1] neg_lo:[1,0,0]
v_pk_fma_f32 v[40:41], v[20:21], v[40:41], v[80:81] op_sel:[0,0,0] op_sel_hi:[0,1,1]
v_pk_fma_f32 v[80:81], v[20:21], v[40:41], v[58:59] op_sel:[1,1,0] op_sel_hi:[1,0,1] neg_lo:[1,0,0]
v_pk_fma_f32 v[40:41], v[20:21], v[40:41], v[80:81] op_sel:[0,0,0] op_sel_hi:[0,1,1]
v_pk_fma_f32 v[80:81], v[20:21], v[40:41], v[60:61] op_sel:[1,1,0] op_sel_hi:[1,0,1] neg_lo:[1,0,0]
v_pk_fma_f32 v[40:41], v[20:21], v[40:41], v[80:81] op_sel:[0,0,0] op_sel_hi:[0,1,1]
v_pk_fma_f32 v[80:81], v[20:21], v[40:41], v[62:63] op_sel:[1,1,0] op_sel_hi:[1,0,1] neg_lo:[1,0,0]
v_pk_fma_f32 v[40:41], v[20:21], v[40:41], v[80:81] op_sel:[0,0,0] op_sel_hi:[0,1,1]
v_pk_fma_f32 v[80:81], v[20:21], v[40:41], v[64:65] op_sel:[1,1,0] op_sel_hi:[1,0,1] neg_lo:[1,0,0]
v_pk_fma_f32 v[40:41], v[20:21], v[40:41], v[80:81] op_sel:[0,0,0] op_sel_hi:[0,1,1]
v_pk_fma_f32 v[80:81], v[20:21], v[40:41], v[66:67] op_sel:[1,1,0] op_sel_hi:[1,0,1] neg_lo:[1,0,0]
v_pk_fma_f32 v[40:41], v[20:21], v[40:41], v[80:81] op_sel:[0,0,0] op_sel_hi:[0,1,1]
v_pk_fma_f32 v[80:81], v[20:21], v[40:41], v[68:69] op_sel:[1,1,0] op_sel_hi:[1,0,1] neg_lo:[1,0,0]
v_pk_fma_f32 v[40:41], v[20:21], v[40:41], v[80:81] op_sel:[0,0,0] op_sel_hi:[0,1,1]
v_pk_fma_f32 v[80:81], v[20:21], v[40:41], v[70:71] op_sel:[1,1,0] op_sel_hi:[1,0,1] neg_lo:[1,0,0]
v_pk_fma_f32 v[40:41], v[20:21], v[40:41], v[80:81] op_sel:[0,0,0] op_sel_hi:[0,1,1]
v_pk_fma_f32 v[80:81], v[20:21], v[40:41], v[72:73] op_sel:[1,1,0] op_sel_hi:[1,0,1] neg_lo:[1,0,0]
v_pk_fma_f32 v[40:41], v[20:21], v[40:41], v[80:81] op_sel:[0,0,0] op_sel_hi:[0,1,1]
v_pk_fma_f32 v[80:81], v[20:21], v[40:41], v[74:75] op_sel:[1,1,0] op_sel_hi:[1,0,1] neg_lo:[1,0,0]
v_pk_fma_f32 v[40:41], v[20:21], v[40:41], v[80:81] op_sel:[0,0,0] op_sel_hi:[0,1,1]
v_pk_fma_f32 v[80:81], v[20:21], v[40:41], v[76:77] op_sel:[1,1,0] op_sel_hi:[1,0,1] neg_lo:[1,0,0]
v_pk_fma_f32 v[40:41], v[20:21], v[40:41], v[80:81] op_sel:[0,0,0] op_sel_hi:[0,1,1]
v_pk_fma_f32 v[80:81], v[20:21], v[40:41], v[78:79] op_sel:[1,1,0] op_sel_hi:[1,0,1] neg_lo:[1,0,0]
v_pk_fma_f32 v[40:41], v[20:21], v[40:41], v[80:81] op_sel:[0,0,0] op_sel_hi:[0,1,1]
ds_write_b64 v51, v[40:41] offset:0
s_waitcnt lgkmcnt(0)
s_barrier
v_lshrrev_b32 v48, 4, v1
v_and_b32 v48, 15, v48
    v_lshlrev_b32 v49, 5, v48
    v_add_u32 v49, 139264, v49
    ds_read_b128 v[40:43], v49 offset:16
    s_lshl_b32 s11, s6, 7
    s_lshl_b32 s12, s5, 4
    s_add_u32 s11, s11, s12
    v_add_u32 v47, s11, v48
    v_lshlrev_b32 v47, 4, v47
    s_add_u32 s64, s48, 23134208
    s_addc_u32 s65, s49, 0
    s_mov_b32 s66, 131072
    s_cmp_lt_u32 s3, 1
    s_cbranch_scc0 L1A_e2d
    v_lshrrev_b32 v46, 4, v48
    v_lshlrev_b32 v46, 11, v46
    v_and_b32 v49, 15, v48
    v_lshl_add_u32 v46, v49, 3, v46
    v_add_u32 v46, 142336, v46
    v_mov_b32 v44, 0
    v_mov_b32 v45, 0
    v_lshlrev_b32 v2, 3, v48
    v_add_u32 v2, 152576, v2
    v_mov_b32 v4, 1.0
    v_mov_b32 v5, 0
    v_mov_b32 v8, 0
    v_mov_b32 v9, 0
ds_read_b64 v[80:81], v46 offset:0
ds_read_b64 v[82:83], v46 offset:128
ds_read_b64 v[84:85], v46 offset:256
ds_read_b64 v[86:87], v46 offset:384
s_waitcnt lgkmcnt(3)
ds_write_b64 v46, v[44:45] offset:0
ds_write_b64 v2, v[4:5] offset:0
v_pk_fma_f32 v[48:49], v[40:41], v[44:45], v[80:81] op_sel:[1,1,0] op_sel_hi:[1,0,1] neg_lo:[1,0,0]
v_pk_fma_f32 v[6:7], v[40:41], v[4:5], v[8:9] op_sel:[1,1,0] op_sel_hi:[1,0,1] neg_lo:[1,0,0]
v_pk_fma_f32 v[44:45], v[40:41], v[44:45], v[48:49] op_sel:[0,0,0] op_sel_hi:[0,1,1]
v_pk_fma_f32 v[4:5], v[40:41], v[4:5], v[6:7] op_sel:[0,0,0] op_sel_hi:[0,1,1]
s_waitcnt lgkmcnt(4)
ds_write_b64 v46, v[44:45] offset:128
ds_write_b64 v2, v[4:5] offset:640
v_pk_fma_f32 v[48:49], v[40:41], v[44:45], v[82:83] op_sel:[1,1,0] op_sel_hi:[1,0,1] neg_lo:[1,0,0]
v_pk_fma_f32 v[6:7], v[40:41], v[4:5], v[8:9] op_sel:[1,1,0] op_sel_hi:[1,0,1] neg_lo:[1,0,0]
v_pk_fma_f32 v[44:45], v[40:41], v[44:45], v[48:49] op_sel:[0,0,0] op_sel_hi:[0,1,1]
v_pk_fma_f32 v[4:5], v[40:41], v[4:5], v[6:7] op_sel:[0,0,0] op_sel_hi:[0,1,1]
s_waitcnt lgkmcnt(5)
ds_write_b64 v46, v[44:45] offset:256
ds_write_b64 v2, v[4:5] offset:1280
v_pk_fma_f32 v[48:49], v[40:41], v[44:45], v[84:85] op_sel:[1,1,0] op_sel_hi:[1,0,1] neg_lo:[1,0,0]
v_pk_fma_f32 v[6:7], v[40:41], v[4:5], v[8:9] op_sel:[1,1,0] op_sel_hi:[1,0,1] neg_lo:[1,0,0]
v_pk_fma_f32 v[44:45], v[40:41], v[44:45], v[48:49] op_sel:[0,0,0] op_sel_hi:[0,1,1]
v_pk_fma_f32 v[4:5], v[40:41], v[4:5], v[6:7] op_sel:[0,0,0] op_sel_hi:[0,1,1]
s_waitcnt lgkmcnt(6)
ds_write_b64 v46, v[44:45] offset:384
ds_write_b64 v2, v[4:5] offset:1920
v_pk_fma_f32 v[48:49], v[40:41], v[44:45], v[86:87] op_sel:[1,1,0] op_sel_hi:[1,0,1] neg_lo:[1,0,0]
v_pk_fma_f32 v[6:7], v[40:41], v[4:5], v[8:9] op_sel:[1,1,0] op_sel_hi:[1,0,1] neg_lo:[1,0,0]
v_pk_fma_f32 v[44:45], v[40:41], v[44:45], v[48:49] op_sel:[0,0,0] op_sel_hi:[0,1,1]
v_pk_fma_f32 v[4:5], v[40:41], v[4:5], v[6:7] op_sel:[0,0,0] op_sel_hi:[0,1,1]
ds_read_b64 v[80:81], v46 offset:512
ds_read_b64 v[82:83], v46 offset:640
ds_read_b64 v[84:85], v46 offset:768
ds_read_b64 v[86:87], v46 offset:896
s_waitcnt lgkmcnt(3)
ds_write_b64 v46, v[44:45] offset:512
ds_write_b64 v2, v[4:5] offset:2560
v_pk_fma_f32 v[48:49], v[40:41], v[44:45], v[80:81] op_sel:[1,1,0] op_sel_hi:[1,0,1] neg_lo:[1,0,0]
v_pk_fma_f32 v[6:7], v[40:41], v[4:5], v[8:9] op_sel:[1,1,0] op_sel_hi:[1,0,1] neg_lo:[1,0,0]
v_pk_fma_f32 v[44:45], v[40:41], v[44:45], v[48:49] op_sel:[0,0,0] op_sel_hi:[0,1,1]
v_pk_fma_f32 v[4:5], v[40:41], v[4:5], v[6:7] op_sel:[0,0,0] op_sel_hi:[0,1,1]
s_waitcnt lgkmcnt(4)
ds_write_b64 v46, v[44:45] offset:640
ds_write_b64 v2, v[4:5] offset:3200
v_pk_fma_f32 v[48:49], v[40:41], v[44:45], v[82:83] op_sel:[1,1,0] op_sel_hi:[1,0,1] neg_lo:[1,0,0]
v_pk_fma_f32 v[6:7], v[40:41], v[4:5], v[8:9] op_sel:[1,1,0] op_sel_hi:[1,0,1] neg_lo:[1,0,0]
v_pk_fma_f32 v[44:45], v[40:41], v[44:45], v[48:49] op_sel:[0,0,0] op_sel_hi:[0,1,1]
v_pk_fma_f32 v[4:5], v[40:41], v[4:5], v[6:7] op_sel:[0,0,0] op_sel_hi:[0,1,1]
s_waitcnt lgkmcnt(5)
ds_write_b64 v46, v[44:45] offset:768
ds_write_b64 v2, v[4:5] offset:3840
v_pk_fma_f32 v[48:49], v[40:41], v[44:45], v[84:85] op_sel:[1,1,0] op_sel_hi:[1,0,1] neg_lo:[1,0,0]
v_pk_fma_f32 v[6:7], v[40:41], v[4:5], v[8:9] op_sel:[1,1,0] op_sel_hi:[1,0,1] neg_lo:[1,0,0]
v_pk_fma_f32 v[44:45], v[40:41], v[44:45], v[48:49] op_sel:[0,0,0] op_sel_hi:[0,1,1]
v_pk_fma_f32 v[4:5], v[40:41], v[4:5], v[6:7] op_sel:[0,0,0] op_sel_hi:[0,1,1]
s_waitcnt lgkmcnt(6)
ds_write_b64 v46, v[44:45] offset:896
ds_write_b64 v2, v[4:5] offset:4480
v_pk_fma_f32 v[48:49], v[40:41], v[44:45], v[86:87] op_sel:[1,1,0] op_sel_hi:[1,0,1] neg_lo:[1,0,0]
v_pk_fma_f32 v[6:7], v[40:41], v[4:5], v[8:9] op_sel:[1,1,0] op_sel_hi:[1,0,1] neg_lo:[1,0,0]
v_pk_fma_f32 v[44:45], v[40:41], v[44:45], v[48:49] op_sel:[0,0,0] op_sel_hi:[0,1,1]
v_pk_fma_f32 v[4:5], v[40:41], v[4:5], v[6:7] op_sel:[0,0,0] op_sel_hi:[0,1,1]
ds_read_b64 v[80:81], v46 offset:1024
ds_read_b64 v[82:83], v46 offset:1152
ds_read_b64 v[84:85], v46 offset:1280
ds_read_b64 v[86:87], v46 offset:1408
s_waitcnt lgkmcnt(3)
ds_write_b64 v46, v[44:45] offset:1024
ds_write_b64 v2, v[4:5] offset:5120
v_pk_fma_f32 v[48:49], v[40:41], v[44:45], v[80:81] op_sel:[1,1,0] op_sel_hi:[1,0,1] neg_lo:[1,0,0]
v_pk_fma_f32 v[6:7], v[40:41], v[4:5], v[8:9] op_sel:[1,1,0] op_sel_hi:[1,0,1] neg_lo:[1,0,0]
v_pk_fma_f32 v[44:45], v[40:41], v[44:45], v[48:49] op_sel:[0,0,0] op_sel_hi:[0,1,1]
v_pk_fma_f32 v[4:5], v[40:41], v[4:5], v[6:7] op_sel:[0,0,0] op_sel_hi:[0,1,1]
s_waitcnt lgkmcnt(4)
ds_write_b64 v46, v[44:45] offset:1152
ds_write_b64 v2, v[4:5] offset:5760
v_pk_fma_f32 v[48:49], v[40:41], v[44:45], v[82:83] op_sel:[1,1,0] op_sel_hi:[1,0,1] neg_lo:[1,0,0]
v_pk_fma_f32 v[6:7], v[40:41], v[4:5], v[8:9] op_sel:[1,1,0] op_sel_hi:[1,0,1] neg_lo:[1,0,0]
v_pk_fma_f32 v[44:45], v[40:41], v[44:45], v[48:49] op_sel:[0,0,0] op_sel_hi:[0,1,1]
v_pk_fma_f32 v[4:5], v[40:41], v[4:5], v[6:7] op_sel:[0,0,0] op_sel_hi:[0,1,1]
s_waitcnt lgkmcnt(5)
ds_write_b64 v46, v[44:45] offset:1280
ds_write_b64 v2, v[4:5] offset:6400
v_pk_fma_f32 v[48:49], v[40:41], v[44:45], v[84:85] op_sel:[1,1,0] op_sel_hi:[1,0,1] neg_lo:[1,0,0]
v_pk_fma_f32 v[6:7], v[40:41], v[4:5], v[8:9] op_sel:[1,1,0] op_sel_hi:[1,0,1] neg_lo:[1,0,0]
v_pk_fma_f32 v[44:45], v[40:41], v[44:45], v[48:49] op_sel:[0,0,0] op_sel_hi:[0,1,1]
v_pk_fma_f32 v[4:5], v[40:41], v[4:5], v[6:7] op_sel:[0,0,0] op_sel_hi:[0,1,1]
s_waitcnt lgkmcnt(6)
ds_write_b64 v46, v[44:45] offset:1408
ds_write_b64 v2, v[4:5] offset:7040
v_pk_fma_f32 v[48:49], v[40:41], v[44:45], v[86:87] op_sel:[1,1,0] op_sel_hi:[1,0,1] neg_lo:[1,0,0]
v_pk_fma_f32 v[6:7], v[40:41], v[4:5], v[8:9] op_sel:[1,1,0] op_sel_hi:[1,0,1] neg_lo:[1,0,0]
v_pk_fma_f32 v[44:45], v[40:41], v[44:45], v[48:49] op_sel:[0,0,0] op_sel_hi:[0,1,1]
v_pk_fma_f32 v[4:5], v[40:41], v[4:5], v[6:7] op_sel:[0,0,0] op_sel_hi:[0,1,1]
ds_read_b64 v[80:81], v46 offset:1536
ds_read_b64 v[82:83], v46 offset:1664
ds_read_b64 v[84:85], v46 offset:1792
ds_read_b64 v[86:87], v46 offset:1920
s_waitcnt lgkmcnt(3)
ds_write_b64 v46, v[44:45] offset:1536
ds_write_b64 v2, v[4:5] offset:7680
v_pk_fma_f32 v[48:49], v[40:41], v[44:45], v[80:81] op_sel:[1,1,0] op_sel_hi:[1,0,1] neg_lo:[1,0,0]
v_pk_fma_f32 v[6:7], v[40:41], v[4:5], v[8:9] op_sel:[1,1,0] op_sel_hi:[1,0,1] neg_lo:[1,0,0]
v_pk_fma_f32 v[44:45], v[40:41], v[44:45], v[48:49] op_sel:[0,0,0] op_sel_hi:[0,1,1]
v_pk_fma_f32 v[4:5], v[40:41], v[4:5], v[6:7] op_sel:[0,0,0] op_sel_hi:[0,1,1]
s_waitcnt lgkmcnt(4)
ds_write_b64 v46, v[44:45] offset:1664
ds_write_b64 v2, v[4:5] offset:8320
v_pk_fma_f32 v[48:49], v[40:41], v[44:45], v[82:83] op_sel:[1,1,0] op_sel_hi:[1,0,1] neg_lo:[1,0,0]
v_pk_fma_f32 v[6:7], v[40:41], v[4:5], v[8:9] op_sel:[1,1,0] op_sel_hi:[1,0,1] neg_lo:[1,0,0]
v_pk_fma_f32 v[44:45], v[40:41], v[44:45], v[48:49] op_sel:[0,0,0] op_sel_hi:[0,1,1]
v_pk_fma_f32 v[4:5], v[40:41], v[4:5], v[6:7] op_sel:[0,0,0] op_sel_hi:[0,1,1]
s_waitcnt lgkmcnt(5)
ds_write_b64 v46, v[44:45] offset:1792
ds_write_b64 v2, v[4:5] offset:8960
v_pk_fma_f32 v[48:49], v[40:41], v[44:45], v[84:85] op_sel:[1,1,0] op_sel_hi:[1,0,1] neg_lo:[1,0,0]
v_pk_fma_f32 v[6:7], v[40:41], v[4:5], v[8:9] op_sel:[1,1,0] op_sel_hi:[1,0,1] neg_lo:[1,0,0]
v_pk_fma_f32 v[44:45], v[40:41], v[44:45], v[48:49] op_sel:[0,0,0] op_sel_hi:[0,1,1]
v_pk_fma_f32 v[4:5], v[40:41], v[4:5], v[6:7] op_sel:[0,0,0] op_sel_hi:[0,1,1]
s_waitcnt lgkmcnt(6)
ds_write_b64 v46, v[44:45] offset:1920
ds_write_b64 v2, v[4:5] offset:9600
v_pk_fma_f32 v[48:49], v[40:41], v[44:45], v[86:87] op_sel:[1,1,0] op_sel_hi:[1,0,1] neg_lo:[1,0,0]
v_pk_fma_f32 v[6:7], v[40:41], v[4:5], v[8:9] op_sel:[1,1,0] op_sel_hi:[1,0,1] neg_lo:[1,0,0]
v_pk_fma_f32 v[44:45], v[40:41], v[44:45], v[48:49] op_sel:[0,0,0] op_sel_hi:[0,1,1]
v_pk_fma_f32 v[4:5], v[40:41], v[4:5], v[6:7] op_sel:[0,0,0] op_sel_hi:[0,1,1]
    s_lshl_b32 s11, s4, 14
    v_mov_b32 v80, v44
    v_mov_b32 v81, s98
    v_mov_b32 v82, v45
    v_mov_b32 v83, s98
s_mov_b64 exec, 0xffff
buffer_store_dwordx4 v[80:83], v47, s[64:67], s11 offen sc0 sc1
s_mov_b64 exec, -1
L1A_e2d:
s_sub_u32 s11, s4, 7
s_lshl_b32 s11, s11, 14
v_add_u32 v47, s11, v47
s_mov_b32 s92, 0xbdd2d3e8
s_mov_b32 s93, 0xbdd2d3e8
s_mov_b32 s94, 1.0
s_mov_b32 s95, 1.0
v_mov_b32 v18, 0xc0135761
v_mov_b32 v19, 0xc0135761
    s_lshl_b32 s11, s4, 1
    s_add_u32 s11, s11, s7
    s_mul_i32 s11, s11, 1441792
    s_add_u32 s56, s48, s11
    s_addc_u32 s57, s49, 0
    s_mov_b32 s58, 1441792
    s_mul_i32 s96, s8, 720896
    s_sub_u32 s97, 720896, s96
    s_mul_i32 s11, s6, 14
    s_lshl_b32 s12, s5, 2
    s_add_u32 s11, s11, s12
    s_lshl_b32 s12, s8, 1
    s_add_u32 s11, s11, s12
    s_lshl_b32 s11, s11, 10
    s_add_u32 s13, s96, s11
    s_add_u32 s14, s97, s11
v_pk_mul_f32 v[2:3], v[88:89], v[88:89]
v_pk_mul_f32 v[4:5], v[90:91], v[90:91]
v_pk_mul_f32 v[6:7], v[96:97], v[96:97]
v_pk_mul_f32 v[8:9], v[98:99], v[98:99]
v_pk_fma_f32 v[2:3], v[2:3], s[92:93], v[18:19]
v_pk_fma_f32 v[4:5], v[4:5], s[92:93], v[18:19]
v_pk_fma_f32 v[6:7], v[6:7], s[92:93], v[18:19]
v_pk_fma_f32 v[8:9], v[8:9], s[92:93], v[18:19]
v_pk_mul_f32 v[2:3], v[2:3], v[88:89]
v_pk_mul_f32 v[4:5], v[4:5], v[90:91]
v_pk_mul_f32 v[6:7], v[6:7], v[96:97]
v_pk_mul_f32 v[8:9], v[8:9], v[98:99]
v_exp_f32 v2, v2
v_exp_f32 v3, v3
v_exp_f32 v4, v4
v_exp_f32 v5, v5
v_exp_f32 v6, v6
v_exp_f32 v7, v7
v_exp_f32 v8, v8
v_exp_f32 v9, v9
v_pk_mul_f32 v[88:89], v[88:89], v[92:93]
v_pk_mul_f32 v[90:91], v[90:91], v[94:95]
v_pk_mul_f32 v[96:97], v[96:97], v[100:101]
v_pk_mul_f32 v[98:99], v[98:99], v[102:103]
v_pk_add_f32 v[2:3], v[2:3], s[94:95]
v_pk_add_f32 v[4:5], v[4:5], s[94:95]
v_pk_add_f32 v[6:7], v[6:7], s[94:95]
v_pk_add_f32 v[8:9], v[8:9], s[94:95]
v_rcp_f32 v2, v2
v_rcp_f32 v3, v3
v_rcp_f32 v4, v4
v_rcp_f32 v5, v5
v_rcp_f32 v6, v6
v_rcp_f32 v7, v7
v_rcp_f32 v8, v8
v_rcp_f32 v9, v9
s_add_u32 s11, s13, 0
v_pk_mul_f32 v[88:89], v[88:89], v[2:3]
v_pk_mul_f32 v[90:91], v[90:91], v[4:5]
v_pk_mul_f32 v[96:97], v[96:97], v[6:7]
v_pk_mul_f32 v[98:99], v[98:99], v[8:9]
v_cvt_pk_bf16_f32 v92, v88, v89
v_cvt_pk_bf16_f32 v93, v90, v91
v_cvt_pk_bf16_f32 v94, v96, v97
v_cvt_pk_bf16_f32 v95, v98, v99
buffer_store_dwordx4 v[92:95], v1, s[56:59], s11 offen sc0 sc1
v_pk_mul_f32 v[2:3], v[104:105], v[104:105]
v_pk_mul_f32 v[4:5], v[106:107], v[106:107]
v_pk_mul_f32 v[6:7], v[112:113], v[112:113]
v_pk_mul_f32 v[8:9], v[114:115], v[114:115]
v_pk_fma_f32 v[2:3], v[2:3], s[92:93], v[18:19]
v_pk_fma_f32 v[4:5], v[4:5], s[92:93], v[18:19]
v_pk_fma_f32 v[6:7], v[6:7], s[92:93], v[18:19]
v_pk_fma_f32 v[8:9], v[8:9], s[92:93], v[18:19]
v_pk_mul_f32 v[2:3], v[2:3], v[104:105]
v_pk_mul_f32 v[4:5], v[4:5], v[106:107]
v_pk_mul_f32 v[6:7], v[6:7], v[112:113]
v_pk_mul_f32 v[8:9], v[8:9], v[114:115]
v_exp_f32 v2, v2
v_exp_f32 v3, v3
v_exp_f32 v4, v4
v_exp_f32 v5, v5
v_exp_f32 v6, v6
v_exp_f32 v7, v7
v_exp_f32 v8, v8
v_exp_f32 v9, v9
s_add_u32 s52, s52, s77
s_addc_u32 s53, s53, 0
s_add_u32 m0, s76, 32768
s_nop 0
buffer_load_dwordx4 v0, s[52:55], s68 offen offset:0  lds
buffer_load_dwordx4 v0, s[52:55], s69 offen offset:1024  lds
v_pk_mul_f32 v[104:105], v[104:105], v[108:109]
v_pk_mul_f32 v[106:107], v[106:107], v[110:111]
v_pk_mul_f32 v[112:113], v[112:113], v[116:117]
v_pk_mul_f32 v[114:115], v[114:115], v[118:119]
v_pk_add_f32 v[2:3], v[2:3], s[94:95]
v_pk_add_f32 v[4:5], v[4:5], s[94:95]
v_pk_add_f32 v[6:7], v[6:7], s[94:95]
v_pk_add_f32 v[8:9], v[8:9], s[94:95]
v_rcp_f32 v2, v2
v_rcp_f32 v3, v3
v_rcp_f32 v4, v4
v_rcp_f32 v5, v5
v_rcp_f32 v6, v6
v_rcp_f32 v7, v7
v_rcp_f32 v8, v8
v_rcp_f32 v9, v9
s_add_u32 s11, s13, 1024
v_pk_mul_f32 v[104:105], v[104:105], v[2:3]
v_pk_mul_f32 v[106:107], v[106:107], v[4:5]
v_pk_mul_f32 v[112:113], v[112:113], v[6:7]
v_pk_mul_f32 v[114:115], v[114:115], v[8:9]
v_cvt_pk_bf16_f32 v108, v104, v105
v_cvt_pk_bf16_f32 v109, v106, v107
v_cvt_pk_bf16_f32 v110, v112, v113
v_cvt_pk_bf16_f32 v111, v114, v115
buffer_store_dwordx4 v[108:111], v1, s[56:59], s11 offen sc0 sc1
v_pk_mul_f32 v[2:3], v[120:121], v[120:121]
v_pk_mul_f32 v[4:5], v[122:123], v[122:123]
v_pk_mul_f32 v[6:7], v[128:129], v[128:129]
v_pk_mul_f32 v[8:9], v[130:131], v[130:131]
v_pk_fma_f32 v[2:3], v[2:3], s[92:93], v[18:19]
v_pk_fma_f32 v[4:5], v[4:5], s[92:93], v[18:19]
v_pk_fma_f32 v[6:7], v[6:7], s[92:93], v[18:19]
v_pk_fma_f32 v[8:9], v[8:9], s[92:93], v[18:19]
v_pk_mul_f32 v[2:3], v[2:3], v[120:121]
v_pk_mul_f32 v[4:5], v[4:5], v[122:123]
v_pk_mul_f32 v[6:7], v[6:7], v[128:129]
v_pk_mul_f32 v[8:9], v[8:9], v[130:131]
v_exp_f32 v2, v2
v_exp_f32 v3, v3
v_exp_f32 v4, v4
v_exp_f32 v5, v5
v_exp_f32 v6, v6
v_exp_f32 v7, v7
v_exp_f32 v8, v8
v_exp_f32 v9, v9
buffer_load_dwordx4 v0, s[52:55], s70 offen offset:2048  lds
v_pk_mul_f32 v[120:121], v[120:121], v[124:125]
v_pk_mul_f32 v[122:123], v[122:123], v[126:127]
v_pk_mul_f32 v[128:129], v[128:129], v[132:133]
v_pk_mul_f32 v[130:131], v[130:131], v[134:135]
v_pk_add_f32 v[2:3], v[2:3], s[94:95]
v_pk_add_f32 v[4:5], v[4:5], s[94:95]
v_pk_add_f32 v[6:7], v[6:7], s[94:95]
v_pk_add_f32 v[8:9], v[8:9], s[94:95]
v_rcp_f32 v2, v2
v_rcp_f32 v3, v3
v_rcp_f32 v4, v4
v_rcp_f32 v5, v5
v_rcp_f32 v6, v6
v_rcp_f32 v7, v7
v_rcp_f32 v8, v8
v_rcp_f32 v9, v9
s_add_u32 s11, s13, 180224
v_pk_mul_f32 v[120:121], v[120:121], v[2:3]
v_pk_mul_f32 v[122:123], v[122:123], v[4:5]
v_pk_mul_f32 v[128:129], v[128:129], v[6:7]
v_pk_mul_f32 v[130:131], v[130:131], v[8:9]
v_cvt_pk_bf16_f32 v124, v120, v121
v_cvt_pk_bf16_f32 v125, v122, v123
v_cvt_pk_bf16_f32 v126, v128, v129
v_cvt_pk_bf16_f32 v127, v130, v131
buffer_store_dwordx4 v[124:127], v1, s[56:59], s11 offen sc0 sc1
v_pk_mul_f32 v[2:3], v[136:137], v[136:137]
v_pk_mul_f32 v[4:5], v[138:139], v[138:139]
v_pk_mul_f32 v[6:7], v[144:145], v[144:145]
v_pk_mul_f32 v[8:9], v[146:147], v[146:147]
v_pk_fma_f32 v[2:3], v[2:3], s[92:93], v[18:19]
v_pk_fma_f32 v[4:5], v[4:5], s[92:93], v[18:19]
v_pk_fma_f32 v[6:7], v[6:7], s[92:93], v[18:19]
v_pk_fma_f32 v[8:9], v[8:9], s[92:93], v[18:19]
v_pk_mul_f32 v[2:3], v[2:3], v[136:137]
v_pk_mul_f32 v[4:5], v[4:5], v[138:139]
v_pk_mul_f32 v[6:7], v[6:7], v[144:145]
v_pk_mul_f32 v[8:9], v[8:9], v[146:147]
v_exp_f32 v2, v2
v_exp_f32 v3, v3
v_exp_f32 v4, v4
v_exp_f32 v5, v5
v_exp_f32 v6, v6
v_exp_f32 v7, v7
v_exp_f32 v8, v8
v_exp_f32 v9, v9
buffer_load_dwordx4 v0, s[52:55], s71 offen offset:3072  lds
v_pk_mul_f32 v[136:137], v[136:137], v[140:141]
v_pk_mul_f32 v[138:139], v[138:139], v[142:143]
v_pk_mul_f32 v[144:145], v[144:145], v[148:149]
v_pk_mul_f32 v[146:147], v[146:147], v[150:151]
v_pk_add_f32 v[2:3], v[2:3], s[94:95]
v_pk_add_f32 v[4:5], v[4:5], s[94:95]
v_pk_add_f32 v[6:7], v[6:7], s[94:95]
v_pk_add_f32 v[8:9], v[8:9], s[94:95]
v_rcp_f32 v2, v2
v_rcp_f32 v3, v3
v_rcp_f32 v4, v4
v_rcp_f32 v5, v5
v_rcp_f32 v6, v6
v_rcp_f32 v7, v7
v_rcp_f32 v8, v8
v_rcp_f32 v9, v9
s_add_u32 s11, s13, 181248
v_pk_mul_f32 v[136:137], v[136:137], v[2:3]
v_pk_mul_f32 v[138:139], v[138:139], v[4:5]
v_pk_mul_f32 v[144:145], v[144:145], v[6:7]
v_pk_mul_f32 v[146:147], v[146:147], v[8:9]
v_cvt_pk_bf16_f32 v140, v136, v137
v_cvt_pk_bf16_f32 v141, v138, v139
v_cvt_pk_bf16_f32 v142, v144, v145
v_cvt_pk_bf16_f32 v143, v146, v147
buffer_store_dwordx4 v[140:143], v1, s[56:59], s11 offen sc0 sc1
v_accvgpr_read_b32 v136, a80
v_accvgpr_read_b32 v137, a81
v_accvgpr_read_b32 v138, a82
v_accvgpr_read_b32 v139, a83
v_accvgpr_read_b32 v144, a84
v_accvgpr_read_b32 v145, a85
v_accvgpr_read_b32 v146, a86
v_accvgpr_read_b32 v147, a87
v_pk_mul_f32 v[2:3], v[152:153], v[152:153]
v_pk_mul_f32 v[4:5], v[154:155], v[154:155]
v_pk_mul_f32 v[6:7], v[156:157], v[156:157]
v_pk_mul_f32 v[8:9], v[158:159], v[158:159]
v_pk_fma_f32 v[2:3], v[2:3], s[92:93], v[18:19]
v_pk_fma_f32 v[4:5], v[4:5], s[92:93], v[18:19]
v_pk_fma_f32 v[6:7], v[6:7], s[92:93], v[18:19]
v_pk_fma_f32 v[8:9], v[8:9], s[92:93], v[18:19]
v_pk_mul_f32 v[2:3], v[2:3], v[152:153]
v_pk_mul_f32 v[4:5], v[4:5], v[154:155]
v_pk_mul_f32 v[6:7], v[6:7], v[156:157]
v_pk_mul_f32 v[8:9], v[8:9], v[158:159]
v_exp_f32 v2, v2
v_exp_f32 v3, v3
v_exp_f32 v4, v4
v_exp_f32 v5, v5
v_exp_f32 v6, v6
v_exp_f32 v7, v7
v_exp_f32 v8, v8
v_exp_f32 v9, v9
s_add_u32 m0, s76, 36864
s_nop 0
buffer_load_dwordx4 v0, s[52:55], s72 offen offset:0  lds
v_pk_mul_f32 v[152:153], v[152:153], v[136:137]
v_pk_mul_f32 v[154:155], v[154:155], v[138:139]
v_pk_mul_f32 v[156:157], v[156:157], v[144:145]
v_pk_mul_f32 v[158:159], v[158:159], v[146:147]
v_pk_add_f32 v[2:3], v[2:3], s[94:95]
v_pk_add_f32 v[4:5], v[4:5], s[94:95]
v_pk_add_f32 v[6:7], v[6:7], s[94:95]
v_pk_add_f32 v[8:9], v[8:9], s[94:95]
v_rcp_f32 v2, v2
v_rcp_f32 v3, v3
v_rcp_f32 v4, v4
v_rcp_f32 v5, v5
v_rcp_f32 v6, v6
v_rcp_f32 v7, v7
v_rcp_f32 v8, v8
v_rcp_f32 v9, v9
s_add_u32 s11, s13, 360448
v_pk_mul_f32 v[152:153], v[152:153], v[2:3]
v_pk_mul_f32 v[154:155], v[154:155], v[4:5]
v_pk_mul_f32 v[156:157], v[156:157], v[6:7]
v_pk_mul_f32 v[158:159], v[158:159], v[8:9]
v_cvt_pk_bf16_f32 v136, v152, v153
v_cvt_pk_bf16_f32 v137, v154, v155
v_cvt_pk_bf16_f32 v138, v156, v157
v_cvt_pk_bf16_f32 v139, v158, v159
buffer_store_dwordx4 v[136:139], v1, s[56:59], s11 offen sc0 sc1
v_pk_mul_f32 v[2:3], v[160:161], v[160:161]
v_pk_mul_f32 v[4:5], v[162:163], v[162:163]
v_pk_mul_f32 v[6:7], v[168:169], v[168:169]
v_pk_mul_f32 v[8:9], v[170:171], v[170:171]
v_pk_fma_f32 v[2:3], v[2:3], s[92:93], v[18:19]
v_pk_fma_f32 v[4:5], v[4:5], s[92:93], v[18:19]
v_pk_fma_f32 v[6:7], v[6:7], s[92:93], v[18:19]
v_pk_fma_f32 v[8:9], v[8:9], s[92:93], v[18:19]
v_pk_mul_f32 v[2:3], v[2:3], v[160:161]
v_pk_mul_f32 v[4:5], v[4:5], v[162:163]
v_pk_mul_f32 v[6:7], v[6:7], v[168:169]
v_pk_mul_f32 v[8:9], v[8:9], v[170:171]
v_exp_f32 v2, v2
v_exp_f32 v3, v3
v_exp_f32 v4, v4
v_exp_f32 v5, v5
v_exp_f32 v6, v6
v_exp_f32 v7, v7
v_exp_f32 v8, v8
v_exp_f32 v9, v9
buffer_load_dwordx4 v0, s[52:55], s73 offen offset:1024  lds
v_pk_mul_f32 v[160:161], v[160:161], v[164:165]
v_pk_mul_f32 v[162:163], v[162:163], v[166:167]
v_pk_mul_f32 v[168:169], v[168:169], v[172:173]
v_pk_mul_f32 v[170:171], v[170:171], v[174:175]
v_pk_add_f32 v[2:3], v[2:3], s[94:95]
v_pk_add_f32 v[4:5], v[4:5], s[94:95]
v_pk_add_f32 v[6:7], v[6:7], s[94:95]
v_pk_add_f32 v[8:9], v[8:9], s[94:95]
v_rcp_f32 v2, v2
v_rcp_f32 v3, v3
v_rcp_f32 v4, v4
v_rcp_f32 v5, v5
v_rcp_f32 v6, v6
v_rcp_f32 v7, v7
v_rcp_f32 v8, v8
v_rcp_f32 v9, v9
s_add_u32 s11, s13, 361472
v_pk_mul_f32 v[160:161], v[160:161], v[2:3]
v_pk_mul_f32 v[162:163], v[162:163], v[4:5]
v_pk_mul_f32 v[168:169], v[168:169], v[6:7]
v_pk_mul_f32 v[170:171], v[170:171], v[8:9]
v_cvt_pk_bf16_f32 v164, v160, v161
v_cvt_pk_bf16_f32 v165, v162, v163
v_cvt_pk_bf16_f32 v166, v168, v169
v_cvt_pk_bf16_f32 v167, v170, v171
buffer_store_dwordx4 v[164:167], v1, s[56:59], s11 offen sc0 sc1
v_accvgpr_read_b32 v160, a64
v_accvgpr_read_b32 v161, a65
v_accvgpr_read_b32 v162, a66
v_accvgpr_read_b32 v163, a67
v_accvgpr_read_b32 v168, a68
v_accvgpr_read_b32 v169, a69
v_accvgpr_read_b32 v170, a70
v_accvgpr_read_b32 v171, a71
v_pk_mul_f32 v[2:3], v[176:177], v[176:177]
v_pk_mul_f32 v[4:5], v[178:179], v[178:179]
v_pk_mul_f32 v[6:7], v[180:181], v[180:181]
v_pk_mul_f32 v[8:9], v[182:183], v[182:183]
v_pk_fma_f32 v[2:3], v[2:3], s[92:93], v[18:19]
v_pk_fma_f32 v[4:5], v[4:5], s[92:93], v[18:19]
v_pk_fma_f32 v[6:7], v[6:7], s[92:93], v[18:19]
v_pk_fma_f32 v[8:9], v[8:9], s[92:93], v[18:19]
v_pk_mul_f32 v[2:3], v[2:3], v[176:177]
v_pk_mul_f32 v[4:5], v[4:5], v[178:179]
v_pk_mul_f32 v[6:7], v[6:7], v[180:181]
v_pk_mul_f32 v[8:9], v[8:9], v[182:183]
v_exp_f32 v2, v2
v_exp_f32 v3, v3
v_exp_f32 v4, v4
v_exp_f32 v5, v5
v_exp_f32 v6, v6
v_exp_f32 v7, v7
v_exp_f32 v8, v8
v_exp_f32 v9, v9
buffer_load_dwordx4 v0, s[52:55], s74 offen offset:2048  lds
v_pk_mul_f32 v[176:177], v[176:177], v[160:161]
v_pk_mul_f32 v[178:179], v[178:179], v[162:163]
v_pk_mul_f32 v[180:181], v[180:181], v[168:169]
v_pk_mul_f32 v[182:183], v[182:183], v[170:171]
v_pk_add_f32 v[2:3], v[2:3], s[94:95]
v_pk_add_f32 v[4:5], v[4:5], s[94:95]
v_pk_add_f32 v[6:7], v[6:7], s[94:95]
v_pk_add_f32 v[8:9], v[8:9], s[94:95]
v_rcp_f32 v2, v2
v_rcp_f32 v3, v3
v_rcp_f32 v4, v4
v_rcp_f32 v5, v5
v_rcp_f32 v6, v6
v_rcp_f32 v7, v7
v_rcp_f32 v8, v8
v_rcp_f32 v9, v9
s_add_u32 s11, s13, 540672
v_pk_mul_f32 v[176:177], v[176:177], v[2:3]
v_pk_mul_f32 v[178:179], v[178:179], v[4:5]
v_pk_mul_f32 v[180:181], v[180:181], v[6:7]
v_pk_mul_f32 v[182:183], v[182:183], v[8:9]
v_cvt_pk_bf16_f32 v160, v176, v177
v_cvt_pk_bf16_f32 v161, v178, v179
v_cvt_pk_bf16_f32 v162, v180, v181
v_cvt_pk_bf16_f32 v163, v182, v183
buffer_store_dwordx4 v[160:163], v1, s[56:59], s11 offen sc0 sc1
v_accvgpr_read_b32 v176, a72
v_accvgpr_read_b32 v177, a73
v_accvgpr_read_b32 v178, a74
v_accvgpr_read_b32 v179, a75
v_accvgpr_read_b32 v180, a76
v_accvgpr_read_b32 v181, a77
v_accvgpr_read_b32 v182, a78
v_accvgpr_read_b32 v183, a79
v_pk_mul_f32 v[2:3], v[184:185], v[184:185]
v_pk_mul_f32 v[4:5], v[186:187], v[186:187]
v_pk_mul_f32 v[6:7], v[188:189], v[188:189]
v_pk_mul_f32 v[8:9], v[190:191], v[190:191]
v_pk_fma_f32 v[2:3], v[2:3], s[92:93], v[18:19]
v_pk_fma_f32 v[4:5], v[4:5], s[92:93], v[18:19]
v_pk_fma_f32 v[6:7], v[6:7], s[92:93], v[18:19]
v_pk_fma_f32 v[8:9], v[8:9], s[92:93], v[18:19]
v_pk_mul_f32 v[2:3], v[2:3], v[184:185]
v_pk_mul_f32 v[4:5], v[4:5], v[186:187]
v_pk_mul_f32 v[6:7], v[6:7], v[188:189]
v_pk_mul_f32 v[8:9], v[8:9], v[190:191]
v_exp_f32 v2, v2
v_exp_f32 v3, v3
v_exp_f32 v4, v4
v_exp_f32 v5, v5
v_exp_f32 v6, v6
v_exp_f32 v7, v7
v_exp_f32 v8, v8
v_exp_f32 v9, v9
buffer_load_dwordx4 v0, s[52:55], s75 offen offset:3072  lds
v_pk_mul_f32 v[184:185], v[184:185], v[176:177]
v_pk_mul_f32 v[186:187], v[186:187], v[178:179]
v_pk_mul_f32 v[188:189], v[188:189], v[180:181]
v_pk_mul_f32 v[190:191], v[190:191], v[182:183]
v_pk_add_f32 v[2:3], v[2:3], s[94:95]
v_pk_add_f32 v[4:5], v[4:5], s[94:95]
v_pk_add_f32 v[6:7], v[6:7], s[94:95]
v_pk_add_f32 v[8:9], v[8:9], s[94:95]
v_rcp_f32 v2, v2
v_rcp_f32 v3, v3
v_rcp_f32 v4, v4
v_rcp_f32 v5, v5
v_rcp_f32 v6, v6
v_rcp_f32 v7, v7
v_rcp_f32 v8, v8
v_rcp_f32 v9, v9
s_add_u32 s11, s13, 541696
v_pk_mul_f32 v[184:185], v[184:185], v[2:3]
v_pk_mul_f32 v[186:187], v[186:187], v[4:5]
v_pk_mul_f32 v[188:189], v[188:189], v[6:7]
v_pk_mul_f32 v[190:191], v[190:191], v[8:9]
v_cvt_pk_bf16_f32 v176, v184, v185
v_cvt_pk_bf16_f32 v177, v186, v187
v_cvt_pk_bf16_f32 v178, v188, v189
v_cvt_pk_bf16_f32 v179, v190, v191
buffer_store_dwordx4 v[176:179], v1, s[56:59], s11 offen sc0 sc1
v_accvgpr_read_b32 v184, a48
v_accvgpr_read_b32 v185, a49
v_accvgpr_read_b32 v186, a50
v_accvgpr_read_b32 v187, a51
v_accvgpr_read_b32 v188, a52
v_accvgpr_read_b32 v189, a53
v_accvgpr_read_b32 v190, a54
v_accvgpr_read_b32 v191, a55
v_pk_mul_f32 v[2:3], v[192:193], v[192:193]
v_pk_mul_f32 v[4:5], v[194:195], v[194:195]
v_pk_mul_f32 v[6:7], v[196:197], v[196:197]
v_pk_mul_f32 v[8:9], v[198:199], v[198:199]
v_pk_fma_f32 v[2:3], v[2:3], s[92:93], v[18:19]
v_pk_fma_f32 v[4:5], v[4:5], s[92:93], v[18:19]
v_pk_fma_f32 v[6:7], v[6:7], s[92:93], v[18:19]
v_pk_fma_f32 v[8:9], v[8:9], s[92:93], v[18:19]
v_pk_mul_f32 v[2:3], v[2:3], v[192:193]
v_pk_mul_f32 v[4:5], v[4:5], v[194:195]
v_pk_mul_f32 v[6:7], v[6:7], v[196:197]
v_pk_mul_f32 v[8:9], v[8:9], v[198:199]
v_exp_f32 v2, v2
v_exp_f32 v3, v3
v_exp_f32 v4, v4
v_exp_f32 v5, v5
v_exp_f32 v6, v6
v_exp_f32 v7, v7
v_exp_f32 v8, v8
v_exp_f32 v9, v9
s_add_u32 s52, s52, s77
s_addc_u32 s53, s53, 0
s_add_u32 m0, s76, 65536
s_nop 0
buffer_load_dwordx4 v0, s[52:55], s68 offen offset:0  lds
v_pk_mul_f32 v[192:193], v[192:193], v[184:185]
v_pk_mul_f32 v[194:195], v[194:195], v[186:187]
v_pk_mul_f32 v[196:197], v[196:197], v[188:189]
v_pk_mul_f32 v[198:199], v[198:199], v[190:191]
v_pk_add_f32 v[2:3], v[2:3], s[94:95]
v_pk_add_f32 v[4:5], v[4:5], s[94:95]
v_pk_add_f32 v[6:7], v[6:7], s[94:95]
v_pk_add_f32 v[8:9], v[8:9], s[94:95]
v_rcp_f32 v2, v2
v_rcp_f32 v3, v3
v_rcp_f32 v4, v4
v_rcp_f32 v5, v5
v_rcp_f32 v6, v6
v_rcp_f32 v7, v7
v_rcp_f32 v8, v8
v_rcp_f32 v9, v9
s_add_u32 s11, s14, 0
v_pk_mul_f32 v[192:193], v[192:193], v[2:3]
v_pk_mul_f32 v[194:195], v[194:195], v[4:5]
v_pk_mul_f32 v[196:197], v[196:197], v[6:7]
v_pk_mul_f32 v[198:199], v[198:199], v[8:9]
v_cvt_pk_bf16_f32 v184, v192, v193
v_cvt_pk_bf16_f32 v185, v194, v195
v_cvt_pk_bf16_f32 v186, v196, v197
v_cvt_pk_bf16_f32 v187, v198, v199
buffer_store_dwordx4 v[184:187], v1, s[56:59], s11 offen sc0 sc1
v_accvgpr_read_b32 v192, a56
v_accvgpr_read_b32 v193, a57
v_accvgpr_read_b32 v194, a58
v_accvgpr_read_b32 v195, a59
v_accvgpr_read_b32 v196, a60
v_accvgpr_read_b32 v197, a61
v_accvgpr_read_b32 v198, a62
v_accvgpr_read_b32 v199, a63
v_pk_mul_f32 v[2:3], v[200:201], v[200:201]
v_pk_mul_f32 v[4:5], v[202:203], v[202:203]
v_pk_mul_f32 v[6:7], v[204:205], v[204:205]
v_pk_mul_f32 v[8:9], v[206:207], v[206:207]
v_pk_fma_f32 v[2:3], v[2:3], s[92:93], v[18:19]
v_pk_fma_f32 v[4:5], v[4:5], s[92:93], v[18:19]
v_pk_fma_f32 v[6:7], v[6:7], s[92:93], v[18:19]
v_pk_fma_f32 v[8:9], v[8:9], s[92:93], v[18:19]
v_pk_mul_f32 v[2:3], v[2:3], v[200:201]
v_pk_mul_f32 v[4:5], v[4:5], v[202:203]
v_pk_mul_f32 v[6:7], v[6:7], v[204:205]
v_pk_mul_f32 v[8:9], v[8:9], v[206:207]
v_exp_f32 v2, v2
v_exp_f32 v3, v3
v_exp_f32 v4, v4
v_exp_f32 v5, v5
v_exp_f32 v6, v6
v_exp_f32 v7, v7
v_exp_f32 v8, v8
v_exp_f32 v9, v9
buffer_load_dwordx4 v0, s[52:55], s69 offen offset:1024  lds
v_pk_mul_f32 v[200:201], v[200:201], v[192:193]
v_pk_mul_f32 v[202:203], v[202:203], v[194:195]
v_pk_mul_f32 v[204:205], v[204:205], v[196:197]
v_pk_mul_f32 v[206:207], v[206:207], v[198:199]
v_pk_add_f32 v[2:3], v[2:3], s[94:95]
v_pk_add_f32 v[4:5], v[4:5], s[94:95]
v_pk_add_f32 v[6:7], v[6:7], s[94:95]
v_pk_add_f32 v[8:9], v[8:9], s[94:95]
v_rcp_f32 v2, v2
v_rcp_f32 v3, v3
v_rcp_f32 v4, v4
v_rcp_f32 v5, v5
v_rcp_f32 v6, v6
v_rcp_f32 v7, v7
v_rcp_f32 v8, v8
v_rcp_f32 v9, v9
s_add_u32 s11, s14, 1024
v_pk_mul_f32 v[200:201], v[200:201], v[2:3]
v_pk_mul_f32 v[202:203], v[202:203], v[4:5]
v_pk_mul_f32 v[204:205], v[204:205], v[6:7]
v_pk_mul_f32 v[206:207], v[206:207], v[8:9]
v_cvt_pk_bf16_f32 v192, v200, v201
v_cvt_pk_bf16_f32 v193, v202, v203
v_cvt_pk_bf16_f32 v194, v204, v205
v_cvt_pk_bf16_f32 v195, v206, v207
buffer_store_dwordx4 v[192:195], v1, s[56:59], s11 offen sc0 sc1
v_accvgpr_read_b32 v200, a32
v_accvgpr_read_b32 v201, a33
v_accvgpr_read_b32 v202, a34
v_accvgpr_read_b32 v203, a35
v_accvgpr_read_b32 v204, a36
v_accvgpr_read_b32 v205, a37
v_accvgpr_read_b32 v206, a38
v_accvgpr_read_b32 v207, a39
v_pk_mul_f32 v[2:3], v[208:209], v[208:209]
v_pk_mul_f32 v[4:5], v[210:211], v[210:211]
v_pk_mul_f32 v[6:7], v[212:213], v[212:213]
v_pk_mul_f32 v[8:9], v[214:215], v[214:215]
v_pk_fma_f32 v[2:3], v[2:3], s[92:93], v[18:19]
v_pk_fma_f32 v[4:5], v[4:5], s[92:93], v[18:19]
v_pk_fma_f32 v[6:7], v[6:7], s[92:93], v[18:19]
v_pk_fma_f32 v[8:9], v[8:9], s[92:93], v[18:19]
v_pk_mul_f32 v[2:3], v[2:3], v[208:209]
v_pk_mul_f32 v[4:5], v[4:5], v[210:211]
v_pk_mul_f32 v[6:7], v[6:7], v[212:213]
v_pk_mul_f32 v[8:9], v[8:9], v[214:215]
v_exp_f32 v2, v2
v_exp_f32 v3, v3
v_exp_f32 v4, v4
v_exp_f32 v5, v5
v_exp_f32 v6, v6
v_exp_f32 v7, v7
v_exp_f32 v8, v8
v_exp_f32 v9, v9
buffer_load_dwordx4 v0, s[52:55], s70 offen offset:2048  lds
v_pk_mul_f32 v[208:209], v[208:209], v[200:201]
v_pk_mul_f32 v[210:211], v[210:211], v[202:203]
v_pk_mul_f32 v[212:213], v[212:213], v[204:205]
v_pk_mul_f32 v[214:215], v[214:215], v[206:207]
v_pk_add_f32 v[2:3], v[2:3], s[94:95]
v_pk_add_f32 v[4:5], v[4:5], s[94:95]
v_pk_add_f32 v[6:7], v[6:7], s[94:95]
v_pk_add_f32 v[8:9], v[8:9], s[94:95]
v_rcp_f32 v2, v2
v_rcp_f32 v3, v3
v_rcp_f32 v4, v4
v_rcp_f32 v5, v5
v_rcp_f32 v6, v6
v_rcp_f32 v7, v7
v_rcp_f32 v8, v8
v_rcp_f32 v9, v9
s_add_u32 s11, s14, 180224
v_pk_mul_f32 v[208:209], v[208:209], v[2:3]
v_pk_mul_f32 v[210:211], v[210:211], v[4:5]
v_pk_mul_f32 v[212:213], v[212:213], v[6:7]
v_pk_mul_f32 v[214:215], v[214:215], v[8:9]
v_cvt_pk_bf16_f32 v200, v208, v209
v_cvt_pk_bf16_f32 v201, v210, v211
v_cvt_pk_bf16_f32 v202, v212, v213
v_cvt_pk_bf16_f32 v203, v214, v215
buffer_store_dwordx4 v[200:203], v1, s[56:59], s11 offen sc0 sc1
v_accvgpr_read_b32 v208, a40
v_accvgpr_read_b32 v209, a41
v_accvgpr_read_b32 v210, a42
v_accvgpr_read_b32 v211, a43
v_accvgpr_read_b32 v212, a44
v_accvgpr_read_b32 v213, a45
v_accvgpr_read_b32 v214, a46
v_accvgpr_read_b32 v215, a47
v_pk_mul_f32 v[2:3], v[216:217], v[216:217]
v_pk_mul_f32 v[4:5], v[218:219], v[218:219]
v_pk_mul_f32 v[6:7], v[220:221], v[220:221]
v_pk_mul_f32 v[8:9], v[222:223], v[222:223]
v_pk_fma_f32 v[2:3], v[2:3], s[92:93], v[18:19]
v_pk_fma_f32 v[4:5], v[4:5], s[92:93], v[18:19]
v_pk_fma_f32 v[6:7], v[6:7], s[92:93], v[18:19]
v_pk_fma_f32 v[8:9], v[8:9], s[92:93], v[18:19]
v_pk_mul_f32 v[2:3], v[2:3], v[216:217]
v_pk_mul_f32 v[4:5], v[4:5], v[218:219]
v_pk_mul_f32 v[6:7], v[6:7], v[220:221]
v_pk_mul_f32 v[8:9], v[8:9], v[222:223]
v_exp_f32 v2, v2
v_exp_f32 v3, v3
v_exp_f32 v4, v4
v_exp_f32 v5, v5
v_exp_f32 v6, v6
v_exp_f32 v7, v7
v_exp_f32 v8, v8
v_exp_f32 v9, v9
buffer_load_dwordx4 v0, s[52:55], s71 offen offset:3072  lds
v_pk_mul_f32 v[216:217], v[216:217], v[208:209]
v_pk_mul_f32 v[218:219], v[218:219], v[210:211]
v_pk_mul_f32 v[220:221], v[220:221], v[212:213]
v_pk_mul_f32 v[222:223], v[222:223], v[214:215]
v_pk_add_f32 v[2:3], v[2:3], s[94:95]
v_pk_add_f32 v[4:5], v[4:5], s[94:95]
v_pk_add_f32 v[6:7], v[6:7], s[94:95]
v_pk_add_f32 v[8:9], v[8:9], s[94:95]
v_rcp_f32 v2, v2
v_rcp_f32 v3, v3
v_rcp_f32 v4, v4
v_rcp_f32 v5, v5
v_rcp_f32 v6, v6
v_rcp_f32 v7, v7
v_rcp_f32 v8, v8
v_rcp_f32 v9, v9
s_add_u32 s11, s14, 181248
v_pk_mul_f32 v[216:217], v[216:217], v[2:3]
v_pk_mul_f32 v[218:219], v[218:219], v[4:5]
v_pk_mul_f32 v[220:221], v[220:221], v[6:7]
v_pk_mul_f32 v[222:223], v[222:223], v[8:9]
v_cvt_pk_bf16_f32 v208, v216, v217
v_cvt_pk_bf16_f32 v209, v218, v219
v_cvt_pk_bf16_f32 v210, v220, v221
v_cvt_pk_bf16_f32 v211, v222, v223
buffer_store_dwordx4 v[208:211], v1, s[56:59], s11 offen sc0 sc1
s_sub_u32 s11, s3, 2
s_cmp_lt_u32 s11, 1
s_cbranch_scc0 L1A_nopoll
v_add_u32 v48, 0, v47
buffer_load_dwordx4 v[10:13], v48, s[64:67], 0 offen sc0 sc1
v_add_u32 v48, 16384, v47
buffer_load_dwordx4 v[14:17], v48, s[64:67], 0 offen sc0 sc1
v_add_u32 v48, 32768, v47
buffer_load_dwordx4 v[92:95], v48, s[64:67], 0 offen sc0 sc1
v_add_u32 v48, 49152, v47
buffer_load_dwordx4 v[100:103], v48, s[64:67], 0 offen sc0 sc1
v_add_u32 v48, 65536, v47
buffer_load_dwordx4 v[96:99], v48, s[64:67], 0 offen sc0 sc1
v_add_u32 v48, 81920, v47
buffer_load_dwordx4 v[88:91], v48, s[64:67], 0 offen sc0 sc1
v_add_u32 v48, 98304, v47
buffer_load_dwordx4 v[108:111], v48, s[64:67], 0 offen sc0 sc1
L1A_nopoll:
v_accvgpr_read_b32 v216, a16
v_accvgpr_read_b32 v217, a17
v_accvgpr_read_b32 v218, a18
v_accvgpr_read_b32 v219, a19
v_accvgpr_read_b32 v220, a20
v_accvgpr_read_b32 v221, a21
v_accvgpr_read_b32 v222, a22
v_accvgpr_read_b32 v223, a23
v_pk_mul_f32 v[2:3], v[224:225], v[224:225]
v_pk_mul_f32 v[4:5], v[226:227], v[226:227]
v_pk_mul_f32 v[6:7], v[228:229], v[228:229]
v_pk_mul_f32 v[8:9], v[230:231], v[230:231]
v_pk_fma_f32 v[2:3], v[2:3], s[92:93], v[18:19]
v_pk_fma_f32 v[4:5], v[4:5], s[92:93], v[18:19]
v_pk_fma_f32 v[6:7], v[6:7], s[92:93], v[18:19]
v_pk_fma_f32 v[8:9], v[8:9], s[92:93], v[18:19]
v_pk_mul_f32 v[2:3], v[2:3], v[224:225]
v_pk_mul_f32 v[4:5], v[4:5], v[226:227]
v_pk_mul_f32 v[6:7], v[6:7], v[228:229]
v_pk_mul_f32 v[8:9], v[8:9], v[230:231]
v_exp_f32 v2, v2
v_exp_f32 v3, v3
v_exp_f32 v4, v4
v_exp_f32 v5, v5
v_exp_f32 v6, v6
v_exp_f32 v7, v7
v_exp_f32 v8, v8
v_exp_f32 v9, v9
s_add_u32 m0, s76, 69632
s_nop 0
buffer_load_dwordx4 v0, s[52:55], s72 offen offset:0  lds
v_pk_mul_f32 v[224:225], v[224:225], v[216:217]
v_pk_mul_f32 v[226:227], v[226:227], v[218:219]
v_pk_mul_f32 v[228:229], v[228:229], v[220:221]
v_pk_mul_f32 v[230:231], v[230:231], v[222:223]
v_pk_add_f32 v[2:3], v[2:3], s[94:95]
v_pk_add_f32 v[4:5], v[4:5], s[94:95]
v_pk_add_f32 v[6:7], v[6:7], s[94:95]
v_pk_add_f32 v[8:9], v[8:9], s[94:95]
v_rcp_f32 v2, v2
v_rcp_f32 v3, v3
v_rcp_f32 v4, v4
v_rcp_f32 v5, v5
v_rcp_f32 v6, v6
v_rcp_f32 v7, v7
v_rcp_f32 v8, v8
v_rcp_f32 v9, v9
s_add_u32 s11, s14, 360448
v_pk_mul_f32 v[224:225], v[224:225], v[2:3]
v_pk_mul_f32 v[226:227], v[226:227], v[4:5]
v_pk_mul_f32 v[228:229], v[228:229], v[6:7]
v_pk_mul_f32 v[230:231], v[230:231], v[8:9]
v_cvt_pk_bf16_f32 v216, v224, v225
v_cvt_pk_bf16_f32 v217, v226, v227
v_cvt_pk_bf16_f32 v218, v228, v229
v_cvt_pk_bf16_f32 v219, v230, v231
buffer_store_dwordx4 v[216:219], v1, s[56:59], s11 offen sc0 sc1
v_accvgpr_read_b32 v224, a24
v_accvgpr_read_b32 v225, a25
v_accvgpr_read_b32 v226, a26
v_accvgpr_read_b32 v227, a27
v_accvgpr_read_b32 v228, a28
v_accvgpr_read_b32 v229, a29
v_accvgpr_read_b32 v230, a30
v_accvgpr_read_b32 v231, a31
v_pk_mul_f32 v[2:3], v[232:233], v[232:233]
v_pk_mul_f32 v[4:5], v[234:235], v[234:235]
v_pk_mul_f32 v[6:7], v[236:237], v[236:237]
v_pk_mul_f32 v[8:9], v[238:239], v[238:239]
v_pk_fma_f32 v[2:3], v[2:3], s[92:93], v[18:19]
v_pk_fma_f32 v[4:5], v[4:5], s[92:93], v[18:19]
v_pk_fma_f32 v[6:7], v[6:7], s[92:93], v[18:19]
v_pk_fma_f32 v[8:9], v[8:9], s[92:93], v[18:19]
v_pk_mul_f32 v[2:3], v[2:3], v[232:233]
v_pk_mul_f32 v[4:5], v[4:5], v[234:235]
v_pk_mul_f32 v[6:7], v[6:7], v[236:237]
v_pk_mul_f32 v[8:9], v[8:9], v[238:239]
v_exp_f32 v2, v2
v_exp_f32 v3, v3
v_exp_f32 v4, v4
v_exp_f32 v5, v5
v_exp_f32 v6, v6
v_exp_f32 v7, v7
v_exp_f32 v8, v8
v_exp_f32 v9, v9
buffer_load_dwordx4 v0, s[52:55], s73 offen offset:1024  lds
v_pk_mul_f32 v[232:233], v[232:233], v[224:225]
v_pk_mul_f32 v[234:235], v[234:235], v[226:227]
v_pk_mul_f32 v[236:237], v[236:237], v[228:229]
v_pk_mul_f32 v[238:239], v[238:239], v[230:231]
v_pk_add_f32 v[2:3], v[2:3], s[94:95]
v_pk_add_f32 v[4:5], v[4:5], s[94:95]
v_pk_add_f32 v[6:7], v[6:7], s[94:95]
v_pk_add_f32 v[8:9], v[8:9], s[94:95]
v_rcp_f32 v2, v2
v_rcp_f32 v3, v3
v_rcp_f32 v4, v4
v_rcp_f32 v5, v5
v_rcp_f32 v6, v6
v_rcp_f32 v7, v7
v_rcp_f32 v8, v8
v_rcp_f32 v9, v9
s_add_u32 s11, s14, 361472
v_pk_mul_f32 v[232:233], v[232:233], v[2:3]
v_pk_mul_f32 v[234:235], v[234:235], v[4:5]
v_pk_mul_f32 v[236:237], v[236:237], v[6:7]
v_pk_mul_f32 v[238:239], v[238:239], v[8:9]
v_cvt_pk_bf16_f32 v224, v232, v233
v_cvt_pk_bf16_f32 v225, v234, v235
v_cvt_pk_bf16_f32 v226, v236, v237
v_cvt_pk_bf16_f32 v227, v238, v239
buffer_store_dwordx4 v[224:227], v1, s[56:59], s11 offen sc0 sc1
v_accvgpr_read_b32 v232, a0
v_accvgpr_read_b32 v233, a1
v_accvgpr_read_b32 v234, a2
v_accvgpr_read_b32 v235, a3
v_accvgpr_read_b32 v236, a4
v_accvgpr_read_b32 v237, a5
v_accvgpr_read_b32 v238, a6
v_accvgpr_read_b32 v239, a7
v_pk_mul_f32 v[2:3], v[240:241], v[240:241]
v_pk_mul_f32 v[4:5], v[242:243], v[242:243]
v_pk_mul_f32 v[6:7], v[244:245], v[244:245]
v_pk_mul_f32 v[8:9], v[246:247], v[246:247]
v_pk_fma_f32 v[2:3], v[2:3], s[92:93], v[18:19]
v_pk_fma_f32 v[4:5], v[4:5], s[92:93], v[18:19]
v_pk_fma_f32 v[6:7], v[6:7], s[92:93], v[18:19]
v_pk_fma_f32 v[8:9], v[8:9], s[92:93], v[18:19]
v_pk_mul_f32 v[2:3], v[2:3], v[240:241]
v_pk_mul_f32 v[4:5], v[4:5], v[242:243]
v_pk_mul_f32 v[6:7], v[6:7], v[244:245]
v_pk_mul_f32 v[8:9], v[8:9], v[246:247]
v_exp_f32 v2, v2
v_exp_f32 v3, v3
v_exp_f32 v4, v4
v_exp_f32 v5, v5
v_exp_f32 v6, v6
v_exp_f32 v7, v7
v_exp_f32 v8, v8
v_exp_f32 v9, v9
buffer_load_dwordx4 v0, s[52:55], s74 offen offset:2048  lds
v_pk_mul_f32 v[240:241], v[240:241], v[232:233]
v_pk_mul_f32 v[242:243], v[242:243], v[234:235]
v_pk_mul_f32 v[244:245], v[244:245], v[236:237]
v_pk_mul_f32 v[246:247], v[246:247], v[238:239]
v_pk_add_f32 v[2:3], v[2:3], s[94:95]
v_pk_add_f32 v[4:5], v[4:5], s[94:95]
v_pk_add_f32 v[6:7], v[6:7], s[94:95]
v_pk_add_f32 v[8:9], v[8:9], s[94:95]
v_rcp_f32 v2, v2
v_rcp_f32 v3, v3
v_rcp_f32 v4, v4
v_rcp_f32 v5, v5
v_rcp_f32 v6, v6
v_rcp_f32 v7, v7
v_rcp_f32 v8, v8
v_rcp_f32 v9, v9
s_add_u32 s11, s14, 540672
v_pk_mul_f32 v[240:241], v[240:241], v[2:3]
v_pk_mul_f32 v[242:243], v[242:243], v[4:5]
v_pk_mul_f32 v[244:245], v[244:245], v[6:7]
v_pk_mul_f32 v[246:247], v[246:247], v[8:9]
v_cvt_pk_bf16_f32 v232, v240, v241
v_cvt_pk_bf16_f32 v233, v242, v243
v_cvt_pk_bf16_f32 v234, v244, v245
v_cvt_pk_bf16_f32 v235, v246, v247
buffer_store_dwordx4 v[232:235], v1, s[56:59], s11 offen sc0 sc1
v_accvgpr_read_b32 v240, a8
v_accvgpr_read_b32 v241, a9
v_accvgpr_read_b32 v242, a10
v_accvgpr_read_b32 v243, a11
v_accvgpr_read_b32 v244, a12
v_accvgpr_read_b32 v245, a13
v_accvgpr_read_b32 v246, a14
v_accvgpr_read_b32 v247, a15
v_pk_mul_f32 v[2:3], v[248:249], v[248:249]
v_pk_mul_f32 v[4:5], v[250:251], v[250:251]
v_pk_mul_f32 v[6:7], v[252:253], v[252:253]
v_pk_mul_f32 v[8:9], v[254:255], v[254:255]
v_pk_fma_f32 v[2:3], v[2:3], s[92:93], v[18:19]
v_pk_fma_f32 v[4:5], v[4:5], s[92:93], v[18:19]
v_pk_fma_f32 v[6:7], v[6:7], s[92:93], v[18:19]
v_pk_fma_f32 v[8:9], v[8:9], s[92:93], v[18:19]
v_pk_mul_f32 v[2:3], v[2:3], v[248:249]
v_pk_mul_f32 v[4:5], v[4:5], v[250:251]
v_pk_mul_f32 v[6:7], v[6:7], v[252:253]
v_pk_mul_f32 v[8:9], v[8:9], v[254:255]
v_exp_f32 v2, v2
v_exp_f32 v3, v3
v_exp_f32 v4, v4
v_exp_f32 v5, v5
v_exp_f32 v6, v6
v_exp_f32 v7, v7
v_exp_f32 v8, v8
v_exp_f32 v9, v9
buffer_load_dwordx4 v0, s[52:55], s75 offen offset:3072  lds
v_pk_mul_f32 v[248:249], v[248:249], v[240:241]
v_pk_mul_f32 v[250:251], v[250:251], v[242:243]
v_pk_mul_f32 v[252:253], v[252:253], v[244:245]
v_pk_mul_f32 v[254:255], v[254:255], v[246:247]
v_pk_add_f32 v[2:3], v[2:3], s[94:95]
v_pk_add_f32 v[4:5], v[4:5], s[94:95]
v_pk_add_f32 v[6:7], v[6:7], s[94:95]
v_pk_add_f32 v[8:9], v[8:9], s[94:95]
v_rcp_f32 v2, v2
v_rcp_f32 v3, v3
v_rcp_f32 v4, v4
v_rcp_f32 v5, v5
v_rcp_f32 v6, v6
v_rcp_f32 v7, v7
v_rcp_f32 v8, v8
v_rcp_f32 v9, v9
s_add_u32 s11, s14, 541696
v_pk_mul_f32 v[248:249], v[248:249], v[2:3]
v_pk_mul_f32 v[250:251], v[250:251], v[4:5]
v_pk_mul_f32 v[252:253], v[252:253], v[6:7]
v_pk_mul_f32 v[254:255], v[254:255], v[8:9]
v_cvt_pk_bf16_f32 v240, v248, v249
v_cvt_pk_bf16_f32 v241, v250, v251
v_cvt_pk_bf16_f32 v242, v252, v253
v_cvt_pk_bf16_f32 v243, v254, v255
buffer_store_dwordx4 v[240:243], v1, s[56:59], s11 offen sc0 sc1
    v_lshrrev_b32 v2, 4, v1
    v_lshrrev_b32 v3, 3, v2
    v_and_b32 v4, 7, v2
    v_lshrrev_b32 v5, 4, v2
    v_mov_b32 v240, v0
    v_mov_b32 v241, v0
    v_xor_b32 v6, v4, v5
    v_lshlrev_b32 v6, 4, v6
    v_lshl_add_u32 v242, v3, 11, v6
    v_bfe_u32 v9, v2, 2, 2
    v_lshrrev_b32 v7, 5, v2
    v_lshlrev_b32 v80, 3, v7
    v_lshl_add_u32 v80, v9, 1, v80
    v_and_b32 v81, 1, v5
    v_add_u32 v80, v80, v81
    v_lshlrev_b32 v80, 7, v80
    v_and_b32 v8, 3, v2
    v_lshl_add_u32 v80, v8, 3, v80
v_xor_b32 v8, 0, v9
v_lshl_add_u32 v244, v8, 5, v80
v_xor_b32 v8, 1, v9
v_lshl_add_u32 v245, v8, 5, v80
v_xor_b32 v8, 2, v9
v_lshl_add_u32 v246, v8, 5, v80
v_xor_b32 v8, 3, v9
v_lshl_add_u32 v247, v8, 5, v80
    v_and_b32 v82, 15, v2
    v_lshrrev_b32 v8, 1, v82
    v_xor_b32 v8, v7, v8
    v_lshlrev_b32 v8, 4, v8
    v_lshl_add_u32 v8, v82, 7, v8
    v_lshl_add_u32 v248, v81, 14, v8
    v_xor_b32 v249, 32, v248
    v_xor_b32 v250, 64, v248
    v_xor_b32 v251, 96, v248
s_sub_u32 s11, s3, 2
s_cmp_lt_u32 s11, 1
s_cbranch_scc0 L1A_e4d
s_mov_b32 s10, 0x40000
s_waitcnt vmcnt(8)
s_branch L1A_chk
L1A_poll:
v_add_u32 v48, 0, v47
buffer_load_dwordx4 v[10:13], v48, s[64:67], 0 offen sc0 sc1
v_add_u32 v48, 16384, v47
buffer_load_dwordx4 v[14:17], v48, s[64:67], 0 offen sc0 sc1
v_add_u32 v48, 32768, v47
buffer_load_dwordx4 v[92:95], v48, s[64:67], 0 offen sc0 sc1
v_add_u32 v48, 49152, v47
buffer_load_dwordx4 v[100:103], v48, s[64:67], 0 offen sc0 sc1
v_add_u32 v48, 65536, v47
buffer_load_dwordx4 v[96:99], v48, s[64:67], 0 offen sc0 sc1
v_add_u32 v48, 81920, v47
buffer_load_dwordx4 v[88:91], v48, s[64:67], 0 offen sc0 sc1
v_add_u32 v48, 98304, v47
buffer_load_dwordx4 v[108:111], v48, s[64:67], 0 offen sc0 sc1
s_waitcnt vmcnt(0)
L1A_chk:
s_mov_b64 s[92:93], -1
s_cmp_ge_u32 s4, 7
s_cselect_b32 s11, s98, 0
v_cmp_eq_u32 vcc, s11, v11
s_and_b64 s[92:93], s[92:93], vcc
v_cmp_eq_u32 vcc, s11, v13
s_and_b64 s[92:93], s[92:93], vcc
s_cmp_ge_u32 s4, 6
s_cselect_b32 s11, s98, 0
v_cmp_eq_u32 vcc, s11, v15
s_and_b64 s[92:93], s[92:93], vcc
v_cmp_eq_u32 vcc, s11, v17
s_and_b64 s[92:93], s[92:93], vcc
s_cmp_ge_u32 s4, 5
s_cselect_b32 s11, s98, 0
v_cmp_eq_u32 vcc, s11, v93
s_and_b64 s[92:93], s[92:93], vcc
v_cmp_eq_u32 vcc, s11, v95
s_and_b64 s[92:93], s[92:93], vcc
s_cmp_ge_u32 s4, 4
s_cselect_b32 s11, s98, 0
v_cmp_eq_u32 vcc, s11, v101
s_and_b64 s[92:93], s[92:93], vcc
v_cmp_eq_u32 vcc, s11, v103
s_and_b64 s[92:93], s[92:93], vcc
s_cmp_ge_u32 s4, 3
s_cselect_b32 s11, s98, 0
v_cmp_eq_u32 vcc, s11, v97
s_and_b64 s[92:93], s[92:93], vcc
v_cmp_eq_u32 vcc, s11, v99
s_and_b64 s[92:93], s[92:93], vcc
s_cmp_ge_u32 s4, 2
s_cselect_b32 s11, s98, 0
v_cmp_eq_u32 vcc, s11, v89
s_and_b64 s[92:93], s[92:93], vcc
v_cmp_eq_u32 vcc, s11, v91
s_and_b64 s[92:93], s[92:93], vcc
s_cmp_ge_u32 s4, 1
s_cselect_b32 s11, s98, 0
v_cmp_eq_u32 vcc, s11, v109
s_and_b64 s[92:93], s[92:93], vcc
v_cmp_eq_u32 vcc, s11, v111
s_and_b64 s[92:93], s[92:93], vcc
s_sub_u32 s10, s10, 1
s_cbranch_scc1 L1A_polld
s_cmp_eq_u64 s[92:93], -1
s_cbranch_scc0 L1A_poll
L1A_polld:
v_mov_b32 v11, v12
v_mov_b32 v15, v16
v_mov_b32 v93, v94
v_mov_b32 v101, v102
v_mov_b32 v97, v98
v_mov_b32 v89, v90
v_mov_b32 v109, v110
v_lshrrev_b32 v46, 4, v1
v_and_b32 v46, 15, v46
v_lshlrev_b32 v46, 3, v46
v_add_u32 v46, 162816, v46
v_pk_fma_f32 v[48:49], v[42:43], v[10:11], v[14:15] op_sel:[1,1,0] op_sel_hi:[1,0,1] neg_lo:[1,0,0]
v_pk_fma_f32 v[44:45], v[42:43], v[10:11], v[48:49] op_sel:[0,0,0] op_sel_hi:[0,1,1]
v_pk_fma_f32 v[48:49], v[42:43], v[44:45], v[92:93] op_sel:[1,1,0] op_sel_hi:[1,0,1] neg_lo:[1,0,0]
v_pk_fma_f32 v[44:45], v[42:43], v[44:45], v[48:49] op_sel:[0,0,0] op_sel_hi:[0,1,1]
v_pk_fma_f32 v[48:49], v[42:43], v[44:45], v[100:101] op_sel:[1,1,0] op_sel_hi:[1,0,1] neg_lo:[1,0,0]
v_pk_fma_f32 v[44:45], v[42:43], v[44:45], v[48:49] op_sel:[0,0,0] op_sel_hi:[0,1,1]
v_pk_fma_f32 v[48:49], v[42:43], v[44:45], v[96:97] op_sel:[1,1,0] op_sel_hi:[1,0,1] neg_lo:[1,0,0]
v_pk_fma_f32 v[44:45], v[42:43], v[44:45], v[48:49] op_sel:[0,0,0] op_sel_hi:[0,1,1]
v_pk_fma_f32 v[48:49], v[42:43], v[44:45], v[88:89] op_sel:[1,1,0] op_sel_hi:[1,0,1] neg_lo:[1,0,0]
v_pk_fma_f32 v[44:45], v[42:43], v[44:45], v[48:49] op_sel:[0,0,0] op_sel_hi:[0,1,1]
v_pk_fma_f32 v[48:49], v[42:43], v[44:45], v[108:109] op_sel:[1,1,0] op_sel_hi:[1,0,1] neg_lo:[1,0,0]
v_pk_fma_f32 v[44:45], v[42:43], v[44:45], v[48:49] op_sel:[0,0,0] op_sel_hi:[0,1,1]
ds_write_b64 v46, v[44:45]
L1A_e4d:
    v_lshrrev_b32 v4, 4, v1
    v_and_b32 v5, 15, v4
    v_lshrrev_b32 v6, 4, v4
    v_and_b32 v2, 3, v5
    v_lshl_add_u32 v2, v6, 2, v2
    v_and_b32 v3, 4, v5
    v_xor_b32 v2, v2, v3
    v_lshrrev_b32 v3, 2, v5
    v_lshl_add_u32 v2, v3, 4, v2
    v_lshlrev_b32 v2, 4, v2
    s_lshl_b32 s11, s3, 13
    s_add_u32 s11, s11, 98304
    v_add_u32 v2, s11, v2
    v_and_b32 v10, 3, v4
    v_lshl_add_u32 v3, v10, 2, v3
    v_lshlrev_b32 v3, 4, v3
    v_lshrrev_b32 v10, 5, v4
    v_lshl_add_u32 v3, v10, 9, v3
    v_and_b32 v10, 1, v6
    v_lshl_add_u32 v3, v10, 3, v3
    v_add_u32 v3, s11, v3
    v_xor_b32 v10, 64, v3
    v_lshlrev_b32 v7, 3, v5
    v_mul_u32_u24 v6, 640, v6
    v_add_u32 v6, v6, v7
    s_mul_i32 s11, s7, 5120
    s_add_u32 s11, s11, 152576
    s_mul_i32 s12, s8, 2560
    s_add_u32 s13, s11, s12
    s_sub_u32 s12, 2560, s12
    s_add_u32 s14, s11, s12
    v_add_u32 v8, s13, v6
    v_add_u32 v9, s14, v6
    v_add_u32 v7, 162816, v7
    s_lshl_b32 s11, s6, 3
    s_add_u32 s11, s11, s5
    s_add_u32 s11, s11, 112
    s_lshl_b32 s11, s11, 10
    s_add_u32 s13, s96, s11
    s_lshl_b32 s12, s8, 11
    s_add_u32 s11, s11, s12
    s_add_u32 s96, s96, s11
    s_add_u32 s97, s97, s11
    s_lshl_b32 s12, s8, 8
    s_andn2_b32 s11, s80, 1
    s_add_u32 s11, s11, s15
    s_lshl_b32 s84, s11, 7
    s_lshl_b32 s12, s4, 5
    s_add_u32 s12, s12, s9
    s_lshl_b32 s85, s12, 3
    s_lshr_b32 s12, s12, 4
    s_cmp_eq_u32 s11, s12
    s_cselect_b32 s88, 0x10001, 0
    s_and_b32 s11, s9, 15
    s_lshl_b32 s88, s88, s11
    s_mov_b32 s89, s88
    s_add_u32 s84, s84, 270336
    s_add_u32 s85, s85, 270336
v_bfe_u32 v54, v1, 4, 4
v_lshlrev_b32 v54, 3, v54
s_add_u32 s64, s48, 23068672
s_addc_u32 s65, s49, 0
s_mov_b32 s66, 327680
s_waitcnt vmcnt(0) lgkmcnt(0)
s_barrier
    s_cmp_eq_u32 s3, 0
    s_cbranch_scc0 L1A_pg_d
    s_add_u32 s11, s85, 0
    v_mov_b32 v118, s98
    v_mov_b32 v119, s98
    s_mov_b64 exec, 1
    buffer_store_dwordx2 v[118:119], v54, s[64:67], s11 offen sc0 sc1
    s_mov_b64 exec, -1
    s_nop 1
L1A_pg_d:
ds_read_b64 v[40:41], v51 offset:0
ds_read_b64 v[14:15], v8 offset:0
ds_read_b64 v[94:95], v7 offset:0
    s_lshl_b32 s11, s80, 2
    s_add_u32 s11, s11, s3
    s_mul_i32 s11, s11, 360448
    s_add_u32 s60, s48, s11
    s_addc_u32 s61, s49, 0
    s_mov_b32 s62, 360448
    s_mul_i32 s78, s15, 57344
    s_add_u32 s79, s78, 180224
    s_xor_b32 s76, s76, 65536
    s_waitcnt lgkmcnt(0)
v_pk_fma_f32 v[80:81], v[14:15], v[94:95], v[40:41] op_sel:[1,1,0] op_sel_hi:[1,0,1] neg_lo:[1,0,0]
v_pk_fma_f32 v[40:41], v[14:15], v[94:95], v[80:81] op_sel:[0,0,0] op_sel_hi:[0,1,1]
v_pk_fma_f32 v[80:81], v[20:21], v[40:41], v[32:33] op_sel:[1,1,0] op_sel_hi:[1,0,1] neg_lo:[1,0,0]
v_pk_fma_f32 v[32:33], v[20:21], v[40:41], v[80:81] op_sel:[0,0,0] op_sel_hi:[0,1,1]
v_pk_fma_f32 v[80:81], v[20:21], v[32:33], v[34:35] op_sel:[1,1,0] op_sel_hi:[1,0,1] neg_lo:[1,0,0]
v_pk_fma_f32 v[34:35], v[20:21], v[32:33], v[80:81] op_sel:[0,0,0] op_sel_hi:[0,1,1]
v_pk_fma_f32 v[80:81], v[20:21], v[34:35], v[36:37] op_sel:[1,1,0] op_sel_hi:[1,0,1] neg_lo:[1,0,0]
v_pk_fma_f32 v[36:37], v[20:21], v[34:35], v[80:81] op_sel:[0,0,0] op_sel_hi:[0,1,1]
v_pk_fma_f32 v[80:81], v[20:21], v[36:37], v[38:39] op_sel:[1,1,0] op_sel_hi:[1,0,1] neg_lo:[1,0,0]
v_pk_fma_f32 v[38:39], v[20:21], v[36:37], v[80:81] op_sel:[0,0,0] op_sel_hi:[0,1,1]
v_cvt_pk_bf16_f32 v32, v32, v34
v_cvt_pk_bf16_f32 v34, -v33, -v35
v_cvt_pk_bf16_f32 v33, v36, v38
v_cvt_pk_bf16_f32 v35, -v37, -v39
ds_write_b128 v2, v[32:35] offset:0
ds_read_b64_tr_b16 v[32:33], v3 offset:0
ds_read_b64_tr_b16 v[34:35], v10 offset:256
v_pk_fma_f32 v[80:81], v[20:21], v[38:39], v[56:57] op_sel:[1,1,0] op_sel_hi:[1,0,1] neg_lo:[1,0,0]
v_pk_fma_f32 v[56:57], v[20:21], v[38:39], v[80:81] op_sel:[0,0,0] op_sel_hi:[0,1,1]
v_pk_fma_f32 v[80:81], v[20:21], v[56:57], v[58:59] op_sel:[1,1,0] op_sel_hi:[1,0,1] neg_lo:[1,0,0]
v_pk_fma_f32 v[58:59], v[20:21], v[56:57], v[80:81] op_sel:[0,0,0] op_sel_hi:[0,1,1]
v_pk_fma_f32 v[80:81], v[20:21], v[58:59], v[60:61] op_sel:[1,1,0] op_sel_hi:[1,0,1] neg_lo:[1,0,0]
v_pk_fma_f32 v[60:61], v[20:21], v[58:59], v[80:81] op_sel:[0,0,0] op_sel_hi:[0,1,1]
v_pk_fma_f32 v[80:81], v[20:21], v[60:61], v[62:63] op_sel:[1,1,0] op_sel_hi:[1,0,1] neg_lo:[1,0,0]
v_pk_fma_f32 v[62:63], v[20:21], v[60:61], v[80:81] op_sel:[0,0,0] op_sel_hi:[0,1,1]
v_cvt_pk_bf16_f32 v56, v56, v58
v_cvt_pk_bf16_f32 v58, -v57, -v59
v_cvt_pk_bf16_f32 v57, v60, v62
v_cvt_pk_bf16_f32 v59, -v61, -v63
ds_write_b128 v2, v[56:59] offset:0
ds_read_b64_tr_b16 v[56:57], v3 offset:0
ds_read_b64_tr_b16 v[58:59], v10 offset:256
v_pk_fma_f32 v[80:81], v[20:21], v[62:63], v[64:65] op_sel:[1,1,0] op_sel_hi:[1,0,1] neg_lo:[1,0,0]
v_pk_fma_f32 v[64:65], v[20:21], v[62:63], v[80:81] op_sel:[0,0,0] op_sel_hi:[0,1,1]
v_pk_fma_f32 v[80:81], v[20:21], v[64:65], v[66:67] op_sel:[1,1,0] op_sel_hi:[1,0,1] neg_lo:[1,0,0]
v_pk_fma_f32 v[66:67], v[20:21], v[64:65], v[80:81] op_sel:[0,0,0] op_sel_hi:[0,1,1]
v_pk_fma_f32 v[80:81], v[20:21], v[66:67], v[68:69] op_sel:[1,1,0] op_sel_hi:[1,0,1] neg_lo:[1,0,0]
v_pk_fma_f32 v[68:69], v[20:21], v[66:67], v[80:81] op_sel:[0,0,0] op_sel_hi:[0,1,1]
v_pk_fma_f32 v[80:81], v[20:21], v[68:69], v[70:71] op_sel:[1,1,0] op_sel_hi:[1,0,1] neg_lo:[1,0,0]
v_pk_fma_f32 v[70:71], v[20:21], v[68:69], v[80:81] op_sel:[0,0,0] op_sel_hi:[0,1,1]
v_cvt_pk_bf16_f32 v64, v64, v66
v_cvt_pk_bf16_f32 v66, -v65, -v67
v_cvt_pk_bf16_f32 v65, v68, v70
v_cvt_pk_bf16_f32 v67, -v69, -v71
ds_write_b128 v2, v[64:67] offset:0
ds_read_b64_tr_b16 v[64:65], v3 offset:0
ds_read_b64_tr_b16 v[66:67], v10 offset:256
buffer_load_dwordx2 v[116:117], v54, s[64:67], s84 offen sc0 sc1
v_pk_fma_f32 v[80:81], v[20:21], v[70:71], v[72:73] op_sel:[1,1,0] op_sel_hi:[1,0,1] neg_lo:[1,0,0]
v_pk_fma_f32 v[72:73], v[20:21], v[70:71], v[80:81] op_sel:[0,0,0] op_sel_hi:[0,1,1]
v_pk_fma_f32 v[80:81], v[20:21], v[72:73], v[74:75] op_sel:[1,1,0] op_sel_hi:[1,0,1] neg_lo:[1,0,0]
v_pk_fma_f32 v[74:75], v[20:21], v[72:73], v[80:81] op_sel:[0,0,0] op_sel_hi:[0,1,1]
v_pk_fma_f32 v[80:81], v[20:21], v[74:75], v[76:77] op_sel:[1,1,0] op_sel_hi:[1,0,1] neg_lo:[1,0,0]
v_pk_fma_f32 v[76:77], v[20:21], v[74:75], v[80:81] op_sel:[0,0,0] op_sel_hi:[0,1,1]
v_pk_fma_f32 v[80:81], v[20:21], v[76:77], v[78:79] op_sel:[1,1,0] op_sel_hi:[1,0,1] neg_lo:[1,0,0]
v_pk_fma_f32 v[78:79], v[20:21], v[76:77], v[80:81] op_sel:[0,0,0] op_sel_hi:[0,1,1]
v_cvt_pk_bf16_f32 v72, v72, v74
v_cvt_pk_bf16_f32 v74, -v73, -v75
v_cvt_pk_bf16_f32 v73, v76, v78
v_cvt_pk_bf16_f32 v75, -v77, -v79
ds_write_b128 v2, v[72:75] offset:0
ds_read_b64_tr_b16 v[72:73], v3 offset:0
ds_read_b64_tr_b16 v[74:75], v10 offset:256
s_mov_b32 s10, 0x40000
s_waitcnt vmcnt(0)
L1A_gc_c:
    v_cmp_eq_u32 vcc, s98, v116
    s_mov_b64 s[92:93], vcc
    v_cmp_eq_u32 vcc, s98, v117
    s_and_b64 s[92:93], s[92:93], vcc
    s_or_b64 s[92:93], s[92:93], s[88:89]
    s_cmp_eq_u64 s[92:93], -1
    s_cbranch_scc1 L1A_gc_ok
    buffer_load_dwordx2 v[116:117], v54, s[64:67], s84 offen sc0 sc1
    s_waitcnt vmcnt(0)
    s_sub_u32 s10, s10, 1
    s_cbranch_scc0 L1A_gc_c
L1A_gc_ok:
buffer_load_dwordx4 a[0:3], v1, s[60:63], s78 offen offset:0 sc1
buffer_load_dwordx4 a[4:7], v1, s[60:63], s79 offen offset:0 sc1
buffer_load_dwordx4 a[8:11], v1, s[60:63], s78 offen offset:1024 sc1
buffer_load_dwordx4 a[12:15], v1, s[60:63], s79 offen offset:1024 sc1
buffer_load_dwordx4 a[16:19], v1, s[60:63], s78 offen offset:2048 sc1
buffer_load_dwordx4 a[20:23], v1, s[60:63], s79 offen offset:2048 sc1
buffer_load_dwordx4 a[24:27], v1, s[60:63], s78 offen offset:3072 sc1
buffer_load_dwordx4 a[28:31], v1, s[60:63], s79 offen offset:3072 sc1
s_add_u32 s78, s78, 4096
s_add_u32 s79, s79, 4096
s_add_u32 s11, s13, 0
s_waitcnt lgkmcnt(9)
buffer_store_dwordx4 v[32:35], v1, s[56:59], s11 offen sc0 sc1
s_add_u32 s11, s13, 180224
s_waitcnt lgkmcnt(6)
buffer_store_dwordx4 v[56:59], v1, s[56:59], s11 offen sc0 sc1
s_add_u32 s11, s13, 360448
s_waitcnt lgkmcnt(3)
buffer_store_dwordx4 v[64:67], v1, s[56:59], s11 offen sc0 sc1
s_add_u32 s11, s13, 540672
s_waitcnt lgkmcnt(0)
buffer_store_dwordx4 v[72:75], v1, s[56:59], s11 offen sc0 sc1
s_branch L2_start
L1B_epi:
v_lshrrev_b32 v50, 4, v1
v_and_b32 v51, 15, v50
v_lshlrev_b32 v52, 5, v51
v_add_u32 v52, 139264, v52
ds_read_b128 v[20:23], v52 offset:2048
s_lshl_b32 s11, s8, 10
v_add_u32 v52, s11, v52
ds_read_b128 v[24:27], v52
ds_read_b128 v[28:31], v52 offset:512
    v_lshrrev_b32 v50, 4, v50
    v_lshlrev_b32 v50, 7, v50
    v_lshl_add_u32 v50, v51, 3, v50
    s_lshl_b32 s11, s7, 10
    s_lshl_b32 s12, s8, 9
    s_add_u32 s11, s11, s12
    s_add_u32 s11, s11, 142336
    s_xor_b32 s12, s11, 512
    s_lshl_b32 s13, s8, 12
    v_add_u32 v51, s11, v50
    s_add_u32 s11, s11, s13
    s_add_u32 s12, s12, s13
    v_add_u32 v52, s11, v50
    v_add_u32 v53, s12, v50
    s_waitcnt lgkmcnt(0)
v_pk_mul_f32 v[32:33], v[22:23], v[56:57] op_sel:[0,0] op_sel_hi:[1,0]
v_pk_mul_f32 v[34:35], v[22:23], v[56:57] op_sel:[0,1] op_sel_hi:[1,1]
v_pk_mul_f32 v[36:37], v[22:23], v[58:59] op_sel:[0,0] op_sel_hi:[1,0]
v_pk_mul_f32 v[38:39], v[22:23], v[58:59] op_sel:[0,1] op_sel_hi:[1,1]
v_pk_fma_f32 v[32:33], v[22:23], v[60:61], v[32:33] op_sel:[1,0,0] op_sel_hi:[0,0,1] neg_lo:[1,0,0]
v_pk_fma_f32 v[34:35], v[22:23], v[60:61], v[34:35] op_sel:[1,1,0] op_sel_hi:[0,1,1] neg_lo:[1,0,0]
v_pk_fma_f32 v[36:37], v[22:23], v[62:63], v[36:37] op_sel:[1,0,0] op_sel_hi:[0,0,1] neg_lo:[1,0,0]
v_pk_fma_f32 v[38:39], v[22:23], v[62:63], v[38:39] op_sel:[1,1,0] op_sel_hi:[0,1,1] neg_lo:[1,0,0]
v_pk_mul_f32 v[56:57], v[22:23], v[64:65] op_sel:[0,0] op_sel_hi:[1,0]
v_pk_mul_f32 v[58:59], v[22:23], v[64:65] op_sel:[0,1] op_sel_hi:[1,1]
v_pk_mul_f32 v[60:61], v[22:23], v[66:67] op_sel:[0,0] op_sel_hi:[1,0]
v_pk_mul_f32 v[62:63], v[22:23], v[66:67] op_sel:[0,1] op_sel_hi:[1,1]
v_pk_fma_f32 v[56:57], v[22:23], v[68:69], v[56:57] op_sel:[1,0,0] op_sel_hi:[0,0,1] neg_lo:[1,0,0]
v_pk_fma_f32 v[58:59], v[22:23], v[68:69], v[58:59] op_sel:[1,1,0] op_sel_hi:[0,1,1] neg_lo:[1,0,0]
v_pk_fma_f32 v[60:61], v[22:23], v[70:71], v[60:61] op_sel:[1,0,0] op_sel_hi:[0,0,1] neg_lo:[1,0,0]
v_pk_fma_f32 v[62:63], v[22:23], v[70:71], v[62:63] op_sel:[1,1,0] op_sel_hi:[0,1,1] neg_lo:[1,0,0]
v_pk_mul_f32 v[64:65], v[22:23], v[72:73] op_sel:[0,0] op_sel_hi:[1,0]
v_pk_mul_f32 v[66:67], v[22:23], v[72:73] op_sel:[0,1] op_sel_hi:[1,1]
v_pk_mul_f32 v[68:69], v[22:23], v[74:75] op_sel:[0,0] op_sel_hi:[1,0]
v_pk_mul_f32 v[70:71], v[22:23], v[74:75] op_sel:[0,1] op_sel_hi:[1,1]
v_pk_fma_f32 v[64:65], v[22:23], v[76:77], v[64:65] op_sel:[1,0,0] op_sel_hi:[0,0,1] neg_lo:[1,0,0]
v_pk_fma_f32 v[66:67], v[22:23], v[76:77], v[66:67] op_sel:[1,1,0] op_sel_hi:[0,1,1] neg_lo:[1,0,0]
v_pk_fma_f32 v[68:69], v[22:23], v[78:79], v[68:69] op_sel:[1,0,0] op_sel_hi:[0,0,1] neg_lo:[1,0,0]
v_pk_fma_f32 v[70:71], v[22:23], v[78:79], v[70:71] op_sel:[1,1,0] op_sel_hi:[0,1,1] neg_lo:[1,0,0]
v_pk_mul_f32 v[72:73], v[22:23], v[80:81] op_sel:[0,0] op_sel_hi:[1,0]
v_pk_mul_f32 v[74:75], v[22:23], v[80:81] op_sel:[0,1] op_sel_hi:[1,1]
v_pk_mul_f32 v[76:77], v[22:23], v[82:83] op_sel:[0,0] op_sel_hi:[1,0]
v_pk_mul_f32 v[78:79], v[22:23], v[82:83] op_sel:[0,1] op_sel_hi:[1,1]
v_pk_fma_f32 v[72:73], v[22:23], v[84:85], v[72:73] op_sel:[1,0,0] op_sel_hi:[0,0,1] neg_lo:[1,0,0]
v_pk_fma_f32 v[74:75], v[22:23], v[84:85], v[74:75] op_sel:[1,1,0] op_sel_hi:[0,1,1] neg_lo:[1,0,0]
v_pk_fma_f32 v[76:77], v[22:23], v[86:87], v[76:77] op_sel:[1,0,0] op_sel_hi:[0,0,1] neg_lo:[1,0,0]
v_pk_fma_f32 v[78:79], v[22:23], v[86:87], v[78:79] op_sel:[1,1,0] op_sel_hi:[0,1,1] neg_lo:[1,0,0]
v_pk_mul_f32 v[80:81], v[26:27], v[88:89] op_sel:[0,0] op_sel_hi:[1,0]
v_pk_mul_f32 v[82:83], v[26:27], v[88:89] op_sel:[0,1] op_sel_hi:[1,1]
v_pk_mul_f32 v[84:85], v[26:27], v[90:91] op_sel:[0,0] op_sel_hi:[1,0]
v_pk_mul_f32 v[86:87], v[26:27], v[90:91] op_sel:[0,1] op_sel_hi:[1,1]
v_pk_fma_f32 v[80:81], v[26:27], v[92:93], v[80:81] op_sel:[1,0,0] op_sel_hi:[0,0,1] neg_lo:[1,0,0]
v_pk_fma_f32 v[82:83], v[26:27], v[92:93], v[82:83] op_sel:[1,1,0] op_sel_hi:[0,1,1] neg_lo:[1,0,0]
v_pk_fma_f32 v[84:85], v[26:27], v[94:95], v[84:85] op_sel:[1,0,0] op_sel_hi:[0,0,1] neg_lo:[1,0,0]
v_pk_fma_f32 v[86:87], v[26:27], v[94:95], v[86:87] op_sel:[1,1,0] op_sel_hi:[0,1,1] neg_lo:[1,0,0]
v_pk_mul_f32 v[88:89], v[26:27], v[96:97] op_sel:[0,0] op_sel_hi:[1,0]
v_pk_mul_f32 v[90:91], v[26:27], v[96:97] op_sel:[0,1] op_sel_hi:[1,1]
v_pk_mul_f32 v[92:93], v[26:27], v[98:99] op_sel:[0,0] op_sel_hi:[1,0]
v_pk_mul_f32 v[94:95], v[26:27], v[98:99] op_sel:[0,1] op_sel_hi:[1,1]
v_pk_fma_f32 v[88:89], v[26:27], v[100:101], v[88:89] op_sel:[1,0,0] op_sel_hi:[0,0,1] neg_lo:[1,0,0]
v_pk_fma_f32 v[90:91], v[26:27], v[100:101], v[90:91] op_sel:[1,1,0] op_sel_hi:[0,1,1] neg_lo:[1,0,0]
v_pk_fma_f32 v[92:93], v[26:27], v[102:103], v[92:93] op_sel:[1,0,0] op_sel_hi:[0,0,1] neg_lo:[1,0,0]
v_pk_fma_f32 v[94:95], v[26:27], v[102:103], v[94:95] op_sel:[1,1,0] op_sel_hi:[0,1,1] neg_lo:[1,0,0]
v_pk_mul_f32 v[96:97], v[26:27], v[104:105] op_sel:[0,0] op_sel_hi:[1,0]
v_pk_mul_f32 v[98:99], v[26:27], v[104:105] op_sel:[0,1] op_sel_hi:[1,1]
v_pk_mul_f32 v[100:101], v[26:27], v[106:107] op_sel:[0,0] op_sel_hi:[1,0]
v_pk_mul_f32 v[102:103], v[26:27], v[106:107] op_sel:[0,1] op_sel_hi:[1,1]
v_pk_fma_f32 v[96:97], v[26:27], v[108:109], v[96:97] op_sel:[1,0,0] op_sel_hi:[0,0,1] neg_lo:[1,0,0]
v_pk_fma_f32 v[98:99], v[26:27], v[108:109], v[98:99] op_sel:[1,1,0] op_sel_hi:[0,1,1] neg_lo:[1,0,0]
v_pk_fma_f32 v[100:101], v[26:27], v[110:111], v[100:101] op_sel:[1,0,0] op_sel_hi:[0,0,1] neg_lo:[1,0,0]
v_pk_fma_f32 v[102:103], v[26:27], v[110:111], v[102:103] op_sel:[1,1,0] op_sel_hi:[0,1,1] neg_lo:[1,0,0]
v_pk_mul_f32 v[104:105], v[26:27], v[112:113] op_sel:[0,0] op_sel_hi:[1,0]
v_pk_mul_f32 v[106:107], v[26:27], v[112:113] op_sel:[0,1] op_sel_hi:[1,1]
v_pk_mul_f32 v[108:109], v[26:27], v[114:115] op_sel:[0,0] op_sel_hi:[1,0]
v_pk_mul_f32 v[110:111], v[26:27], v[114:115] op_sel:[0,1] op_sel_hi:[1,1]
v_pk_fma_f32 v[104:105], v[26:27], v[116:117], v[104:105] op_sel:[1,0,0] op_sel_hi:[0,0,1] neg_lo:[1,0,0]
v_pk_fma_f32 v[106:107], v[26:27], v[116:117], v[106:107] op_sel:[1,1,0] op_sel_hi:[0,1,1] neg_lo:[1,0,0]
v_pk_fma_f32 v[108:109], v[26:27], v[118:119], v[108:109] op_sel:[1,0,0] op_sel_hi:[0,0,1] neg_lo:[1,0,0]
v_pk_fma_f32 v[110:111], v[26:27], v[118:119], v[110:111] op_sel:[1,1,0] op_sel_hi:[0,1,1] neg_lo:[1,0,0]
v_pk_mul_f32 v[112:113], v[26:27], v[120:121] op_sel:[0,0] op_sel_hi:[1,0]
v_pk_mul_f32 v[114:115], v[26:27], v[120:121] op_sel:[0,1] op_sel_hi:[1,1]
v_pk_mul_f32 v[116:117], v[26:27], v[122:123] op_sel:[0,0] op_sel_hi:[1,0]
v_pk_mul_f32 v[118:119], v[26:27], v[122:123] op_sel:[0,1] op_sel_hi:[1,1]
v_pk_fma_f32 v[112:113], v[26:27], v[124:125], v[112:113] op_sel:[1,0,0] op_sel_hi:[0,0,1] neg_lo:[1,0,0]
v_pk_fma_f32 v[114:115], v[26:27], v[124:125], v[114:115] op_sel:[1,1,0] op_sel_hi:[0,1,1] neg_lo:[1,0,0]
v_pk_fma_f32 v[116:117], v[26:27], v[126:127], v[116:117] op_sel:[1,0,0] op_sel_hi:[0,0,1] neg_lo:[1,0,0]
v_pk_fma_f32 v[118:119], v[26:27], v[126:127], v[118:119] op_sel:[1,1,0] op_sel_hi:[0,1,1] neg_lo:[1,0,0]
v_pk_mul_f32 v[120:121], v[26:27], v[128:129] op_sel:[0,0] op_sel_hi:[1,0]
v_pk_mul_f32 v[122:123], v[26:27], v[128:129] op_sel:[0,1] op_sel_hi:[1,1]
v_pk_mul_f32 v[124:125], v[26:27], v[130:131] op_sel:[0,0] op_sel_hi:[1,0]
v_pk_mul_f32 v[126:127], v[26:27], v[130:131] op_sel:[0,1] op_sel_hi:[1,1]
v_pk_fma_f32 v[120:121], v[26:27], v[132:133], v[120:121] op_sel:[1,0,0] op_sel_hi:[0,0,1] neg_lo:[1,0,0]
v_pk_fma_f32 v[122:123], v[26:27], v[132:133], v[122:123] op_sel:[1,1,0] op_sel_hi:[0,1,1] neg_lo:[1,0,0]
v_pk_fma_f32 v[124:125], v[26:27], v[134:135], v[124:125] op_sel:[1,0,0] op_sel_hi:[0,0,1] neg_lo:[1,0,0]
v_pk_fma_f32 v[126:127], v[26:27], v[134:135], v[126:127] op_sel:[1,1,0] op_sel_hi:[0,1,1] neg_lo:[1,0,0]
v_pk_mul_f32 v[128:129], v[26:27], v[136:137] op_sel:[0,0] op_sel_hi:[1,0]
v_pk_mul_f32 v[130:131], v[26:27], v[136:137] op_sel:[0,1] op_sel_hi:[1,1]
v_pk_mul_f32 v[132:133], v[26:27], v[138:139] op_sel:[0,0] op_sel_hi:[1,0]
v_pk_mul_f32 v[134:135], v[26:27], v[138:139] op_sel:[0,1] op_sel_hi:[1,1]
v_pk_fma_f32 v[128:129], v[26:27], v[140:141], v[128:129] op_sel:[1,0,0] op_sel_hi:[0,0,1] neg_lo:[1,0,0]
v_pk_fma_f32 v[130:131], v[26:27], v[140:141], v[130:131] op_sel:[1,1,0] op_sel_hi:[0,1,1] neg_lo:[1,0,0]
v_pk_fma_f32 v[132:133], v[26:27], v[142:143], v[132:133] op_sel:[1,0,0] op_sel_hi:[0,0,1] neg_lo:[1,0,0]
v_pk_fma_f32 v[134:135], v[26:27], v[142:143], v[134:135] op_sel:[1,1,0] op_sel_hi:[0,1,1] neg_lo:[1,0,0]
v_pk_mul_f32 v[136:137], v[26:27], v[144:145] op_sel:[0,0] op_sel_hi:[1,0]
v_pk_mul_f32 v[138:139], v[26:27], v[144:145] op_sel:[0,1] op_sel_hi:[1,1]
v_pk_mul_f32 v[140:141], v[26:27], v[146:147] op_sel:[0,0] op_sel_hi:[1,0]
v_pk_mul_f32 v[142:143], v[26:27], v[146:147] op_sel:[0,1] op_sel_hi:[1,1]
v_pk_fma_f32 v[136:137], v[26:27], v[148:149], v[136:137] op_sel:[1,0,0] op_sel_hi:[0,0,1] neg_lo:[1,0,0]
v_pk_fma_f32 v[138:139], v[26:27], v[148:149], v[138:139] op_sel:[1,1,0] op_sel_hi:[0,1,1] neg_lo:[1,0,0]
v_pk_fma_f32 v[140:141], v[26:27], v[150:151], v[140:141] op_sel:[1,0,0] op_sel_hi:[0,0,1] neg_lo:[1,0,0]
v_pk_fma_f32 v[142:143], v[26:27], v[150:151], v[142:143] op_sel:[1,1,0] op_sel_hi:[0,1,1] neg_lo:[1,0,0]
v_pk_mul_f32 v[144:145], v[30:31], v[152:153] op_sel:[0,0] op_sel_hi:[1,0]
v_pk_mul_f32 v[146:147], v[30:31], v[152:153] op_sel:[0,1] op_sel_hi:[1,1]
v_pk_mul_f32 v[148:149], v[30:31], v[154:155] op_sel:[0,0] op_sel_hi:[1,0]
v_pk_mul_f32 v[150:151], v[30:31], v[154:155] op_sel:[0,1] op_sel_hi:[1,1]
v_pk_fma_f32 v[144:145], v[30:31], v[156:157], v[144:145] op_sel:[1,0,0] op_sel_hi:[0,0,1] neg_lo:[1,0,0]
v_pk_fma_f32 v[146:147], v[30:31], v[156:157], v[146:147] op_sel:[1,1,0] op_sel_hi:[0,1,1] neg_lo:[1,0,0]
v_pk_fma_f32 v[148:149], v[30:31], v[158:159], v[148:149] op_sel:[1,0,0] op_sel_hi:[0,0,1] neg_lo:[1,0,0]
v_pk_fma_f32 v[150:151], v[30:31], v[158:159], v[150:151] op_sel:[1,1,0] op_sel_hi:[0,1,1] neg_lo:[1,0,0]
v_pk_mul_f32 v[152:153], v[30:31], v[160:161] op_sel:[0,0] op_sel_hi:[1,0]
v_pk_mul_f32 v[154:155], v[30:31], v[160:161] op_sel:[0,1] op_sel_hi:[1,1]
v_pk_mul_f32 v[156:157], v[30:31], v[162:163] op_sel:[0,0] op_sel_hi:[1,0]
v_pk_mul_f32 v[158:159], v[30:31], v[162:163] op_sel:[0,1] op_sel_hi:[1,1]
v_pk_fma_f32 v[152:153], v[30:31], v[164:165], v[152:153] op_sel:[1,0,0] op_sel_hi:[0,0,1] neg_lo:[1,0,0]
v_pk_fma_f32 v[154:155], v[30:31], v[164:165], v[154:155] op_sel:[1,1,0] op_sel_hi:[0,1,1] neg_lo:[1,0,0]
v_pk_fma_f32 v[156:157], v[30:31], v[166:167], v[156:157] op_sel:[1,0,0] op_sel_hi:[0,0,1] neg_lo:[1,0,0]
v_pk_fma_f32 v[158:159], v[30:31], v[166:167], v[158:159] op_sel:[1,1,0] op_sel_hi:[0,1,1] neg_lo:[1,0,0]
v_pk_mul_f32 v[160:161], v[30:31], v[168:169] op_sel:[0,0] op_sel_hi:[1,0]
v_pk_mul_f32 v[162:163], v[30:31], v[168:169] op_sel:[0,1] op_sel_hi:[1,1]
v_pk_mul_f32 v[164:165], v[30:31], v[170:171] op_sel:[0,0] op_sel_hi:[1,0]
v_pk_mul_f32 v[166:167], v[30:31], v[170:171] op_sel:[0,1] op_sel_hi:[1,1]
v_pk_fma_f32 v[160:161], v[30:31], v[172:173], v[160:161] op_sel:[1,0,0] op_sel_hi:[0,0,1] neg_lo:[1,0,0]
v_pk_fma_f32 v[162:163], v[30:31], v[172:173], v[162:163] op_sel:[1,1,0] op_sel_hi:[0,1,1] neg_lo:[1,0,0]
v_pk_fma_f32 v[164:165], v[30:31], v[174:175], v[164:165] op_sel:[1,0,0] op_sel_hi:[0,0,1] neg_lo:[1,0,0]
v_pk_fma_f32 v[166:167], v[30:31], v[174:175], v[166:167] op_sel:[1,1,0] op_sel_hi:[0,1,1] neg_lo:[1,0,0]
v_pk_mul_f32 v[168:169], v[30:31], v[176:177] op_sel:[0,0] op_sel_hi:[1,0]
v_pk_mul_f32 v[170:171], v[30:31], v[176:177] op_sel:[0,1] op_sel_hi:[1,1]
v_pk_mul_f32 v[172:173], v[30:31], v[178:179] op_sel:[0,0] op_sel_hi:[1,0]
v_pk_mul_f32 v[174:175], v[30:31], v[178:179] op_sel:[0,1] op_sel_hi:[1,1]
v_pk_fma_f32 v[168:169], v[30:31], v[180:181], v[168:169] op_sel:[1,0,0] op_sel_hi:[0,0,1] neg_lo:[1,0,0]
v_pk_fma_f32 v[170:171], v[30:31], v[180:181], v[170:171] op_sel:[1,1,0] op_sel_hi:[0,1,1] neg_lo:[1,0,0]
v_pk_fma_f32 v[172:173], v[30:31], v[182:183], v[172:173] op_sel:[1,0,0] op_sel_hi:[0,0,1] neg_lo:[1,0,0]
v_pk_fma_f32 v[174:175], v[30:31], v[182:183], v[174:175] op_sel:[1,1,0] op_sel_hi:[0,1,1] neg_lo:[1,0,0]
v_pk_mul_f32 v[176:177], v[30:31], v[184:185] op_sel:[0,0] op_sel_hi:[1,0]
v_pk_mul_f32 v[178:179], v[30:31], v[184:185] op_sel:[0,1] op_sel_hi:[1,1]
v_pk_mul_f32 v[180:181], v[30:31], v[186:187] op_sel:[0,0] op_sel_hi:[1,0]
v_pk_mul_f32 v[182:183], v[30:31], v[186:187] op_sel:[0,1] op_sel_hi:[1,1]
v_pk_fma_f32 v[176:177], v[30:31], v[188:189], v[176:177] op_sel:[1,0,0] op_sel_hi:[0,0,1] neg_lo:[1,0,0]
v_pk_fma_f32 v[178:179], v[30:31], v[188:189], v[178:179] op_sel:[1,1,0] op_sel_hi:[0,1,1] neg_lo:[1,0,0]
v_pk_fma_f32 v[180:181], v[30:31], v[190:191], v[180:181] op_sel:[1,0,0] op_sel_hi:[0,0,1] neg_lo:[1,0,0]
v_pk_fma_f32 v[182:183], v[30:31], v[190:191], v[182:183] op_sel:[1,1,0] op_sel_hi:[0,1,1] neg_lo:[1,0,0]
v_pk_mul_f32 v[184:185], v[30:31], v[192:193] op_sel:[0,0] op_sel_hi:[1,0]
v_pk_mul_f32 v[186:187], v[30:31], v[192:193] op_sel:[0,1] op_sel_hi:[1,1]
v_pk_mul_f32 v[188:189], v[30:31], v[194:195] op_sel:[0,0] op_sel_hi:[1,0]
v_pk_mul_f32 v[190:191], v[30:31], v[194:195] op_sel:[0,1] op_sel_hi:[1,1]
v_pk_fma_f32 v[184:185], v[30:31], v[196:197], v[184:185] op_sel:[1,0,0] op_sel_hi:[0,0,1] neg_lo:[1,0,0]
v_pk_fma_f32 v[186:187], v[30:31], v[196:197], v[186:187] op_sel:[1,1,0] op_sel_hi:[0,1,1] neg_lo:[1,0,0]
v_pk_fma_f32 v[188:189], v[30:31], v[198:199], v[188:189] op_sel:[1,0,0] op_sel_hi:[0,0,1] neg_lo:[1,0,0]
v_pk_fma_f32 v[190:191], v[30:31], v[198:199], v[190:191] op_sel:[1,1,0] op_sel_hi:[0,1,1] neg_lo:[1,0,0]
v_pk_mul_f32 v[192:193], v[30:31], v[200:201] op_sel:[0,0] op_sel_hi:[1,0]
v_pk_mul_f32 v[194:195], v[30:31], v[200:201] op_sel:[0,1] op_sel_hi:[1,1]
v_pk_mul_f32 v[196:197], v[30:31], v[202:203] op_sel:[0,0] op_sel_hi:[1,0]
v_pk_mul_f32 v[198:199], v[30:31], v[202:203] op_sel:[0,1] op_sel_hi:[1,1]
v_pk_fma_f32 v[192:193], v[30:31], v[204:205], v[192:193] op_sel:[1,0,0] op_sel_hi:[0,0,1] neg_lo:[1,0,0]
v_pk_fma_f32 v[194:195], v[30:31], v[204:205], v[194:195] op_sel:[1,1,0] op_sel_hi:[0,1,1] neg_lo:[1,0,0]
v_pk_fma_f32 v[196:197], v[30:31], v[206:207], v[196:197] op_sel:[1,0,0] op_sel_hi:[0,0,1] neg_lo:[1,0,0]
v_pk_fma_f32 v[198:199], v[30:31], v[206:207], v[198:199] op_sel:[1,1,0] op_sel_hi:[0,1,1] neg_lo:[1,0,0]
v_pk_mul_f32 v[200:201], v[30:31], v[208:209] op_sel:[0,0] op_sel_hi:[1,0]
v_pk_mul_f32 v[202:203], v[30:31], v[208:209] op_sel:[0,1] op_sel_hi:[1,1]
v_pk_mul_f32 v[204:205], v[30:31], v[210:211] op_sel:[0,0] op_sel_hi:[1,0]
v_pk_mul_f32 v[206:207], v[30:31], v[210:211] op_sel:[0,1] op_sel_hi:[1,1]
v_pk_fma_f32 v[200:201], v[30:31], v[212:213], v[200:201] op_sel:[1,0,0] op_sel_hi:[0,0,1] neg_lo:[1,0,0]
v_pk_fma_f32 v[202:203], v[30:31], v[212:213], v[202:203] op_sel:[1,1,0] op_sel_hi:[0,1,1] neg_lo:[1,0,0]
v_pk_fma_f32 v[204:205], v[30:31], v[214:215], v[204:205] op_sel:[1,0,0] op_sel_hi:[0,0,1] neg_lo:[1,0,0]
v_pk_fma_f32 v[206:207], v[30:31], v[214:215], v[206:207] op_sel:[1,1,0] op_sel_hi:[0,1,1] neg_lo:[1,0,0]
v_pk_fma_f32 v[208:209], v[20:21], v[32:33], v[34:35] op_sel:[1,1,0] op_sel_hi:[1,0,1] neg_lo:[1,0,0]
v_pk_fma_f32 v[210:211], v[24:25], v[80:81], v[82:83] op_sel:[1,1,0] op_sel_hi:[1,0,1] neg_lo:[1,0,0]
v_pk_fma_f32 v[212:213], v[24:25], v[112:113], v[114:115] op_sel:[1,1,0] op_sel_hi:[1,0,1] neg_lo:[1,0,0]
v_pk_fma_f32 v[214:215], v[28:29], v[144:145], v[146:147] op_sel:[1,1,0] op_sel_hi:[1,0,1] neg_lo:[1,0,0]
v_pk_fma_f32 v[18:19], v[28:29], v[176:177], v[178:179] op_sel:[1,1,0] op_sel_hi:[1,0,1] neg_lo:[1,0,0]
v_pk_fma_f32 v[40:41], v[20:21], v[32:33], v[208:209] op_sel:[0,0,0] op_sel_hi:[0,1,1]
v_pk_fma_f32 v[42:43], v[24:25], v[80:81], v[210:211] op_sel:[0,0,0] op_sel_hi:[0,1,1]
v_pk_fma_f32 v[44:45], v[24:25], v[112:113], v[212:213] op_sel:[0,0,0] op_sel_hi:[0,1,1]
v_pk_fma_f32 v[46:47], v[28:29], v[144:145], v[214:215] op_sel:[0,0,0] op_sel_hi:[0,1,1]
v_pk_fma_f32 v[48:49], v[28:29], v[176:177], v[18:19] op_sel:[0,0,0] op_sel_hi:[0,1,1]
v_pk_fma_f32 v[208:209], v[20:21], v[40:41], v[36:37] op_sel:[1,1,0] op_sel_hi:[1,0,1] neg_lo:[1,0,0]
v_pk_fma_f32 v[210:211], v[24:25], v[42:43], v[84:85] op_sel:[1,1,0] op_sel_hi:[1,0,1] neg_lo:[1,0,0]
v_pk_fma_f32 v[212:213], v[24:25], v[44:45], v[116:117] op_sel:[1,1,0] op_sel_hi:[1,0,1] neg_lo:[1,0,0]
v_pk_fma_f32 v[214:215], v[28:29], v[46:47], v[148:149] op_sel:[1,1,0] op_sel_hi:[1,0,1] neg_lo:[1,0,0]
v_pk_fma_f32 v[18:19], v[28:29], v[48:49], v[180:181] op_sel:[1,1,0] op_sel_hi:[1,0,1] neg_lo:[1,0,0]
v_pk_fma_f32 v[40:41], v[20:21], v[40:41], v[208:209] op_sel:[0,0,0] op_sel_hi:[0,1,1]
v_pk_fma_f32 v[42:43], v[24:25], v[42:43], v[210:211] op_sel:[0,0,0] op_sel_hi:[0,1,1]
v_pk_fma_f32 v[44:45], v[24:25], v[44:45], v[212:213] op_sel:[0,0,0] op_sel_hi:[0,1,1]
v_pk_fma_f32 v[46:47], v[28:29], v[46:47], v[214:215] op_sel:[0,0,0] op_sel_hi:[0,1,1]
v_pk_fma_f32 v[48:49], v[28:29], v[48:49], v[18:19] op_sel:[0,0,0] op_sel_hi:[0,1,1]
v_pk_fma_f32 v[208:209], v[20:21], v[40:41], v[38:39] op_sel:[1,1,0] op_sel_hi:[1,0,1] neg_lo:[1,0,0]
v_pk_fma_f32 v[210:211], v[24:25], v[42:43], v[86:87] op_sel:[1,1,0] op_sel_hi:[1,0,1] neg_lo:[1,0,0]
v_pk_fma_f32 v[212:213], v[24:25], v[44:45], v[118:119] op_sel:[1,1,0] op_sel_hi:[1,0,1] neg_lo:[1,0,0]
v_pk_fma_f32 v[214:215], v[28:29], v[46:47], v[150:151] op_sel:[1,1,0] op_sel_hi:[1,0,1] neg_lo:[1,0,0]
v_pk_fma_f32 v[18:19], v[28:29], v[48:49], v[182:183] op_sel:[1,1,0] op_sel_hi:[1,0,1] neg_lo:[1,0,0]
v_pk_fma_f32 v[40:41], v[20:21], v[40:41], v[208:209] op_sel:[0,0,0] op_sel_hi:[0,1,1]
v_pk_fma_f32 v[42:43], v[24:25], v[42:43], v[210:211] op_sel:[0,0,0] op_sel_hi:[0,1,1]
v_pk_fma_f32 v[44:45], v[24:25], v[44:45], v[212:213] op_sel:[0,0,0] op_sel_hi:[0,1,1]
v_pk_fma_f32 v[46:47], v[28:29], v[46:47], v[214:215] op_sel:[0,0,0] op_sel_hi:[0,1,1]
v_pk_fma_f32 v[48:49], v[28:29], v[48:49], v[18:19] op_sel:[0,0,0] op_sel_hi:[0,1,1]
v_pk_fma_f32 v[208:209], v[20:21], v[40:41], v[56:57] op_sel:[1,1,0] op_sel_hi:[1,0,1] neg_lo:[1,0,0]
v_pk_fma_f32 v[210:211], v[24:25], v[42:43], v[88:89] op_sel:[1,1,0] op_sel_hi:[1,0,1] neg_lo:[1,0,0]
v_pk_fma_f32 v[212:213], v[24:25], v[44:45], v[120:121] op_sel:[1,1,0] op_sel_hi:[1,0,1] neg_lo:[1,0,0]
v_pk_fma_f32 v[214:215], v[28:29], v[46:47], v[152:153] op_sel:[1,1,0] op_sel_hi:[1,0,1] neg_lo:[1,0,0]
v_pk_fma_f32 v[18:19], v[28:29], v[48:49], v[184:185] op_sel:[1,1,0] op_sel_hi:[1,0,1] neg_lo:[1,0,0]
v_pk_fma_f32 v[40:41], v[20:21], v[40:41], v[208:209] op_sel:[0,0,0] op_sel_hi:[0,1,1]
v_pk_fma_f32 v[42:43], v[24:25], v[42:43], v[210:211] op_sel:[0,0,0] op_sel_hi:[0,1,1]
v_pk_fma_f32 v[44:45], v[24:25], v[44:45], v[212:213] op_sel:[0,0,0] op_sel_hi:[0,1,1]
v_pk_fma_f32 v[46:47], v[28:29], v[46:47], v[214:215] op_sel:[0,0,0] op_sel_hi:[0,1,1]
v_pk_fma_f32 v[48:49], v[28:29], v[48:49], v[18:19] op_sel:[0,0,0] op_sel_hi:[0,1,1]
v_pk_fma_f32 v[208:209], v[20:21], v[40:41], v[58:59] op_sel:[1,1,0] op_sel_hi:[1,0,1] neg_lo:[1,0,0]
v_pk_fma_f32 v[210:211], v[24:25], v[42:43], v[90:91] op_sel:[1,1,0] op_sel_hi:[1,0,1] neg_lo:[1,0,0]
v_pk_fma_f32 v[212:213], v[24:25], v[44:45], v[122:123] op_sel:[1,1,0] op_sel_hi:[1,0,1] neg_lo:[1,0,0]
v_pk_fma_f32 v[214:215], v[28:29], v[46:47], v[154:155] op_sel:[1,1,0] op_sel_hi:[1,0,1] neg_lo:[1,0,0]
v_pk_fma_f32 v[18:19], v[28:29], v[48:49], v[186:187] op_sel:[1,1,0] op_sel_hi:[1,0,1] neg_lo:[1,0,0]
v_pk_fma_f32 v[40:41], v[20:21], v[40:41], v[208:209] op_sel:[0,0,0] op_sel_hi:[0,1,1]
v_pk_fma_f32 v[42:43], v[24:25], v[42:43], v[210:211] op_sel:[0,0,0] op_sel_hi:[0,1,1]
v_pk_fma_f32 v[44:45], v[24:25], v[44:45], v[212:213] op_sel:[0,0,0] op_sel_hi:[0,1,1]
v_pk_fma_f32 v[46:47], v[28:29], v[46:47], v[214:215] op_sel:[0,0,0] op_sel_hi:[0,1,1]
v_pk_fma_f32 v[48:49], v[28:29], v[48:49], v[18:19] op_sel:[0,0,0] op_sel_hi:[0,1,1]
v_pk_fma_f32 v[208:209], v[20:21], v[40:41], v[60:61] op_sel:[1,1,0] op_sel_hi:[1,0,1] neg_lo:[1,0,0]
v_pk_fma_f32 v[210:211], v[24:25], v[42:43], v[92:93] op_sel:[1,1,0] op_sel_hi:[1,0,1] neg_lo:[1,0,0]
v_pk_fma_f32 v[212:213], v[24:25], v[44:45], v[124:125] op_sel:[1,1,0] op_sel_hi:[1,0,1] neg_lo:[1,0,0]
v_pk_fma_f32 v[214:215], v[28:29], v[46:47], v[156:157] op_sel:[1,1,0] op_sel_hi:[1,0,1] neg_lo:[1,0,0]
v_pk_fma_f32 v[18:19], v[28:29], v[48:49], v[188:189] op_sel:[1,1,0] op_sel_hi:[1,0,1] neg_lo:[1,0,0]
v_pk_fma_f32 v[40:41], v[20:21], v[40:41], v[208:209] op_sel:[0,0,0] op_sel_hi:[0,1,1]
v_pk_fma_f32 v[42:43], v[24:25], v[42:43], v[210:211] op_sel:[0,0,0] op_sel_hi:[0,1,1]
v_pk_fma_f32 v[44:45], v[24:25], v[44:45], v[212:213] op_sel:[0,0,0] op_sel_hi:[0,1,1]
v_pk_fma_f32 v[46:47], v[28:29], v[46:47], v[214:215] op_sel:[0,0,0] op_sel_hi:[0,1,1]
v_pk_fma_f32 v[48:49], v[28:29], v[48:49], v[18:19] op_sel:[0,0,0] op_sel_hi:[0,1,1]
v_pk_fma_f32 v[208:209], v[20:21], v[40:41], v[62:63] op_sel:[1,1,0] op_sel_hi:[1,0,1] neg_lo:[1,0,0]
v_pk_fma_f32 v[210:211], v[24:25], v[42:43], v[94:95] op_sel:[1,1,0] op_sel_hi:[1,0,1] neg_lo:[1,0,0]
v_pk_fma_f32 v[212:213], v[24:25], v[44:45], v[126:127] op_sel:[1,1,0] op_sel_hi:[1,0,1] neg_lo:[1,0,0]
v_pk_fma_f32 v[214:215], v[28:29], v[46:47], v[158:159] op_sel:[1,1,0] op_sel_hi:[1,0,1] neg_lo:[1,0,0]
v_pk_fma_f32 v[18:19], v[28:29], v[48:49], v[190:191] op_sel:[1,1,0] op_sel_hi:[1,0,1] neg_lo:[1,0,0]
v_pk_fma_f32 v[40:41], v[20:21], v[40:41], v[208:209] op_sel:[0,0,0] op_sel_hi:[0,1,1]
v_pk_fma_f32 v[42:43], v[24:25], v[42:43], v[210:211] op_sel:[0,0,0] op_sel_hi:[0,1,1]
v_pk_fma_f32 v[44:45], v[24:25], v[44:45], v[212:213] op_sel:[0,0,0] op_sel_hi:[0,1,1]
v_pk_fma_f32 v[46:47], v[28:29], v[46:47], v[214:215] op_sel:[0,0,0] op_sel_hi:[0,1,1]
v_pk_fma_f32 v[48:49], v[28:29], v[48:49], v[18:19] op_sel:[0,0,0] op_sel_hi:[0,1,1]
v_pk_fma_f32 v[208:209], v[20:21], v[40:41], v[64:65] op_sel:[1,1,0] op_sel_hi:[1,0,1] neg_lo:[1,0,0]
v_pk_fma_f32 v[210:211], v[24:25], v[42:43], v[96:97] op_sel:[1,1,0] op_sel_hi:[1,0,1] neg_lo:[1,0,0]
v_pk_fma_f32 v[212:213], v[24:25], v[44:45], v[128:129] op_sel:[1,1,0] op_sel_hi:[1,0,1] neg_lo:[1,0,0]
v_pk_fma_f32 v[214:215], v[28:29], v[46:47], v[160:161] op_sel:[1,1,0] op_sel_hi:[1,0,1] neg_lo:[1,0,0]
v_pk_fma_f32 v[18:19], v[28:29], v[48:49], v[192:193] op_sel:[1,1,0] op_sel_hi:[1,0,1] neg_lo:[1,0,0]
v_pk_fma_f32 v[40:41], v[20:21], v[40:41], v[208:209] op_sel:[0,0,0] op_sel_hi:[0,1,1]
v_pk_fma_f32 v[42:43], v[24:25], v[42:43], v[210:211] op_sel:[0,0,0] op_sel_hi:[0,1,1]
v_pk_fma_f32 v[44:45], v[24:25], v[44:45], v[212:213] op_sel:[0,0,0] op_sel_hi:[0,1,1]
v_pk_fma_f32 v[46:47], v[28:29], v[46:47], v[214:215] op_sel:[0,0,0] op_sel_hi:[0,1,1]
v_pk_fma_f32 v[48:49], v[28:29], v[48:49], v[18:19] op_sel:[0,0,0] op_sel_hi:[0,1,1]
v_pk_fma_f32 v[208:209], v[20:21], v[40:41], v[66:67] op_sel:[1,1,0] op_sel_hi:[1,0,1] neg_lo:[1,0,0]
v_pk_fma_f32 v[210:211], v[24:25], v[42:43], v[98:99] op_sel:[1,1,0] op_sel_hi:[1,0,1] neg_lo:[1,0,0]
v_pk_fma_f32 v[212:213], v[24:25], v[44:45], v[130:131] op_sel:[1,1,0] op_sel_hi:[1,0,1] neg_lo:[1,0,0]
v_pk_fma_f32 v[214:215], v[28:29], v[46:47], v[162:163] op_sel:[1,1,0] op_sel_hi:[1,0,1] neg_lo:[1,0,0]
v_pk_fma_f32 v[18:19], v[28:29], v[48:49], v[194:195] op_sel:[1,1,0] op_sel_hi:[1,0,1] neg_lo:[1,0,0]
v_pk_fma_f32 v[40:41], v[20:21], v[40:41], v[208:209] op_sel:[0,0,0] op_sel_hi:[0,1,1]
v_pk_fma_f32 v[42:43], v[24:25], v[42:43], v[210:211] op_sel:[0,0,0] op_sel_hi:[0,1,1]
v_pk_fma_f32 v[44:45], v[24:25], v[44:45], v[212:213] op_sel:[0,0,0] op_sel_hi:[0,1,1]
v_pk_fma_f32 v[46:47], v[28:29], v[46:47], v[214:215] op_sel:[0,0,0] op_sel_hi:[0,1,1]
v_pk_fma_f32 v[48:49], v[28:29], v[48:49], v[18:19] op_sel:[0,0,0] op_sel_hi:[0,1,1]
v_pk_fma_f32 v[208:209], v[20:21], v[40:41], v[68:69] op_sel:[1,1,0] op_sel_hi:[1,0,1] neg_lo:[1,0,0]
v_pk_fma_f32 v[210:211], v[24:25], v[42:43], v[100:101] op_sel:[1,1,0] op_sel_hi:[1,0,1] neg_lo:[1,0,0]
v_pk_fma_f32 v[212:213], v[24:25], v[44:45], v[132:133] op_sel:[1,1,0] op_sel_hi:[1,0,1] neg_lo:[1,0,0]
v_pk_fma_f32 v[214:215], v[28:29], v[46:47], v[164:165] op_sel:[1,1,0] op_sel_hi:[1,0,1] neg_lo:[1,0,0]
v_pk_fma_f32 v[18:19], v[28:29], v[48:49], v[196:197] op_sel:[1,1,0] op_sel_hi:[1,0,1] neg_lo:[1,0,0]
v_pk_fma_f32 v[40:41], v[20:21], v[40:41], v[208:209] op_sel:[0,0,0] op_sel_hi:[0,1,1]
v_pk_fma_f32 v[42:43], v[24:25], v[42:43], v[210:211] op_sel:[0,0,0] op_sel_hi:[0,1,1]
v_pk_fma_f32 v[44:45], v[24:25], v[44:45], v[212:213] op_sel:[0,0,0] op_sel_hi:[0,1,1]
v_pk_fma_f32 v[46:47], v[28:29], v[46:47], v[214:215] op_sel:[0,0,0] op_sel_hi:[0,1,1]
v_pk_fma_f32 v[48:49], v[28:29], v[48:49], v[18:19] op_sel:[0,0,0] op_sel_hi:[0,1,1]
v_pk_fma_f32 v[208:209], v[20:21], v[40:41], v[70:71] op_sel:[1,1,0] op_sel_hi:[1,0,1] neg_lo:[1,0,0]
v_pk_fma_f32 v[210:211], v[24:25], v[42:43], v[102:103] op_sel:[1,1,0] op_sel_hi:[1,0,1] neg_lo:[1,0,0]
v_pk_fma_f32 v[212:213], v[24:25], v[44:45], v[134:135] op_sel:[1,1,0] op_sel_hi:[1,0,1] neg_lo:[1,0,0]
v_pk_fma_f32 v[214:215], v[28:29], v[46:47], v[166:167] op_sel:[1,1,0] op_sel_hi:[1,0,1] neg_lo:[1,0,0]
v_pk_fma_f32 v[18:19], v[28:29], v[48:49], v[198:199] op_sel:[1,1,0] op_sel_hi:[1,0,1] neg_lo:[1,0,0]
v_pk_fma_f32 v[40:41], v[20:21], v[40:41], v[208:209] op_sel:[0,0,0] op_sel_hi:[0,1,1]
v_pk_fma_f32 v[42:43], v[24:25], v[42:43], v[210:211] op_sel:[0,0,0] op_sel_hi:[0,1,1]
v_pk_fma_f32 v[44:45], v[24:25], v[44:45], v[212:213] op_sel:[0,0,0] op_sel_hi:[0,1,1]
v_pk_fma_f32 v[46:47], v[28:29], v[46:47], v[214:215] op_sel:[0,0,0] op_sel_hi:[0,1,1]
v_pk_fma_f32 v[48:49], v[28:29], v[48:49], v[18:19] op_sel:[0,0,0] op_sel_hi:[0,1,1]
v_pk_fma_f32 v[208:209], v[20:21], v[40:41], v[72:73] op_sel:[1,1,0] op_sel_hi:[1,0,1] neg_lo:[1,0,0]
v_pk_fma_f32 v[210:211], v[24:25], v[42:43], v[104:105] op_sel:[1,1,0] op_sel_hi:[1,0,1] neg_lo:[1,0,0]
v_pk_fma_f32 v[212:213], v[24:25], v[44:45], v[136:137] op_sel:[1,1,0] op_sel_hi:[1,0,1] neg_lo:[1,0,0]
v_pk_fma_f32 v[214:215], v[28:29], v[46:47], v[168:169] op_sel:[1,1,0] op_sel_hi:[1,0,1] neg_lo:[1,0,0]
v_pk_fma_f32 v[18:19], v[28:29], v[48:49], v[200:201] op_sel:[1,1,0] op_sel_hi:[1,0,1] neg_lo:[1,0,0]
v_pk_fma_f32 v[40:41], v[20:21], v[40:41], v[208:209] op_sel:[0,0,0] op_sel_hi:[0,1,1]
v_pk_fma_f32 v[42:43], v[24:25], v[42:43], v[210:211] op_sel:[0,0,0] op_sel_hi:[0,1,1]
v_pk_fma_f32 v[44:45], v[24:25], v[44:45], v[212:213] op_sel:[0,0,0] op_sel_hi:[0,1,1]
v_pk_fma_f32 v[46:47], v[28:29], v[46:47], v[214:215] op_sel:[0,0,0] op_sel_hi:[0,1,1]
v_pk_fma_f32 v[48:49], v[28:29], v[48:49], v[18:19] op_sel:[0,0,0] op_sel_hi:[0,1,1]
v_pk_fma_f32 v[208:209], v[20:21], v[40:41], v[74:75] op_sel:[1,1,0] op_sel_hi:[1,0,1] neg_lo:[1,0,0]
v_pk_fma_f32 v[210:211], v[24:25], v[42:43], v[106:107] op_sel:[1,1,0] op_sel_hi:[1,0,1] neg_lo:[1,0,0]
v_pk_fma_f32 v[212:213], v[24:25], v[44:45], v[138:139] op_sel:[1,1,0] op_sel_hi:[1,0,1] neg_lo:[1,0,0]
v_pk_fma_f32 v[214:215], v[28:29], v[46:47], v[170:171] op_sel:[1,1,0] op_sel_hi:[1,0,1] neg_lo:[1,0,0]
v_pk_fma_f32 v[18:19], v[28:29], v[48:49], v[202:203] op_sel:[1,1,0] op_sel_hi:[1,0,1] neg_lo:[1,0,0]
v_pk_fma_f32 v[40:41], v[20:21], v[40:41], v[208:209] op_sel:[0,0,0] op_sel_hi:[0,1,1]
v_pk_fma_f32 v[42:43], v[24:25], v[42:43], v[210:211] op_sel:[0,0,0] op_sel_hi:[0,1,1]
v_pk_fma_f32 v[44:45], v[24:25], v[44:45], v[212:213] op_sel:[0,0,0] op_sel_hi:[0,1,1]
v_pk_fma_f32 v[46:47], v[28:29], v[46:47], v[214:215] op_sel:[0,0,0] op_sel_hi:[0,1,1]
v_pk_fma_f32 v[48:49], v[28:29], v[48:49], v[18:19] op_sel:[0,0,0] op_sel_hi:[0,1,1]
v_pk_fma_f32 v[208:209], v[20:21], v[40:41], v[76:77] op_sel:[1,1,0] op_sel_hi:[1,0,1] neg_lo:[1,0,0]
v_pk_fma_f32 v[210:211], v[24:25], v[42:43], v[108:109] op_sel:[1,1,0] op_sel_hi:[1,0,1] neg_lo:[1,0,0]
v_pk_fma_f32 v[212:213], v[24:25], v[44:45], v[140:141] op_sel:[1,1,0] op_sel_hi:[1,0,1] neg_lo:[1,0,0]
v_pk_fma_f32 v[214:215], v[28:29], v[46:47], v[172:173] op_sel:[1,1,0] op_sel_hi:[1,0,1] neg_lo:[1,0,0]
v_pk_fma_f32 v[18:19], v[28:29], v[48:49], v[204:205] op_sel:[1,1,0] op_sel_hi:[1,0,1] neg_lo:[1,0,0]
v_pk_fma_f32 v[40:41], v[20:21], v[40:41], v[208:209] op_sel:[0,0,0] op_sel_hi:[0,1,1]
v_pk_fma_f32 v[42:43], v[24:25], v[42:43], v[210:211] op_sel:[0,0,0] op_sel_hi:[0,1,1]
v_pk_fma_f32 v[44:45], v[24:25], v[44:45], v[212:213] op_sel:[0,0,0] op_sel_hi:[0,1,1]
v_pk_fma_f32 v[46:47], v[28:29], v[46:47], v[214:215] op_sel:[0,0,0] op_sel_hi:[0,1,1]
v_pk_fma_f32 v[48:49], v[28:29], v[48:49], v[18:19] op_sel:[0,0,0] op_sel_hi:[0,1,1]
v_pk_fma_f32 v[208:209], v[20:21], v[40:41], v[78:79] op_sel:[1,1,0] op_sel_hi:[1,0,1] neg_lo:[1,0,0]
v_pk_fma_f32 v[210:211], v[24:25], v[42:43], v[110:111] op_sel:[1,1,0] op_sel_hi:[1,0,1] neg_lo:[1,0,0]
v_pk_fma_f32 v[212:213], v[24:25], v[44:45], v[142:143] op_sel:[1,1,0] op_sel_hi:[1,0,1] neg_lo:[1,0,0]
v_pk_fma_f32 v[214:215], v[28:29], v[46:47], v[174:175] op_sel:[1,1,0] op_sel_hi:[1,0,1] neg_lo:[1,0,0]
v_pk_fma_f32 v[18:19], v[28:29], v[48:49], v[206:207] op_sel:[1,1,0] op_sel_hi:[1,0,1] neg_lo:[1,0,0]
v_pk_fma_f32 v[40:41], v[20:21], v[40:41], v[208:209] op_sel:[0,0,0] op_sel_hi:[0,1,1]
v_pk_fma_f32 v[42:43], v[24:25], v[42:43], v[210:211] op_sel:[0,0,0] op_sel_hi:[0,1,1]
v_pk_fma_f32 v[44:45], v[24:25], v[44:45], v[212:213] op_sel:[0,0,0] op_sel_hi:[0,1,1]
v_pk_fma_f32 v[46:47], v[28:29], v[46:47], v[214:215] op_sel:[0,0,0] op_sel_hi:[0,1,1]
v_pk_fma_f32 v[48:49], v[28:29], v[48:49], v[18:19] op_sel:[0,0,0] op_sel_hi:[0,1,1]
ds_write_b64 v51, v[40:41] offset:8192
ds_write_b64 v52, v[42:43] offset:0
ds_write_b64 v53, v[44:45] offset:0
ds_write_b64 v52, v[46:47] offset:2048
ds_write_b64 v53, v[48:49] offset:2048
s_waitcnt lgkmcnt(0)
s_barrier
v_lshrrev_b32 v48, 4, v1
s_lshl_b32 s11, s8, 6
v_add_u32 v48, s11, v48
v_min_u32 v48, 79, v48
    v_lshlrev_b32 v49, 5, v48
    v_add_u32 v49, 139264, v49
    ds_read_b128 v[40:43], v49 offset:16
    s_lshl_b32 s11, s6, 7
    s_lshl_b32 s12, s5, 4
    s_add_u32 s11, s11, s12
    v_add_u32 v47, s11, v48
    v_lshlrev_b32 v47, 4, v47
    s_add_u32 s64, s48, 23134208
    s_addc_u32 s65, s49, 0
    s_mov_b32 s66, 131072
    s_cmp_lt_u32 s3, 2
    s_cbranch_scc0 L1B_e2d
    v_lshrrev_b32 v46, 4, v48
    v_lshlrev_b32 v46, 11, v46
    v_and_b32 v49, 15, v48
    v_lshl_add_u32 v46, v49, 3, v46
    v_add_u32 v46, 142336, v46
    v_mov_b32 v44, 0
    v_mov_b32 v45, 0
    v_lshlrev_b32 v2, 3, v48
    v_add_u32 v2, 152576, v2
    v_mov_b32 v4, 1.0
    v_mov_b32 v5, 0
    v_mov_b32 v8, 0
    v_mov_b32 v9, 0
ds_read_b64 v[208:209], v46 offset:0
ds_read_b64 v[210:211], v46 offset:128
ds_read_b64 v[212:213], v46 offset:256
ds_read_b64 v[214:215], v46 offset:384
s_waitcnt lgkmcnt(3)
ds_write_b64 v46, v[44:45] offset:0
ds_write_b64 v2, v[4:5] offset:0
v_pk_fma_f32 v[48:49], v[40:41], v[44:45], v[208:209] op_sel:[1,1,0] op_sel_hi:[1,0,1] neg_lo:[1,0,0]
v_pk_fma_f32 v[6:7], v[40:41], v[4:5], v[8:9] op_sel:[1,1,0] op_sel_hi:[1,0,1] neg_lo:[1,0,0]
v_pk_fma_f32 v[44:45], v[40:41], v[44:45], v[48:49] op_sel:[0,0,0] op_sel_hi:[0,1,1]
v_pk_fma_f32 v[4:5], v[40:41], v[4:5], v[6:7] op_sel:[0,0,0] op_sel_hi:[0,1,1]
s_waitcnt lgkmcnt(4)
ds_write_b64 v46, v[44:45] offset:128
ds_write_b64 v2, v[4:5] offset:640
v_pk_fma_f32 v[48:49], v[40:41], v[44:45], v[210:211] op_sel:[1,1,0] op_sel_hi:[1,0,1] neg_lo:[1,0,0]
v_pk_fma_f32 v[6:7], v[40:41], v[4:5], v[8:9] op_sel:[1,1,0] op_sel_hi:[1,0,1] neg_lo:[1,0,0]
v_pk_fma_f32 v[44:45], v[40:41], v[44:45], v[48:49] op_sel:[0,0,0] op_sel_hi:[0,1,1]
v_pk_fma_f32 v[4:5], v[40:41], v[4:5], v[6:7] op_sel:[0,0,0] op_sel_hi:[0,1,1]
s_waitcnt lgkmcnt(5)
ds_write_b64 v46, v[44:45] offset:256
ds_write_b64 v2, v[4:5] offset:1280
v_pk_fma_f32 v[48:49], v[40:41], v[44:45], v[212:213] op_sel:[1,1,0] op_sel_hi:[1,0,1] neg_lo:[1,0,0]
v_pk_fma_f32 v[6:7], v[40:41], v[4:5], v[8:9] op_sel:[1,1,0] op_sel_hi:[1,0,1] neg_lo:[1,0,0]
v_pk_fma_f32 v[44:45], v[40:41], v[44:45], v[48:49] op_sel:[0,0,0] op_sel_hi:[0,1,1]
v_pk_fma_f32 v[4:5], v[40:41], v[4:5], v[6:7] op_sel:[0,0,0] op_sel_hi:[0,1,1]
s_waitcnt lgkmcnt(6)
ds_write_b64 v46, v[44:45] offset:384
ds_write_b64 v2, v[4:5] offset:1920
v_pk_fma_f32 v[48:49], v[40:41], v[44:45], v[214:215] op_sel:[1,1,0] op_sel_hi:[1,0,1] neg_lo:[1,0,0]
v_pk_fma_f32 v[6:7], v[40:41], v[4:5], v[8:9] op_sel:[1,1,0] op_sel_hi:[1,0,1] neg_lo:[1,0,0]
v_pk_fma_f32 v[44:45], v[40:41], v[44:45], v[48:49] op_sel:[0,0,0] op_sel_hi:[0,1,1]
v_pk_fma_f32 v[4:5], v[40:41], v[4:5], v[6:7] op_sel:[0,0,0] op_sel_hi:[0,1,1]
ds_read_b64 v[208:209], v46 offset:512
ds_read_b64 v[210:211], v46 offset:640
ds_read_b64 v[212:213], v46 offset:768
ds_read_b64 v[214:215], v46 offset:896
s_waitcnt lgkmcnt(3)
ds_write_b64 v46, v[44:45] offset:512
ds_write_b64 v2, v[4:5] offset:2560
v_pk_fma_f32 v[48:49], v[40:41], v[44:45], v[208:209] op_sel:[1,1,0] op_sel_hi:[1,0,1] neg_lo:[1,0,0]
v_pk_fma_f32 v[6:7], v[40:41], v[4:5], v[8:9] op_sel:[1,1,0] op_sel_hi:[1,0,1] neg_lo:[1,0,0]
v_pk_fma_f32 v[44:45], v[40:41], v[44:45], v[48:49] op_sel:[0,0,0] op_sel_hi:[0,1,1]
v_pk_fma_f32 v[4:5], v[40:41], v[4:5], v[6:7] op_sel:[0,0,0] op_sel_hi:[0,1,1]
s_waitcnt lgkmcnt(4)
ds_write_b64 v46, v[44:45] offset:640
ds_write_b64 v2, v[4:5] offset:3200
v_pk_fma_f32 v[48:49], v[40:41], v[44:45], v[210:211] op_sel:[1,1,0] op_sel_hi:[1,0,1] neg_lo:[1,0,0]
v_pk_fma_f32 v[6:7], v[40:41], v[4:5], v[8:9] op_sel:[1,1,0] op_sel_hi:[1,0,1] neg_lo:[1,0,0]
v_pk_fma_f32 v[44:45], v[40:41], v[44:45], v[48:49] op_sel:[0,0,0] op_sel_hi:[0,1,1]
v_pk_fma_f32 v[4:5], v[40:41], v[4:5], v[6:7] op_sel:[0,0,0] op_sel_hi:[0,1,1]
s_waitcnt lgkmcnt(5)
ds_write_b64 v46, v[44:45] offset:768
ds_write_b64 v2, v[4:5] offset:3840
v_pk_fma_f32 v[48:49], v[40:41], v[44:45], v[212:213] op_sel:[1,1,0] op_sel_hi:[1,0,1] neg_lo:[1,0,0]
v_pk_fma_f32 v[6:7], v[40:41], v[4:5], v[8:9] op_sel:[1,1,0] op_sel_hi:[1,0,1] neg_lo:[1,0,0]
v_pk_fma_f32 v[44:45], v[40:41], v[44:45], v[48:49] op_sel:[0,0,0] op_sel_hi:[0,1,1]
v_pk_fma_f32 v[4:5], v[40:41], v[4:5], v[6:7] op_sel:[0,0,0] op_sel_hi:[0,1,1]
s_waitcnt lgkmcnt(6)
ds_write_b64 v46, v[44:45] offset:896
ds_write_b64 v2, v[4:5] offset:4480
v_pk_fma_f32 v[48:49], v[40:41], v[44:45], v[214:215] op_sel:[1,1,0] op_sel_hi:[1,0,1] neg_lo:[1,0,0]
v_pk_fma_f32 v[6:7], v[40:41], v[4:5], v[8:9] op_sel:[1,1,0] op_sel_hi:[1,0,1] neg_lo:[1,0,0]
v_pk_fma_f32 v[44:45], v[40:41], v[44:45], v[48:49] op_sel:[0,0,0] op_sel_hi:[0,1,1]
v_pk_fma_f32 v[4:5], v[40:41], v[4:5], v[6:7] op_sel:[0,0,0] op_sel_hi:[0,1,1]
ds_read_b64 v[208:209], v46 offset:1024
ds_read_b64 v[210:211], v46 offset:1152
ds_read_b64 v[212:213], v46 offset:1280
ds_read_b64 v[214:215], v46 offset:1408
s_waitcnt lgkmcnt(3)
ds_write_b64 v46, v[44:45] offset:1024
ds_write_b64 v2, v[4:5] offset:5120
v_pk_fma_f32 v[48:49], v[40:41], v[44:45], v[208:209] op_sel:[1,1,0] op_sel_hi:[1,0,1] neg_lo:[1,0,0]
v_pk_fma_f32 v[6:7], v[40:41], v[4:5], v[8:9] op_sel:[1,1,0] op_sel_hi:[1,0,1] neg_lo:[1,0,0]
v_pk_fma_f32 v[44:45], v[40:41], v[44:45], v[48:49] op_sel:[0,0,0] op_sel_hi:[0,1,1]
v_pk_fma_f32 v[4:5], v[40:41], v[4:5], v[6:7] op_sel:[0,0,0] op_sel_hi:[0,1,1]
s_waitcnt lgkmcnt(4)
ds_write_b64 v46, v[44:45] offset:1152
ds_write_b64 v2, v[4:5] offset:5760
v_pk_fma_f32 v[48:49], v[40:41], v[44:45], v[210:211] op_sel:[1,1,0] op_sel_hi:[1,0,1] neg_lo:[1,0,0]
v_pk_fma_f32 v[6:7], v[40:41], v[4:5], v[8:9] op_sel:[1,1,0] op_sel_hi:[1,0,1] neg_lo:[1,0,0]
v_pk_fma_f32 v[44:45], v[40:41], v[44:45], v[48:49] op_sel:[0,0,0] op_sel_hi:[0,1,1]
v_pk_fma_f32 v[4:5], v[40:41], v[4:5], v[6:7] op_sel:[0,0,0] op_sel_hi:[0,1,1]
s_waitcnt lgkmcnt(5)
ds_write_b64 v46, v[44:45] offset:1280
ds_write_b64 v2, v[4:5] offset:6400
v_pk_fma_f32 v[48:49], v[40:41], v[44:45], v[212:213] op_sel:[1,1,0] op_sel_hi:[1,0,1] neg_lo:[1,0,0]
v_pk_fma_f32 v[6:7], v[40:41], v[4:5], v[8:9] op_sel:[1,1,0] op_sel_hi:[1,0,1] neg_lo:[1,0,0]
v_pk_fma_f32 v[44:45], v[40:41], v[44:45], v[48:49] op_sel:[0,0,0] op_sel_hi:[0,1,1]
v_pk_fma_f32 v[4:5], v[40:41], v[4:5], v[6:7] op_sel:[0,0,0] op_sel_hi:[0,1,1]
s_waitcnt lgkmcnt(6)
ds_write_b64 v46, v[44:45] offset:1408
ds_write_b64 v2, v[4:5] offset:7040
v_pk_fma_f32 v[48:49], v[40:41], v[44:45], v[214:215] op_sel:[1,1,0] op_sel_hi:[1,0,1] neg_lo:[1,0,0]
v_pk_fma_f32 v[6:7], v[40:41], v[4:5], v[8:9] op_sel:[1,1,0] op_sel_hi:[1,0,1] neg_lo:[1,0,0]
v_pk_fma_f32 v[44:45], v[40:41], v[44:45], v[48:49] op_sel:[0,0,0] op_sel_hi:[0,1,1]
v_pk_fma_f32 v[4:5], v[40:41], v[4:5], v[6:7] op_sel:[0,0,0] op_sel_hi:[0,1,1]
ds_read_b64 v[208:209], v46 offset:1536
ds_read_b64 v[210:211], v46 offset:1664
ds_read_b64 v[212:213], v46 offset:1792
ds_read_b64 v[214:215], v46 offset:1920
s_waitcnt lgkmcnt(3)
ds_write_b64 v46, v[44:45] offset:1536
ds_write_b64 v2, v[4:5] offset:7680
v_pk_fma_f32 v[48:49], v[40:41], v[44:45], v[208:209] op_sel:[1,1,0] op_sel_hi:[1,0,1] neg_lo:[1,0,0]
v_pk_fma_f32 v[6:7], v[40:41], v[4:5], v[8:9] op_sel:[1,1,0] op_sel_hi:[1,0,1] neg_lo:[1,0,0]
v_pk_fma_f32 v[44:45], v[40:41], v[44:45], v[48:49] op_sel:[0,0,0] op_sel_hi:[0,1,1]
v_pk_fma_f32 v[4:5], v[40:41], v[4:5], v[6:7] op_sel:[0,0,0] op_sel_hi:[0,1,1]
s_waitcnt lgkmcnt(4)
ds_write_b64 v46, v[44:45] offset:1664
ds_write_b64 v2, v[4:5] offset:8320
v_pk_fma_f32 v[48:49], v[40:41], v[44:45], v[210:211] op_sel:[1,1,0] op_sel_hi:[1,0,1] neg_lo:[1,0,0]
v_pk_fma_f32 v[6:7], v[40:41], v[4:5], v[8:9] op_sel:[1,1,0] op_sel_hi:[1,0,1] neg_lo:[1,0,0]
v_pk_fma_f32 v[44:45], v[40:41], v[44:45], v[48:49] op_sel:[0,0,0] op_sel_hi:[0,1,1]
v_pk_fma_f32 v[4:5], v[40:41], v[4:5], v[6:7] op_sel:[0,0,0] op_sel_hi:[0,1,1]
s_waitcnt lgkmcnt(5)
ds_write_b64 v46, v[44:45] offset:1792
ds_write_b64 v2, v[4:5] offset:8960
v_pk_fma_f32 v[48:49], v[40:41], v[44:45], v[212:213] op_sel:[1,1,0] op_sel_hi:[1,0,1] neg_lo:[1,0,0]
v_pk_fma_f32 v[6:7], v[40:41], v[4:5], v[8:9] op_sel:[1,1,0] op_sel_hi:[1,0,1] neg_lo:[1,0,0]
v_pk_fma_f32 v[44:45], v[40:41], v[44:45], v[48:49] op_sel:[0,0,0] op_sel_hi:[0,1,1]
v_pk_fma_f32 v[4:5], v[40:41], v[4:5], v[6:7] op_sel:[0,0,0] op_sel_hi:[0,1,1]
s_waitcnt lgkmcnt(6)
ds_write_b64 v46, v[44:45] offset:1920
ds_write_b64 v2, v[4:5] offset:9600
v_pk_fma_f32 v[48:49], v[40:41], v[44:45], v[214:215] op_sel:[1,1,0] op_sel_hi:[1,0,1] neg_lo:[1,0,0]
v_pk_fma_f32 v[6:7], v[40:41], v[4:5], v[8:9] op_sel:[1,1,0] op_sel_hi:[1,0,1] neg_lo:[1,0,0]
v_pk_fma_f32 v[44:45], v[40:41], v[44:45], v[48:49] op_sel:[0,0,0] op_sel_hi:[0,1,1]
v_pk_fma_f32 v[4:5], v[40:41], v[4:5], v[6:7] op_sel:[0,0,0] op_sel_hi:[0,1,1]
    s_lshl_b32 s11, s4, 14
    v_mov_b32 v208, v44
    v_mov_b32 v209, s98
    v_mov_b32 v210, v45
    v_mov_b32 v211, s98
s_cmp_eq_u32 s3, 0
s_cselect_b64 exec, -1, 0xffff
buffer_store_dwordx4 v[208:211], v47, s[64:67], s11 offen sc0 sc1
s_mov_b64 exec, -1
L1B_e2d:
s_sub_u32 s11, s4, 7
s_lshl_b32 s11, s11, 14
v_add_u32 v47, s11, v47
s_mov_b32 s92, 0xbdd2d3e8
s_mov_b32 s93, 0xbdd2d3e8
s_mov_b32 s94, 1.0
s_mov_b32 s95, 1.0
v_mov_b32 v18, 0xc0135761
v_mov_b32 v19, 0xc0135761
    s_lshl_b32 s11, s4, 1
    s_add_u32 s11, s11, s7
    s_mul_i32 s11, s11, 1441792
    s_add_u32 s56, s48, s11
    s_addc_u32 s57, s49, 0
    s_mov_b32 s58, 1441792
    s_mul_i32 s96, s8, 720896
    s_sub_u32 s97, 720896, s96
    s_mul_i32 s11, s6, 14
    s_lshl_b32 s12, s5, 2
    s_add_u32 s11, s11, s12
    s_lshl_b32 s12, s8, 0
    s_add_u32 s11, s11, s12
    s_lshl_b32 s11, s11, 10
    s_add_u32 s13, s96, s11
    s_add_u32 s14, s97, s11
v_accvgpr_read_b32 v14, a56
v_accvgpr_read_b32 v15, a57
v_accvgpr_read_b32 v16, a58
v_accvgpr_read_b32 v17, a59
v_accvgpr_read_b32 v10, a60
v_accvgpr_read_b32 v11, a61
v_accvgpr_read_b32 v12, a62
v_accvgpr_read_b32 v13, a63
v_pk_mul_f32 v[2:3], v[216:217], v[216:217]
v_pk_mul_f32 v[4:5], v[218:219], v[218:219]
v_pk_mul_f32 v[6:7], v[220:221], v[220:221]
v_pk_mul_f32 v[8:9], v[222:223], v[222:223]
v_pk_fma_f32 v[2:3], v[2:3], s[92:93], v[18:19]
v_pk_fma_f32 v[4:5], v[4:5], s[92:93], v[18:19]
v_pk_fma_f32 v[6:7], v[6:7], s[92:93], v[18:19]
v_pk_fma_f32 v[8:9], v[8:9], s[92:93], v[18:19]
v_pk_mul_f32 v[2:3], v[2:3], v[216:217]
v_pk_mul_f32 v[4:5], v[4:5], v[218:219]
v_pk_mul_f32 v[6:7], v[6:7], v[220:221]
v_pk_mul_f32 v[8:9], v[8:9], v[222:223]
v_exp_f32 v2, v2
v_exp_f32 v3, v3
v_exp_f32 v4, v4
v_exp_f32 v5, v5
v_exp_f32 v6, v6
v_exp_f32 v7, v7
v_exp_f32 v8, v8
v_exp_f32 v9, v9
v_pk_mul_f32 v[216:217], v[216:217], v[14:15]
v_pk_mul_f32 v[218:219], v[218:219], v[16:17]
v_pk_mul_f32 v[220:221], v[220:221], v[10:11]
v_pk_mul_f32 v[222:223], v[222:223], v[12:13]
v_pk_add_f32 v[2:3], v[2:3], s[94:95]
v_pk_add_f32 v[4:5], v[4:5], s[94:95]
v_pk_add_f32 v[6:7], v[6:7], s[94:95]
v_pk_add_f32 v[8:9], v[8:9], s[94:95]
v_rcp_f32 v2, v2
v_rcp_f32 v3, v3
v_rcp_f32 v4, v4
v_rcp_f32 v5, v5
v_rcp_f32 v6, v6
v_rcp_f32 v7, v7
v_rcp_f32 v8, v8
v_rcp_f32 v9, v9
s_add_u32 s11, s13, 0
v_pk_mul_f32 v[216:217], v[216:217], v[2:3]
v_pk_mul_f32 v[218:219], v[218:219], v[4:5]
v_pk_mul_f32 v[220:221], v[220:221], v[6:7]
v_pk_mul_f32 v[222:223], v[222:223], v[8:9]
v_cvt_pk_bf16_f32 v14, v216, v217
v_cvt_pk_bf16_f32 v15, v218, v219
v_cvt_pk_bf16_f32 v16, v220, v221
v_cvt_pk_bf16_f32 v17, v222, v223
buffer_store_dwordx4 v[14:17], v1, s[56:59], s11 offen sc0 sc1
v_accvgpr_read_b32 v216, a48
v_accvgpr_read_b32 v217, a49
v_accvgpr_read_b32 v218, a50
v_accvgpr_read_b32 v219, a51
v_accvgpr_read_b32 v220, a52
v_accvgpr_read_b32 v221, a53
v_accvgpr_read_b32 v222, a54
v_accvgpr_read_b32 v223, a55
v_pk_mul_f32 v[2:3], v[224:225], v[224:225]
v_pk_mul_f32 v[4:5], v[226:227], v[226:227]
v_pk_mul_f32 v[6:7], v[228:229], v[228:229]
v_pk_mul_f32 v[8:9], v[230:231], v[230:231]
v_pk_fma_f32 v[2:3], v[2:3], s[92:93], v[18:19]
v_pk_fma_f32 v[4:5], v[4:5], s[92:93], v[18:19]
v_pk_fma_f32 v[6:7], v[6:7], s[92:93], v[18:19]
v_pk_fma_f32 v[8:9], v[8:9], s[92:93], v[18:19]
v_pk_mul_f32 v[2:3], v[2:3], v[224:225]
v_pk_mul_f32 v[4:5], v[4:5], v[226:227]
v_pk_mul_f32 v[6:7], v[6:7], v[228:229]
v_pk_mul_f32 v[8:9], v[8:9], v[230:231]
v_exp_f32 v2, v2
v_exp_f32 v3, v3
v_exp_f32 v4, v4
v_exp_f32 v5, v5
v_exp_f32 v6, v6
v_exp_f32 v7, v7
v_exp_f32 v8, v8
v_exp_f32 v9, v9
s_add_u32 s52, s52, s77
s_addc_u32 s53, s53, 0
s_add_u32 m0, s76, 32768
s_nop 0
buffer_load_dwordx4 v0, s[52:55], s68 offen offset:0  lds
buffer_load_dwordx4 v0, s[52:55], s69 offen offset:1024  lds
buffer_load_dwordx4 v0, s[52:55], s70 offen offset:2048  lds
v_pk_mul_f32 v[224:225], v[224:225], v[216:217]
v_pk_mul_f32 v[226:227], v[226:227], v[218:219]
v_pk_mul_f32 v[228:229], v[228:229], v[220:221]
v_pk_mul_f32 v[230:231], v[230:231], v[222:223]
v_pk_add_f32 v[2:3], v[2:3], s[94:95]
v_pk_add_f32 v[4:5], v[4:5], s[94:95]
v_pk_add_f32 v[6:7], v[6:7], s[94:95]
v_pk_add_f32 v[8:9], v[8:9], s[94:95]
v_rcp_f32 v2, v2
v_rcp_f32 v3, v3
v_rcp_f32 v4, v4
v_rcp_f32 v5, v5
v_rcp_f32 v6, v6
v_rcp_f32 v7, v7
v_rcp_f32 v8, v8
v_rcp_f32 v9, v9
s_add_u32 s11, s13, 180224
v_pk_mul_f32 v[224:225], v[224:225], v[2:3]
v_pk_mul_f32 v[226:227], v[226:227], v[4:5]
v_pk_mul_f32 v[228:229], v[228:229], v[6:7]
v_pk_mul_f32 v[230:231], v[230:231], v[8:9]
v_cvt_pk_bf16_f32 v216, v224, v225
v_cvt_pk_bf16_f32 v217, v226, v227
v_cvt_pk_bf16_f32 v218, v228, v229
v_cvt_pk_bf16_f32 v219, v230, v231
buffer_store_dwordx4 v[216:219], v1, s[56:59], s11 offen sc0 sc1
v_accvgpr_read_b32 v224, a40
v_accvgpr_read_b32 v225, a41
v_accvgpr_read_b32 v226, a42
v_accvgpr_read_b32 v227, a43
v_accvgpr_read_b32 v228, a44
v_accvgpr_read_b32 v229, a45
v_accvgpr_read_b32 v230, a46
v_accvgpr_read_b32 v231, a47
v_pk_mul_f32 v[2:3], v[232:233], v[232:233]
v_pk_mul_f32 v[4:5], v[234:235], v[234:235]
v_pk_mul_f32 v[6:7], v[236:237], v[236:237]
v_pk_mul_f32 v[8:9], v[238:239], v[238:239]
v_pk_fma_f32 v[2:3], v[2:3], s[92:93], v[18:19]
v_pk_fma_f32 v[4:5], v[4:5], s[92:93], v[18:19]
v_pk_fma_f32 v[6:7], v[6:7], s[92:93], v[18:19]
v_pk_fma_f32 v[8:9], v[8:9], s[92:93], v[18:19]
v_pk_mul_f32 v[2:3], v[2:3], v[232:233]
v_pk_mul_f32 v[4:5], v[4:5], v[234:235]
v_pk_mul_f32 v[6:7], v[6:7], v[236:237]
v_pk_mul_f32 v[8:9], v[8:9], v[238:239]
v_exp_f32 v2, v2
v_exp_f32 v3, v3
v_exp_f32 v4, v4
v_exp_f32 v5, v5
v_exp_f32 v6, v6
v_exp_f32 v7, v7
v_exp_f32 v8, v8
v_exp_f32 v9, v9
buffer_load_dwordx4 v0, s[52:55], s71 offen offset:3072  lds
s_add_u32 m0, s76, 36864
s_nop 0
buffer_load_dwordx4 v0, s[52:55], s72 offen offset:0  lds
buffer_load_dwordx4 v0, s[52:55], s73 offen offset:1024  lds
v_pk_mul_f32 v[232:233], v[232:233], v[224:225]
v_pk_mul_f32 v[234:235], v[234:235], v[226:227]
v_pk_mul_f32 v[236:237], v[236:237], v[228:229]
v_pk_mul_f32 v[238:239], v[238:239], v[230:231]
v_pk_add_f32 v[2:3], v[2:3], s[94:95]
v_pk_add_f32 v[4:5], v[4:5], s[94:95]
v_pk_add_f32 v[6:7], v[6:7], s[94:95]
v_pk_add_f32 v[8:9], v[8:9], s[94:95]
v_rcp_f32 v2, v2
v_rcp_f32 v3, v3
v_rcp_f32 v4, v4
v_rcp_f32 v5, v5
v_rcp_f32 v6, v6
v_rcp_f32 v7, v7
v_rcp_f32 v8, v8
v_rcp_f32 v9, v9
s_add_u32 s11, s13, 360448
v_pk_mul_f32 v[232:233], v[232:233], v[2:3]
v_pk_mul_f32 v[234:235], v[234:235], v[4:5]
v_pk_mul_f32 v[236:237], v[236:237], v[6:7]
v_pk_mul_f32 v[238:239], v[238:239], v[8:9]
v_cvt_pk_bf16_f32 v224, v232, v233
v_cvt_pk_bf16_f32 v225, v234, v235
v_cvt_pk_bf16_f32 v226, v236, v237
v_cvt_pk_bf16_f32 v227, v238, v239
buffer_store_dwordx4 v[224:227], v1, s[56:59], s11 offen sc0 sc1
v_accvgpr_read_b32 v232, a32
v_accvgpr_read_b32 v233, a33
v_accvgpr_read_b32 v234, a34
v_accvgpr_read_b32 v235, a35
v_accvgpr_read_b32 v236, a36
v_accvgpr_read_b32 v237, a37
v_accvgpr_read_b32 v238, a38
v_accvgpr_read_b32 v239, a39
v_pk_mul_f32 v[2:3], v[240:241], v[240:241]
v_pk_mul_f32 v[4:5], v[242:243], v[242:243]
v_pk_mul_f32 v[6:7], v[244:245], v[244:245]
v_pk_mul_f32 v[8:9], v[246:247], v[246:247]
v_pk_fma_f32 v[2:3], v[2:3], s[92:93], v[18:19]
v_pk_fma_f32 v[4:5], v[4:5], s[92:93], v[18:19]
v_pk_fma_f32 v[6:7], v[6:7], s[92:93], v[18:19]
v_pk_fma_f32 v[8:9], v[8:9], s[92:93], v[18:19]
v_pk_mul_f32 v[2:3], v[2:3], v[240:241]
v_pk_mul_f32 v[4:5], v[4:5], v[242:243]
v_pk_mul_f32 v[6:7], v[6:7], v[244:245]
v_pk_mul_f32 v[8:9], v[8:9], v[246:247]
v_exp_f32 v2, v2
v_exp_f32 v3, v3
v_exp_f32 v4, v4
v_exp_f32 v5, v5
v_exp_f32 v6, v6
v_exp_f32 v7, v7
v_exp_f32 v8, v8
v_exp_f32 v9, v9
buffer_load_dwordx4 v0, s[52:55], s74 offen offset:2048  lds
buffer_load_dwordx4 v0, s[52:55], s75 offen offset:3072  lds
v_pk_mul_f32 v[240:241], v[240:241], v[232:233]
v_pk_mul_f32 v[242:243], v[242:243], v[234:235]
v_pk_mul_f32 v[244:245], v[244:245], v[236:237]
v_pk_mul_f32 v[246:247], v[246:247], v[238:239]
v_pk_add_f32 v[2:3], v[2:3], s[94:95]
v_pk_add_f32 v[4:5], v[4:5], s[94:95]
v_pk_add_f32 v[6:7], v[6:7], s[94:95]
v_pk_add_f32 v[8:9], v[8:9], s[94:95]
v_rcp_f32 v2, v2
v_rcp_f32 v3, v3
v_rcp_f32 v4, v4
v_rcp_f32 v5, v5
v_rcp_f32 v6, v6
v_rcp_f32 v7, v7
v_rcp_f32 v8, v8
v_rcp_f32 v9, v9
s_add_u32 s11, s13, 540672
v_pk_mul_f32 v[240:241], v[240:241], v[2:3]
v_pk_mul_f32 v[242:243], v[242:243], v[4:5]
v_pk_mul_f32 v[244:245], v[244:245], v[6:7]
v_pk_mul_f32 v[246:247], v[246:247], v[8:9]
v_cvt_pk_bf16_f32 v232, v240, v241
v_cvt_pk_bf16_f32 v233, v242, v243
v_cvt_pk_bf16_f32 v234, v244, v245
v_cvt_pk_bf16_f32 v235, v246, v247
buffer_store_dwordx4 v[232:235], v1, s[56:59], s11 offen sc0 sc1
v_accvgpr_read_b32 v240, a24
v_accvgpr_read_b32 v241, a25
v_accvgpr_read_b32 v242, a26
v_accvgpr_read_b32 v243, a27
v_accvgpr_read_b32 v244, a28
v_accvgpr_read_b32 v245, a29
v_accvgpr_read_b32 v246, a30
v_accvgpr_read_b32 v247, a31
v_pk_mul_f32 v[2:3], v[248:249], v[248:249]
v_pk_mul_f32 v[4:5], v[250:251], v[250:251]
v_pk_mul_f32 v[6:7], v[252:253], v[252:253]
v_pk_mul_f32 v[8:9], v[254:255], v[254:255]
v_pk_fma_f32 v[2:3], v[2:3], s[92:93], v[18:19]
v_pk_fma_f32 v[4:5], v[4:5], s[92:93], v[18:19]
v_pk_fma_f32 v[6:7], v[6:7], s[92:93], v[18:19]
v_pk_fma_f32 v[8:9], v[8:9], s[92:93], v[18:19]
v_pk_mul_f32 v[2:3], v[2:3], v[248:249]
v_pk_mul_f32 v[4:5], v[4:5], v[250:251]
v_pk_mul_f32 v[6:7], v[6:7], v[252:253]
v_pk_mul_f32 v[8:9], v[8:9], v[254:255]
v_exp_f32 v2, v2
v_exp_f32 v3, v3
v_exp_f32 v4, v4
v_exp_f32 v5, v5
v_exp_f32 v6, v6
v_exp_f32 v7, v7
v_exp_f32 v8, v8
v_exp_f32 v9, v9
s_add_u32 s52, s52, s77
s_addc_u32 s53, s53, 0
s_add_u32 m0, s76, 65536
s_nop 0
buffer_load_dwordx4 v0, s[52:55], s68 offen offset:0  lds
buffer_load_dwordx4 v0, s[52:55], s69 offen offset:1024  lds
v_pk_mul_f32 v[248:249], v[248:249], v[240:241]
v_pk_mul_f32 v[250:251], v[250:251], v[242:243]
v_pk_mul_f32 v[252:253], v[252:253], v[244:245]
v_pk_mul_f32 v[254:255], v[254:255], v[246:247]
v_pk_add_f32 v[2:3], v[2:3], s[94:95]
v_pk_add_f32 v[4:5], v[4:5], s[94:95]
v_pk_add_f32 v[6:7], v[6:7], s[94:95]
v_pk_add_f32 v[8:9], v[8:9], s[94:95]
v_rcp_f32 v2, v2
v_rcp_f32 v3, v3
v_rcp_f32 v4, v4
v_rcp_f32 v5, v5
v_rcp_f32 v6, v6
v_rcp_f32 v7, v7
v_rcp_f32 v8, v8
v_rcp_f32 v9, v9
s_add_u32 s11, s14, 0
v_pk_mul_f32 v[248:249], v[248:249], v[2:3]
v_pk_mul_f32 v[250:251], v[250:251], v[4:5]
v_pk_mul_f32 v[252:253], v[252:253], v[6:7]
v_pk_mul_f32 v[254:255], v[254:255], v[8:9]
v_cvt_pk_bf16_f32 v240, v248, v249
v_cvt_pk_bf16_f32 v241, v250, v251
v_cvt_pk_bf16_f32 v242, v252, v253
v_cvt_pk_bf16_f32 v243, v254, v255
buffer_store_dwordx4 v[240:243], v1, s[56:59], s11 offen sc0 sc1
v_accvgpr_read_b32 v248, a80
v_accvgpr_read_b32 v249, a81
v_accvgpr_read_b32 v250, a82
v_accvgpr_read_b32 v251, a83
v_accvgpr_read_b32 v252, a16
v_accvgpr_read_b32 v253, a17
v_accvgpr_read_b32 v254, a18
v_accvgpr_read_b32 v255, a19
v_accvgpr_read_b32 v244, a84
v_accvgpr_read_b32 v245, a85
v_accvgpr_read_b32 v246, a86
v_accvgpr_read_b32 v247, a87
v_accvgpr_read_b32 v240, a20
v_accvgpr_read_b32 v241, a21
v_accvgpr_read_b32 v242, a22
v_accvgpr_read_b32 v243, a23
v_pk_mul_f32 v[2:3], v[248:249], v[248:249]
v_pk_mul_f32 v[4:5], v[250:251], v[250:251]
v_pk_mul_f32 v[6:7], v[244:245], v[244:245]
v_pk_mul_f32 v[8:9], v[246:247], v[246:247]
v_pk_fma_f32 v[2:3], v[2:3], s[92:93], v[18:19]
v_pk_fma_f32 v[4:5], v[4:5], s[92:93], v[18:19]
v_pk_fma_f32 v[6:7], v[6:7], s[92:93], v[18:19]
v_pk_fma_f32 v[8:9], v[8:9], s[92:93], v[18:19]
v_pk_mul_f32 v[2:3], v[2:3], v[248:249]
v_pk_mul_f32 v[4:5], v[4:5], v[250:251]
v_pk_mul_f32 v[6:7], v[6:7], v[244:245]
v_pk_mul_f32 v[8:9], v[8:9], v[246:247]
v_exp_f32 v2, v2
v_exp_f32 v3, v3
v_exp_f32 v4, v4
v_exp_f32 v5, v5
v_exp_f32 v6, v6
v_exp_f32 v7, v7
v_exp_f32 v8, v8
v_exp_f32 v9, v9
buffer_load_dwordx4 v0, s[52:55], s70 offen offset:2048  lds
buffer_load_dwordx4 v0, s[52:55], s71 offen offset:3072  lds
v_pk_mul_f32 v[248:249], v[248:249], v[252:253]
v_pk_mul_f32 v[250:251], v[250:251], v[254:255]
v_pk_mul_f32 v[244:245], v[244:245], v[240:241]
v_pk_mul_f32 v[246:247], v[246:247], v[242:243]
v_pk_add_f32 v[2:3], v[2:3], s[94:95]
v_pk_add_f32 v[4:5], v[4:5], s[94:95]
v_pk_add_f32 v[6:7], v[6:7], s[94:95]
v_pk_add_f32 v[8:9], v[8:9], s[94:95]
v_rcp_f32 v2, v2
v_rcp_f32 v3, v3
v_rcp_f32 v4, v4
v_rcp_f32 v5, v5
v_rcp_f32 v6, v6
v_rcp_f32 v7, v7
v_rcp_f32 v8, v8
v_rcp_f32 v9, v9
s_add_u32 s11, s14, 180224
v_pk_mul_f32 v[248:249], v[248:249], v[2:3]
v_pk_mul_f32 v[250:251], v[250:251], v[4:5]
v_pk_mul_f32 v[244:245], v[244:245], v[6:7]
v_pk_mul_f32 v[246:247], v[246:247], v[8:9]
v_cvt_pk_bf16_f32 v252, v248, v249
v_cvt_pk_bf16_f32 v253, v250, v251
v_cvt_pk_bf16_f32 v254, v244, v245
v_cvt_pk_bf16_f32 v255, v246, v247
buffer_store_dwordx4 v[252:255], v1, s[56:59], s11 offen sc0 sc1
s_sub_u32 s11, s3, 2
s_cmp_lt_u32 s11, 2
s_cbranch_scc0 L1B_nopoll
v_add_u32 v48, 0, v47
buffer_load_dwordx4 v[14:17], v48, s[64:67], 0 offen sc0 sc1
v_add_u32 v48, 16384, v47
buffer_load_dwordx4 v[10:13], v48, s[64:67], 0 offen sc0 sc1
v_add_u32 v48, 32768, v47
buffer_load_dwordx4 v[216:219], v48, s[64:67], 0 offen sc0 sc1
v_add_u32 v48, 49152, v47
buffer_load_dwordx4 v[220:223], v48, s[64:67], 0 offen sc0 sc1
v_add_u32 v48, 65536, v47
buffer_load_dwordx4 v[224:227], v48, s[64:67], 0 offen sc0 sc1
v_add_u32 v48, 81920, v47
buffer_load_dwordx4 v[228:231], v48, s[64:67], 0 offen sc0 sc1
v_add_u32 v48, 98304, v47
buffer_load_dwordx4 v[232:235], v48, s[64:67], 0 offen sc0 sc1
L1B_nopoll:
v_accvgpr_read_b32 v248, a72
v_accvgpr_read_b32 v249, a73
v_accvgpr_read_b32 v250, a74
v_accvgpr_read_b32 v251, a75
v_accvgpr_read_b32 v244, a8
v_accvgpr_read_b32 v245, a9
v_accvgpr_read_b32 v246, a10
v_accvgpr_read_b32 v247, a11
v_accvgpr_read_b32 v240, a76
v_accvgpr_read_b32 v241, a77
v_accvgpr_read_b32 v242, a78
v_accvgpr_read_b32 v243, a79
v_accvgpr_read_b32 v252, a12
v_accvgpr_read_b32 v253, a13
v_accvgpr_read_b32 v254, a14
v_accvgpr_read_b32 v255, a15
v_pk_mul_f32 v[2:3], v[248:249], v[248:249]
v_pk_mul_f32 v[4:5], v[250:251], v[250:251]
v_pk_mul_f32 v[6:7], v[240:241], v[240:241]
v_pk_mul_f32 v[8:9], v[242:243], v[242:243]
v_pk_fma_f32 v[2:3], v[2:3], s[92:93], v[18:19]
v_pk_fma_f32 v[4:5], v[4:5], s[92:93], v[18:19]
v_pk_fma_f32 v[6:7], v[6:7], s[92:93], v[18:19]
v_pk_fma_f32 v[8:9], v[8:9], s[92:93], v[18:19]
v_pk_mul_f32 v[2:3], v[2:3], v[248:249]
v_pk_mul_f32 v[4:5], v[4:5], v[250:251]
v_pk_mul_f32 v[6:7], v[6:7], v[240:241]
v_pk_mul_f32 v[8:9], v[8:9], v[242:243]
v_exp_f32 v2, v2
v_exp_f32 v3, v3
v_exp_f32 v4, v4
v_exp_f32 v5, v5
v_exp_f32 v6, v6
v_exp_f32 v7, v7
v_exp_f32 v8, v8
v_exp_f32 v9, v9
s_add_u32 m0, s76, 69632
s_nop 0
buffer_load_dwordx4 v0, s[52:55], s72 offen offset:0  lds
buffer_load_dwordx4 v0, s[52:55], s73 offen offset:1024  lds
v_pk_mul_f32 v[248:249], v[248:249], v[244:245]
v_pk_mul_f32 v[250:251], v[250:251], v[246:247]
v_pk_mul_f32 v[240:241], v[240:241], v[252:253]
v_pk_mul_f32 v[242:243], v[242:243], v[254:255]
v_pk_add_f32 v[2:3], v[2:3], s[94:95]
v_pk_add_f32 v[4:5], v[4:5], s[94:95]
v_pk_add_f32 v[6:7], v[6:7], s[94:95]
v_pk_add_f32 v[8:9], v[8:9], s[94:95]
v_rcp_f32 v2, v2
v_rcp_f32 v3, v3
v_rcp_f32 v4, v4
v_rcp_f32 v5, v5
v_rcp_f32 v6, v6
v_rcp_f32 v7, v7
v_rcp_f32 v8, v8
v_rcp_f32 v9, v9
s_add_u32 s11, s14, 360448
v_pk_mul_f32 v[248:249], v[248:249], v[2:3]
v_pk_mul_f32 v[250:251], v[250:251], v[4:5]
v_pk_mul_f32 v[240:241], v[240:241], v[6:7]
v_pk_mul_f32 v[242:243], v[242:243], v[8:9]
v_cvt_pk_bf16_f32 v244, v248, v249
v_cvt_pk_bf16_f32 v245, v250, v251
v_cvt_pk_bf16_f32 v246, v240, v241
v_cvt_pk_bf16_f32 v247, v242, v243
buffer_store_dwordx4 v[244:247], v1, s[56:59], s11 offen sc0 sc1
v_accvgpr_read_b32 v248, a64
v_accvgpr_read_b32 v249, a65
v_accvgpr_read_b32 v250, a66
v_accvgpr_read_b32 v251, a67
v_accvgpr_read_b32 v240, a0
v_accvgpr_read_b32 v241, a1
v_accvgpr_read_b32 v242, a2
v_accvgpr_read_b32 v243, a3
v_accvgpr_read_b32 v252, a68
v_accvgpr_read_b32 v253, a69
v_accvgpr_read_b32 v254, a70
v_accvgpr_read_b32 v255, a71
v_accvgpr_read_b32 v244, a4
v_accvgpr_read_b32 v245, a5
v_accvgpr_read_b32 v246, a6
v_accvgpr_read_b32 v247, a7
v_pk_mul_f32 v[2:3], v[248:249], v[248:249]
v_pk_mul_f32 v[4:5], v[250:251], v[250:251]
v_pk_mul_f32 v[6:7], v[252:253], v[252:253]
v_pk_mul_f32 v[8:9], v[254:255], v[254:255]
v_pk_fma_f32 v[2:3], v[2:3], s[92:93], v[18:19]
v_pk_fma_f32 v[4:5], v[4:5], s[92:93], v[18:19]
v_pk_fma_f32 v[6:7], v[6:7], s[92:93], v[18:19]
v_pk_fma_f32 v[8:9], v[8:9], s[92:93], v[18:19]
v_pk_mul_f32 v[2:3], v[2:3], v[248:249]
v_pk_mul_f32 v[4:5], v[4:5], v[250:251]
v_pk_mul_f32 v[6:7], v[6:7], v[252:253]
v_pk_mul_f32 v[8:9], v[8:9], v[254:255]
v_exp_f32 v2, v2
v_exp_f32 v3, v3
v_exp_f32 v4, v4
v_exp_f32 v5, v5
v_exp_f32 v6, v6
v_exp_f32 v7, v7
v_exp_f32 v8, v8
v_exp_f32 v9, v9
buffer_load_dwordx4 v0, s[52:55], s74 offen offset:2048  lds
buffer_load_dwordx4 v0, s[52:55], s75 offen offset:3072  lds
v_pk_mul_f32 v[248:249], v[248:249], v[240:241]
v_pk_mul_f32 v[250:251], v[250:251], v[242:243]
v_pk_mul_f32 v[252:253], v[252:253], v[244:245]
v_pk_mul_f32 v[254:255], v[254:255], v[246:247]
v_pk_add_f32 v[2:3], v[2:3], s[94:95]
v_pk_add_f32 v[4:5], v[4:5], s[94:95]
v_pk_add_f32 v[6:7], v[6:7], s[94:95]
v_pk_add_f32 v[8:9], v[8:9], s[94:95]
v_rcp_f32 v2, v2
v_rcp_f32 v3, v3
v_rcp_f32 v4, v4
v_rcp_f32 v5, v5
v_rcp_f32 v6, v6
v_rcp_f32 v7, v7
v_rcp_f32 v8, v8
v_rcp_f32 v9, v9
s_add_u32 s11, s14, 540672
v_pk_mul_f32 v[248:249], v[248:249], v[2:3]
v_pk_mul_f32 v[250:251], v[250:251], v[4:5]
v_pk_mul_f32 v[252:253], v[252:253], v[6:7]
v_pk_mul_f32 v[254:255], v[254:255], v[8:9]
v_cvt_pk_bf16_f32 v240, v248, v249
v_cvt_pk_bf16_f32 v241, v250, v251
v_cvt_pk_bf16_f32 v242, v252, v253
v_cvt_pk_bf16_f32 v243, v254, v255
buffer_store_dwordx4 v[240:243], v1, s[56:59], s11 offen sc0 sc1
    v_lshrrev_b32 v2, 4, v1
    v_lshrrev_b32 v3, 3, v2
    v_and_b32 v4, 7, v2
    v_lshrrev_b32 v5, 4, v2
    v_mov_b32 v240, v0
    v_mov_b32 v241, v0
    v_xor_b32 v6, v4, v5
    v_lshlrev_b32 v6, 4, v6
    v_lshl_add_u32 v242, v3, 11, v6
    v_bfe_u32 v9, v2, 2, 2
    v_lshrrev_b32 v7, 5, v2
    v_lshlrev_b32 v208, 3, v7
    v_lshl_add_u32 v208, v9, 1, v208
    v_and_b32 v209, 1, v5
    v_add_u32 v208, v208, v209
    v_lshlrev_b32 v208, 7, v208
    v_and_b32 v8, 3, v2
    v_lshl_add_u32 v208, v8, 3, v208
v_xor_b32 v8, 0, v9
v_lshl_add_u32 v244, v8, 5, v208
v_xor_b32 v8, 1, v9
v_lshl_add_u32 v245, v8, 5, v208
v_xor_b32 v8, 2, v9
v_lshl_add_u32 v246, v8, 5, v208
v_xor_b32 v8, 3, v9
v_lshl_add_u32 v247, v8, 5, v208
    v_and_b32 v210, 15, v2
    v_lshrrev_b32 v8, 1, v210
    v_xor_b32 v8, v7, v8
    v_lshlrev_b32 v8, 4, v8
    v_lshl_add_u32 v8, v210, 7, v8
    v_lshl_add_u32 v248, v209, 14, v8
    v_xor_b32 v249, 32, v248
    v_xor_b32 v250, 64, v248
    v_xor_b32 v251, 96, v248
s_sub_u32 s11, s3, 2
s_cmp_lt_u32 s11, 2
s_cbranch_scc0 L1B_e4d
s_mov_b32 s10, 0x40000
s_waitcnt vmcnt(6)
s_branch L1B_chk
L1B_poll:
v_add_u32 v48, 0, v47
buffer_load_dwordx4 v[14:17], v48, s[64:67], 0 offen sc0 sc1
v_add_u32 v48, 16384, v47
buffer_load_dwordx4 v[10:13], v48, s[64:67], 0 offen sc0 sc1
v_add_u32 v48, 32768, v47
buffer_load_dwordx4 v[216:219], v48, s[64:67], 0 offen sc0 sc1
v_add_u32 v48, 49152, v47
buffer_load_dwordx4 v[220:223], v48, s[64:67], 0 offen sc0 sc1
v_add_u32 v48, 65536, v47
buffer_load_dwordx4 v[224:227], v48, s[64:67], 0 offen sc0 sc1
v_add_u32 v48, 81920, v47
buffer_load_dwordx4 v[228:231], v48, s[64:67], 0 offen sc0 sc1
v_add_u32 v48, 98304, v47
buffer_load_dwordx4 v[232:235], v48, s[64:67], 0 offen sc0 sc1
s_waitcnt vmcnt(0)
L1B_chk:
s_mov_b64 s[92:93], -1
s_cmp_ge_u32 s4, 7
s_cselect_b32 s11, s98, 0
v_cmp_eq_u32 vcc, s11, v15
s_and_b64 s[92:93], s[92:93], vcc
v_cmp_eq_u32 vcc, s11, v17
s_and_b64 s[92:93], s[92:93], vcc
s_cmp_ge_u32 s4, 6
s_cselect_b32 s11, s98, 0
v_cmp_eq_u32 vcc, s11, v11
s_and_b64 s[92:93], s[92:93], vcc
v_cmp_eq_u32 vcc, s11, v13
s_and_b64 s[92:93], s[92:93], vcc
s_cmp_ge_u32 s4, 5
s_cselect_b32 s11, s98, 0
v_cmp_eq_u32 vcc, s11, v217
s_and_b64 s[92:93], s[92:93], vcc
v_cmp_eq_u32 vcc, s11, v219
s_and_b64 s[92:93], s[92:93], vcc
s_cmp_ge_u32 s4, 4
s_cselect_b32 s11, s98, 0
v_cmp_eq_u32 vcc, s11, v221
s_and_b64 s[92:93], s[92:93], vcc
v_cmp_eq_u32 vcc, s11, v223
s_and_b64 s[92:93], s[92:93], vcc
s_cmp_ge_u32 s4, 3
s_cselect_b32 s11, s98, 0
v_cmp_eq_u32 vcc, s11, v225
s_and_b64 s[92:93], s[92:93], vcc
v_cmp_eq_u32 vcc, s11, v227
s_and_b64 s[92:93], s[92:93], vcc
s_cmp_ge_u32 s4, 2
s_cselect_b32 s11, s98, 0
v_cmp_eq_u32 vcc, s11, v229
s_and_b64 s[92:93], s[92:93], vcc
v_cmp_eq_u32 vcc, s11, v231
s_and_b64 s[92:93], s[92:93], vcc
s_cmp_ge_u32 s4, 1
s_cselect_b32 s11, s98, 0
v_cmp_eq_u32 vcc, s11, v233
s_and_b64 s[92:93], s[92:93], vcc
v_cmp_eq_u32 vcc, s11, v235
s_and_b64 s[92:93], s[92:93], vcc
s_sub_u32 s10, s10, 1
s_cbranch_scc1 L1B_polld
s_cmp_eq_u64 s[92:93], -1
s_cbranch_scc0 L1B_poll
L1B_polld:
v_mov_b32 v15, v16
v_mov_b32 v11, v12
v_mov_b32 v217, v218
v_mov_b32 v221, v222
v_mov_b32 v225, v226
v_mov_b32 v229, v230
v_mov_b32 v233, v234
v_lshrrev_b32 v46, 4, v1
s_lshl_b32 s11, s8, 6
v_add_u32 v46, s11, v46
v_min_u32 v46, 79, v46
v_lshlrev_b32 v46, 3, v46
v_add_u32 v46, 162816, v46
v_pk_fma_f32 v[48:49], v[42:43], v[14:15], v[10:11] op_sel:[1,1,0] op_sel_hi:[1,0,1] neg_lo:[1,0,0]
v_pk_fma_f32 v[44:45], v[42:43], v[14:15], v[48:49] op_sel:[0,0,0] op_sel_hi:[0,1,1]
v_pk_fma_f32 v[48:49], v[42:43], v[44:45], v[216:217] op_sel:[1,1,0] op_sel_hi:[1,0,1] neg_lo:[1,0,0]
v_pk_fma_f32 v[44:45], v[42:43], v[44:45], v[48:49] op_sel:[0,0,0] op_sel_hi:[0,1,1]
v_pk_fma_f32 v[48:49], v[42:43], v[44:45], v[220:221] op_sel:[1,1,0] op_sel_hi:[1,0,1] neg_lo:[1,0,0]
v_pk_fma_f32 v[44:45], v[42:43], v[44:45], v[48:49] op_sel:[0,0,0] op_sel_hi:[0,1,1]
v_pk_fma_f32 v[48:49], v[42:43], v[44:45], v[224:225] op_sel:[1,1,0] op_sel_hi:[1,0,1] neg_lo:[1,0,0]
v_pk_fma_f32 v[44:45], v[42:43], v[44:45], v[48:49] op_sel:[0,0,0] op_sel_hi:[0,1,1]
v_pk_fma_f32 v[48:49], v[42:43], v[44:45], v[228:229] op_sel:[1,1,0] op_sel_hi:[1,0,1] neg_lo:[1,0,0]
v_pk_fma_f32 v[44:45], v[42:43], v[44:45], v[48:49] op_sel:[0,0,0] op_sel_hi:[0,1,1]
v_pk_fma_f32 v[48:49], v[42:43], v[44:45], v[232:233] op_sel:[1,1,0] op_sel_hi:[1,0,1] neg_lo:[1,0,0]
v_pk_fma_f32 v[44:45], v[42:43], v[44:45], v[48:49] op_sel:[0,0,0] op_sel_hi:[0,1,1]
ds_write_b64 v46, v[44:45]
L1B_e4d:
    v_lshrrev_b32 v4, 4, v1
    v_and_b32 v5, 15, v4
    v_lshrrev_b32 v6, 4, v4
    v_and_b32 v2, 3, v5
    v_lshl_add_u32 v2, v6, 2, v2
    v_and_b32 v3, 4, v5
    v_xor_b32 v2, v2, v3
    v_lshrrev_b32 v3, 2, v5
    v_lshl_add_u32 v2, v3, 4, v2
    v_lshlrev_b32 v2, 4, v2
    s_lshl_b32 s11, s3, 13
    s_add_u32 s11, s11, 98304
    v_add_u32 v2, s11, v2
    v_and_b32 v10, 3, v4
    v_lshl_add_u32 v3, v10, 2, v3
    v_lshlrev_b32 v3, 4, v3
    v_lshrrev_b32 v10, 5, v4
    v_lshl_add_u32 v3, v10, 9, v3
    v_and_b32 v10, 1, v6
    v_lshl_add_u32 v3, v10, 3, v3
    v_add_u32 v3, s11, v3
    v_xor_b32 v10, 64, v3
    v_lshlrev_b32 v7, 3, v5
    v_mul_u32_u24 v6, 640, v6
    v_add_u32 v6, v6, v7
    s_mul_i32 s11, s7, 5120
    s_add_u32 s11, s11, 152576
    s_mul_i32 s12, s8, 2560
    s_add_u32 s13, s11, s12
    s_sub_u32 s12, 2560, s12
    s_add_u32 s14, s11, s12
    v_add_u32 v8, s13, v6
    v_add_u32 v9, s14, v6
    v_add_u32 v7, 162816, v7
    s_lshl_b32 s11, s6, 3
    s_add_u32 s11, s11, s5
    s_add_u32 s11, s11, 112
    s_lshl_b32 s11, s11, 10
    s_add_u32 s13, s96, s11
    s_lshl_b32 s12, s8, 11
    s_add_u32 s11, s11, s12
    s_add_u32 s96, s96, s11
    s_add_u32 s97, s97, s11
    s_lshl_b32 s12, s8, 8
v_add_u32 v4, s12, v8
v_add_u32 v5, s12, v9
v_add_u32 v6, s12, v7
    s_andn2_b32 s11, s80, 1
    s_add_u32 s11, s11, s15
    s_lshl_b32 s84, s11, 7
    s_lshl_b32 s12, s4, 5
    s_add_u32 s12, s12, s9
    s_lshl_b32 s85, s12, 3
    s_lshr_b32 s12, s12, 4
    s_cmp_eq_u32 s11, s12
    s_cselect_b32 s88, 0x10001, 0
    s_and_b32 s11, s9, 15
    s_lshl_b32 s88, s88, s11
    s_mov_b32 s89, s88
    s_add_u32 s84, s84, 270336
    s_add_u32 s85, s85, 270336
v_bfe_u32 v54, v1, 4, 4
v_lshlrev_b32 v54, 3, v54
s_add_u32 s64, s48, 23068672
s_addc_u32 s65, s49, 0
s_mov_b32 s66, 327680
s_waitcnt vmcnt(0) lgkmcnt(0)
s_barrier
    s_cmp_eq_u32 s3, 0
    s_cbranch_scc0 L1B_pg_d
    s_add_u32 s11, s85, 0
    v_mov_b32 v238, s98
    v_mov_b32 v239, s98
    s_mov_b64 exec, 1
    buffer_store_dwordx2 v[238:239], v54, s[64:67], s11 offen sc0 sc1
    s_mov_b64 exec, -1
    s_nop 1
L1B_pg_d:
ds_read_b64 v[40:41], v51 offset:8192
ds_read_b64 v[14:15], v8 offset:512
ds_read_b64 v[222:223], v7 offset:512
ds_read_b64 v[42:43], v52 offset:0
ds_read_b64 v[16:17], v4 offset:0
ds_read_b64 v[224:225], v6 offset:0
ds_read_b64 v[44:45], v53 offset:0
ds_read_b64 v[216:217], v5 offset:0
ds_read_b64 v[46:47], v52 offset:2048
ds_read_b64 v[218:219], v4 offset:128
ds_read_b64 v[226:227], v6 offset:128
ds_read_b64 v[48:49], v53 offset:2048
ds_read_b64 v[220:221], v5 offset:128
    s_lshl_b32 s11, s80, 2
    s_add_u32 s11, s11, s3
    s_mul_i32 s11, s11, 360448
    s_add_u32 s60, s48, s11
    s_addc_u32 s61, s49, 0
    s_mov_b32 s62, 360448
    s_mul_i32 s78, s15, 57344
    s_add_u32 s79, s78, 180224
    s_xor_b32 s76, s76, 65536
    s_waitcnt lgkmcnt(0)
v_pk_fma_f32 v[208:209], v[14:15], v[222:223], v[40:41] op_sel:[1,1,0] op_sel_hi:[1,0,1] neg_lo:[1,0,0]
v_pk_fma_f32 v[210:211], v[16:17], v[224:225], v[42:43] op_sel:[1,1,0] op_sel_hi:[1,0,1] neg_lo:[1,0,0]
v_pk_fma_f32 v[212:213], v[216:217], v[224:225], v[44:45] op_sel:[1,1,0] op_sel_hi:[1,0,1] neg_lo:[1,0,0]
v_pk_fma_f32 v[214:215], v[218:219], v[226:227], v[46:47] op_sel:[1,1,0] op_sel_hi:[1,0,1] neg_lo:[1,0,0]
v_pk_fma_f32 v[18:19], v[220:221], v[226:227], v[48:49] op_sel:[1,1,0] op_sel_hi:[1,0,1] neg_lo:[1,0,0]
v_pk_fma_f32 v[40:41], v[14:15], v[222:223], v[208:209] op_sel:[0,0,0] op_sel_hi:[0,1,1]
v_pk_fma_f32 v[42:43], v[16:17], v[224:225], v[210:211] op_sel:[0,0,0] op_sel_hi:[0,1,1]
v_pk_fma_f32 v[44:45], v[216:217], v[224:225], v[212:213] op_sel:[0,0,0] op_sel_hi:[0,1,1]
v_pk_fma_f32 v[46:47], v[218:219], v[226:227], v[214:215] op_sel:[0,0,0] op_sel_hi:[0,1,1]
v_pk_fma_f32 v[48:49], v[220:221], v[226:227], v[18:19] op_sel:[0,0,0] op_sel_hi:[0,1,1]
v_pk_fma_f32 v[208:209], v[20:21], v[40:41], v[32:33] op_sel:[1,1,0] op_sel_hi:[1,0,1] neg_lo:[1,0,0]
v_pk_fma_f32 v[210:211], v[24:25], v[42:43], v[80:81] op_sel:[1,1,0] op_sel_hi:[1,0,1] neg_lo:[1,0,0]
v_pk_fma_f32 v[212:213], v[24:25], v[44:45], v[112:113] op_sel:[1,1,0] op_sel_hi:[1,0,1] neg_lo:[1,0,0]
v_pk_fma_f32 v[214:215], v[28:29], v[46:47], v[144:145] op_sel:[1,1,0] op_sel_hi:[1,0,1] neg_lo:[1,0,0]
v_pk_fma_f32 v[18:19], v[28:29], v[48:49], v[176:177] op_sel:[1,1,0] op_sel_hi:[1,0,1] neg_lo:[1,0,0]
v_pk_fma_f32 v[32:33], v[20:21], v[40:41], v[208:209] op_sel:[0,0,0] op_sel_hi:[0,1,1]
v_pk_fma_f32 v[80:81], v[24:25], v[42:43], v[210:211] op_sel:[0,0,0] op_sel_hi:[0,1,1]
v_pk_fma_f32 v[112:113], v[24:25], v[44:45], v[212:213] op_sel:[0,0,0] op_sel_hi:[0,1,1]
v_pk_fma_f32 v[144:145], v[28:29], v[46:47], v[214:215] op_sel:[0,0,0] op_sel_hi:[0,1,1]
v_pk_fma_f32 v[176:177], v[28:29], v[48:49], v[18:19] op_sel:[0,0,0] op_sel_hi:[0,1,1]
v_pk_fma_f32 v[208:209], v[20:21], v[32:33], v[34:35] op_sel:[1,1,0] op_sel_hi:[1,0,1] neg_lo:[1,0,0]
v_pk_fma_f32 v[210:211], v[24:25], v[80:81], v[82:83] op_sel:[1,1,0] op_sel_hi:[1,0,1] neg_lo:[1,0,0]
v_pk_fma_f32 v[212:213], v[24:25], v[112:113], v[114:115] op_sel:[1,1,0] op_sel_hi:[1,0,1] neg_lo:[1,0,0]
v_pk_fma_f32 v[214:215], v[28:29], v[144:145], v[146:147] op_sel:[1,1,0] op_sel_hi:[1,0,1] neg_lo:[1,0,0]
v_pk_fma_f32 v[18:19], v[28:29], v[176:177], v[178:179] op_sel:[1,1,0] op_sel_hi:[1,0,1] neg_lo:[1,0,0]
v_pk_fma_f32 v[34:35], v[20:21], v[32:33], v[208:209] op_sel:[0,0,0] op_sel_hi:[0,1,1]
v_pk_fma_f32 v[82:83], v[24:25], v[80:81], v[210:211] op_sel:[0,0,0] op_sel_hi:[0,1,1]
v_pk_fma_f32 v[114:115], v[24:25], v[112:113], v[212:213] op_sel:[0,0,0] op_sel_hi:[0,1,1]
v_pk_fma_f32 v[146:147], v[28:29], v[144:145], v[214:215] op_sel:[0,0,0] op_sel_hi:[0,1,1]
v_pk_fma_f32 v[178:179], v[28:29], v[176:177], v[18:19] op_sel:[0,0,0] op_sel_hi:[0,1,1]
v_pk_fma_f32 v[208:209], v[20:21], v[34:35], v[36:37] op_sel:[1,1,0] op_sel_hi:[1,0,1] neg_lo:[1,0,0]
v_pk_fma_f32 v[210:211], v[24:25], v[82:83], v[84:85] op_sel:[1,1,0] op_sel_hi:[1,0,1] neg_lo:[1,0,0]
v_pk_fma_f32 v[212:213], v[24:25], v[114:115], v[116:117] op_sel:[1,1,0] op_sel_hi:[1,0,1] neg_lo:[1,0,0]
v_pk_fma_f32 v[214:215], v[28:29], v[146:147], v[148:149] op_sel:[1,1,0] op_sel_hi:[1,0,1] neg_lo:[1,0,0]
v_pk_fma_f32 v[18:19], v[28:29], v[178:179], v[180:181] op_sel:[1,1,0] op_sel_hi:[1,0,1] neg_lo:[1,0,0]
v_pk_fma_f32 v[36:37], v[20:21], v[34:35], v[208:209] op_sel:[0,0,0] op_sel_hi:[0,1,1]
v_pk_fma_f32 v[84:85], v[24:25], v[82:83], v[210:211] op_sel:[0,0,0] op_sel_hi:[0,1,1]
v_pk_fma_f32 v[116:117], v[24:25], v[114:115], v[212:213] op_sel:[0,0,0] op_sel_hi:[0,1,1]
v_pk_fma_f32 v[148:149], v[28:29], v[146:147], v[214:215] op_sel:[0,0,0] op_sel_hi:[0,1,1]
v_pk_fma_f32 v[180:181], v[28:29], v[178:179], v[18:19] op_sel:[0,0,0] op_sel_hi:[0,1,1]
v_pk_fma_f32 v[208:209], v[20:21], v[36:37], v[38:39] op_sel:[1,1,0] op_sel_hi:[1,0,1] neg_lo:[1,0,0]
v_pk_fma_f32 v[210:211], v[24:25], v[84:85], v[86:87] op_sel:[1,1,0] op_sel_hi:[1,0,1] neg_lo:[1,0,0]
v_pk_fma_f32 v[212:213], v[24:25], v[116:117], v[118:119] op_sel:[1,1,0] op_sel_hi:[1,0,1] neg_lo:[1,0,0]
v_pk_fma_f32 v[214:215], v[28:29], v[148:149], v[150:151] op_sel:[1,1,0] op_sel_hi:[1,0,1] neg_lo:[1,0,0]
v_pk_fma_f32 v[18:19], v[28:29], v[180:181], v[182:183] op_sel:[1,1,0] op_sel_hi:[1,0,1] neg_lo:[1,0,0]
v_pk_fma_f32 v[38:39], v[20:21], v[36:37], v[208:209] op_sel:[0,0,0] op_sel_hi:[0,1,1]
v_pk_fma_f32 v[86:87], v[24:25], v[84:85], v[210:211] op_sel:[0,0,0] op_sel_hi:[0,1,1]
v_pk_fma_f32 v[118:119], v[24:25], v[116:117], v[212:213] op_sel:[0,0,0] op_sel_hi:[0,1,1]
v_pk_fma_f32 v[150:151], v[28:29], v[148:149], v[214:215] op_sel:[0,0,0] op_sel_hi:[0,1,1]
v_pk_fma_f32 v[182:183], v[28:29], v[180:181], v[18:19] op_sel:[0,0,0] op_sel_hi:[0,1,1]
v_cvt_pk_bf16_f32 v32, v32, v34
v_cvt_pk_bf16_f32 v34, -v33, -v35
v_cvt_pk_bf16_f32 v33, v36, v38
v_cvt_pk_bf16_f32 v35, -v37, -v39
ds_write_b128 v2, v[32:35] offset:0
v_cvt_pk_bf16_f32 v80, v80, v82
v_cvt_pk_bf16_f32 v82, -v81, -v83
v_cvt_pk_bf16_f32 v81, v84, v86
v_cvt_pk_bf16_f32 v83, -v85, -v87
ds_write_b128 v2, v[80:83] offset:1024
v_cvt_pk_bf16_f32 v112, v112, v114
v_cvt_pk_bf16_f32 v114, -v113, -v115
v_cvt_pk_bf16_f32 v113, v116, v118
v_cvt_pk_bf16_f32 v115, -v117, -v119
ds_write_b128 v2, v[112:115] offset:2048
v_cvt_pk_bf16_f32 v144, v144, v146
v_cvt_pk_bf16_f32 v146, -v145, -v147
v_cvt_pk_bf16_f32 v145, v148, v150
v_cvt_pk_bf16_f32 v147, -v149, -v151
ds_write_b128 v2, v[144:147] offset:3072
v_cvt_pk_bf16_f32 v176, v176, v178
v_cvt_pk_bf16_f32 v178, -v177, -v179
v_cvt_pk_bf16_f32 v177, v180, v182
v_cvt_pk_bf16_f32 v179, -v181, -v183
ds_write_b128 v2, v[176:179] offset:4096
ds_read_b64_tr_b16 v[32:33], v3 offset:0
ds_read_b64_tr_b16 v[34:35], v10 offset:256
ds_read_b64_tr_b16 v[80:81], v3 offset:1024
ds_read_b64_tr_b16 v[82:83], v10 offset:1280
ds_read_b64_tr_b16 v[112:113], v3 offset:2048
ds_read_b64_tr_b16 v[114:115], v10 offset:2304
ds_read_b64_tr_b16 v[144:145], v3 offset:3072
ds_read_b64_tr_b16 v[146:147], v10 offset:3328
ds_read_b64_tr_b16 v[176:177], v3 offset:4096
ds_read_b64_tr_b16 v[178:179], v10 offset:4352
v_pk_fma_f32 v[208:209], v[20:21], v[38:39], v[56:57] op_sel:[1,1,0] op_sel_hi:[1,0,1] neg_lo:[1,0,0]
v_pk_fma_f32 v[210:211], v[24:25], v[86:87], v[88:89] op_sel:[1,1,0] op_sel_hi:[1,0,1] neg_lo:[1,0,0]
v_pk_fma_f32 v[212:213], v[24:25], v[118:119], v[120:121] op_sel:[1,1,0] op_sel_hi:[1,0,1] neg_lo:[1,0,0]
v_pk_fma_f32 v[214:215], v[28:29], v[150:151], v[152:153] op_sel:[1,1,0] op_sel_hi:[1,0,1] neg_lo:[1,0,0]
s_add_u32 s11, s13, 4096
s_waitcnt lgkmcnt(8)
buffer_store_dwordx4 v[32:35], v1, s[56:59], s11 offen sc0 sc1
v_pk_fma_f32 v[18:19], v[28:29], v[182:183], v[184:185] op_sel:[1,1,0] op_sel_hi:[1,0,1] neg_lo:[1,0,0]
v_pk_fma_f32 v[56:57], v[20:21], v[38:39], v[208:209] op_sel:[0,0,0] op_sel_hi:[0,1,1]
v_pk_fma_f32 v[88:89], v[24:25], v[86:87], v[210:211] op_sel:[0,0,0] op_sel_hi:[0,1,1]
v_pk_fma_f32 v[120:121], v[24:25], v[118:119], v[212:213] op_sel:[0,0,0] op_sel_hi:[0,1,1]
v_pk_fma_f32 v[152:153], v[28:29], v[150:151], v[214:215] op_sel:[0,0,0] op_sel_hi:[0,1,1]
v_pk_fma_f32 v[184:185], v[28:29], v[182:183], v[18:19] op_sel:[0,0,0] op_sel_hi:[0,1,1]
v_pk_fma_f32 v[208:209], v[20:21], v[56:57], v[58:59] op_sel:[1,1,0] op_sel_hi:[1,0,1] neg_lo:[1,0,0]
v_pk_fma_f32 v[210:211], v[24:25], v[88:89], v[90:91] op_sel:[1,1,0] op_sel_hi:[1,0,1] neg_lo:[1,0,0]
v_pk_fma_f32 v[212:213], v[24:25], v[120:121], v[122:123] op_sel:[1,1,0] op_sel_hi:[1,0,1] neg_lo:[1,0,0]
v_pk_fma_f32 v[214:215], v[28:29], v[152:153], v[154:155] op_sel:[1,1,0] op_sel_hi:[1,0,1] neg_lo:[1,0,0]
s_add_u32 s11, s96, 0
s_waitcnt lgkmcnt(6)
buffer_store_dwordx4 v[80:83], v1, s[56:59], s11 offen sc0 sc1
v_pk_fma_f32 v[18:19], v[28:29], v[184:185], v[186:187] op_sel:[1,1,0] op_sel_hi:[1,0,1] neg_lo:[1,0,0]
v_pk_fma_f32 v[58:59], v[20:21], v[56:57], v[208:209] op_sel:[0,0,0] op_sel_hi:[0,1,1]
v_pk_fma_f32 v[90:91], v[24:25], v[88:89], v[210:211] op_sel:[0,0,0] op_sel_hi:[0,1,1]
v_pk_fma_f32 v[122:123], v[24:25], v[120:121], v[212:213] op_sel:[0,0,0] op_sel_hi:[0,1,1]
v_pk_fma_f32 v[154:155], v[28:29], v[152:153], v[214:215] op_sel:[0,0,0] op_sel_hi:[0,1,1]
v_pk_fma_f32 v[186:187], v[28:29], v[184:185], v[18:19] op_sel:[0,0,0] op_sel_hi:[0,1,1]
v_pk_fma_f32 v[208:209], v[20:21], v[58:59], v[60:61] op_sel:[1,1,0] op_sel_hi:[1,0,1] neg_lo:[1,0,0]
v_pk_fma_f32 v[210:211], v[24:25], v[90:91], v[92:93] op_sel:[1,1,0] op_sel_hi:[1,0,1] neg_lo:[1,0,0]
v_pk_fma_f32 v[212:213], v[24:25], v[122:123], v[124:125] op_sel:[1,1,0] op_sel_hi:[1,0,1] neg_lo:[1,0,0]
v_pk_fma_f32 v[214:215], v[28:29], v[154:155], v[156:157] op_sel:[1,1,0] op_sel_hi:[1,0,1] neg_lo:[1,0,0]
s_add_u32 s11, s97, 0
s_waitcnt lgkmcnt(4)
buffer_store_dwordx4 v[112:115], v1, s[56:59], s11 offen sc0 sc1
v_pk_fma_f32 v[18:19], v[28:29], v[186:187], v[188:189] op_sel:[1,1,0] op_sel_hi:[1,0,1] neg_lo:[1,0,0]
v_pk_fma_f32 v[60:61], v[20:21], v[58:59], v[208:209] op_sel:[0,0,0] op_sel_hi:[0,1,1]
v_pk_fma_f32 v[92:93], v[24:25], v[90:91], v[210:211] op_sel:[0,0,0] op_sel_hi:[0,1,1]
v_pk_fma_f32 v[124:125], v[24:25], v[122:123], v[212:213] op_sel:[0,0,0] op_sel_hi:[0,1,1]
v_pk_fma_f32 v[156:157], v[28:29], v[154:155], v[214:215] op_sel:[0,0,0] op_sel_hi:[0,1,1]
v_pk_fma_f32 v[188:189], v[28:29], v[186:187], v[18:19] op_sel:[0,0,0] op_sel_hi:[0,1,1]
v_pk_fma_f32 v[208:209], v[20:21], v[60:61], v[62:63] op_sel:[1,1,0] op_sel_hi:[1,0,1] neg_lo:[1,0,0]
v_pk_fma_f32 v[210:211], v[24:25], v[92:93], v[94:95] op_sel:[1,1,0] op_sel_hi:[1,0,1] neg_lo:[1,0,0]
v_pk_fma_f32 v[212:213], v[24:25], v[124:125], v[126:127] op_sel:[1,1,0] op_sel_hi:[1,0,1] neg_lo:[1,0,0]
v_pk_fma_f32 v[214:215], v[28:29], v[156:157], v[158:159] op_sel:[1,1,0] op_sel_hi:[1,0,1] neg_lo:[1,0,0]
s_add_u32 s11, s96, 1024
s_waitcnt lgkmcnt(2)
buffer_store_dwordx4 v[144:147], v1, s[56:59], s11 offen sc0 sc1
v_pk_fma_f32 v[18:19], v[28:29], v[188:189], v[190:191] op_sel:[1,1,0] op_sel_hi:[1,0,1] neg_lo:[1,0,0]
v_pk_fma_f32 v[62:63], v[20:21], v[60:61], v[208:209] op_sel:[0,0,0] op_sel_hi:[0,1,1]
v_pk_fma_f32 v[94:95], v[24:25], v[92:93], v[210:211] op_sel:[0,0,0] op_sel_hi:[0,1,1]
v_pk_fma_f32 v[126:127], v[24:25], v[124:125], v[212:213] op_sel:[0,0,0] op_sel_hi:[0,1,1]
v_pk_fma_f32 v[158:159], v[28:29], v[156:157], v[214:215] op_sel:[0,0,0] op_sel_hi:[0,1,1]
v_pk_fma_f32 v[190:191], v[28:29], v[188:189], v[18:19] op_sel:[0,0,0] op_sel_hi:[0,1,1]
v_cvt_pk_bf16_f32 v56, v56, v58
v_cvt_pk_bf16_f32 v58, -v57, -v59
v_cvt_pk_bf16_f32 v57, v60, v62
v_cvt_pk_bf16_f32 v59, -v61, -v63
s_add_u32 s11, s97, 1024
s_waitcnt lgkmcnt(0)
buffer_store_dwordx4 v[176:179], v1, s[56:59], s11 offen sc0 sc1
ds_write_b128 v2, v[56:59] offset:0
v_cvt_pk_bf16_f32 v88, v88, v90
v_cvt_pk_bf16_f32 v90, -v89, -v91
v_cvt_pk_bf16_f32 v89, v92, v94
v_cvt_pk_bf16_f32 v91, -v93, -v95
ds_write_b128 v2, v[88:91] offset:1024
v_cvt_pk_bf16_f32 v120, v120, v122
v_cvt_pk_bf16_f32 v122, -v121, -v123
v_cvt_pk_bf16_f32 v121, v124, v126
v_cvt_pk_bf16_f32 v123, -v125, -v127
ds_write_b128 v2, v[120:123] offset:2048
v_cvt_pk_bf16_f32 v152, v152, v154
v_cvt_pk_bf16_f32 v154, -v153, -v155
v_cvt_pk_bf16_f32 v153, v156, v158
v_cvt_pk_bf16_f32 v155, -v157, -v159
ds_write_b128 v2, v[152:155] offset:3072
v_cvt_pk_bf16_f32 v184, v184, v186
v_cvt_pk_bf16_f32 v186, -v185, -v187
v_cvt_pk_bf16_f32 v185, v188, v190
v_cvt_pk_bf16_f32 v187, -v189, -v191
ds_write_b128 v2, v[184:187] offset:4096
ds_read_b64_tr_b16 v[56:57], v3 offset:0
ds_read_b64_tr_b16 v[58:59], v10 offset:256
ds_read_b64_tr_b16 v[88:89], v3 offset:1024
ds_read_b64_tr_b16 v[90:91], v10 offset:1280
ds_read_b64_tr_b16 v[120:121], v3 offset:2048
ds_read_b64_tr_b16 v[122:123], v10 offset:2304
ds_read_b64_tr_b16 v[152:153], v3 offset:3072
ds_read_b64_tr_b16 v[154:155], v10 offset:3328
ds_read_b64_tr_b16 v[184:185], v3 offset:4096
ds_read_b64_tr_b16 v[186:187], v10 offset:4352
v_pk_fma_f32 v[208:209], v[20:21], v[62:63], v[64:65] op_sel:[1,1,0] op_sel_hi:[1,0,1] neg_lo:[1,0,0]
v_pk_fma_f32 v[210:211], v[24:25], v[94:95], v[96:97] op_sel:[1,1,0] op_sel_hi:[1,0,1] neg_lo:[1,0,0]
v_pk_fma_f32 v[212:213], v[24:25], v[126:127], v[128:129] op_sel:[1,1,0] op_sel_hi:[1,0,1] neg_lo:[1,0,0]
v_pk_fma_f32 v[214:215], v[28:29], v[158:159], v[160:161] op_sel:[1,1,0] op_sel_hi:[1,0,1] neg_lo:[1,0,0]
s_add_u32 s11, s13, 184320
s_waitcnt lgkmcnt(8)
buffer_store_dwordx4 v[56:59], v1, s[56:59], s11 offen sc0 sc1
v_pk_fma_f32 v[18:19], v[28:29], v[190:191], v[192:193] op_sel:[1,1,0] op_sel_hi:[1,0,1] neg_lo:[1,0,0]
v_pk_fma_f32 v[64:65], v[20:21], v[62:63], v[208:209] op_sel:[0,0,0] op_sel_hi:[0,1,1]
v_pk_fma_f32 v[96:97], v[24:25], v[94:95], v[210:211] op_sel:[0,0,0] op_sel_hi:[0,1,1]
v_pk_fma_f32 v[128:129], v[24:25], v[126:127], v[212:213] op_sel:[0,0,0] op_sel_hi:[0,1,1]
v_pk_fma_f32 v[160:161], v[28:29], v[158:159], v[214:215] op_sel:[0,0,0] op_sel_hi:[0,1,1]
v_pk_fma_f32 v[192:193], v[28:29], v[190:191], v[18:19] op_sel:[0,0,0] op_sel_hi:[0,1,1]
v_pk_fma_f32 v[208:209], v[20:21], v[64:65], v[66:67] op_sel:[1,1,0] op_sel_hi:[1,0,1] neg_lo:[1,0,0]
v_pk_fma_f32 v[210:211], v[24:25], v[96:97], v[98:99] op_sel:[1,1,0] op_sel_hi:[1,0,1] neg_lo:[1,0,0]
v_pk_fma_f32 v[212:213], v[24:25], v[128:129], v[130:131] op_sel:[1,1,0] op_sel_hi:[1,0,1] neg_lo:[1,0,0]
v_pk_fma_f32 v[214:215], v[28:29], v[160:161], v[162:163] op_sel:[1,1,0] op_sel_hi:[1,0,1] neg_lo:[1,0,0]
s_add_u32 s11, s96, 180224
s_waitcnt lgkmcnt(6)
buffer_store_dwordx4 v[88:91], v1, s[56:59], s11 offen sc0 sc1
v_pk_fma_f32 v[18:19], v[28:29], v[192:193], v[194:195] op_sel:[1,1,0] op_sel_hi:[1,0,1] neg_lo:[1,0,0]
v_pk_fma_f32 v[66:67], v[20:21], v[64:65], v[208:209] op_sel:[0,0,0] op_sel_hi:[0,1,1]
v_pk_fma_f32 v[98:99], v[24:25], v[96:97], v[210:211] op_sel:[0,0,0] op_sel_hi:[0,1,1]
v_pk_fma_f32 v[130:131], v[24:25], v[128:129], v[212:213] op_sel:[0,0,0] op_sel_hi:[0,1,1]
v_pk_fma_f32 v[162:163], v[28:29], v[160:161], v[214:215] op_sel:[0,0,0] op_sel_hi:[0,1,1]
v_pk_fma_f32 v[194:195], v[28:29], v[192:193], v[18:19] op_sel:[0,0,0] op_sel_hi:[0,1,1]
v_pk_fma_f32 v[208:209], v[20:21], v[66:67], v[68:69] op_sel:[1,1,0] op_sel_hi:[1,0,1] neg_lo:[1,0,0]
v_pk_fma_f32 v[210:211], v[24:25], v[98:99], v[100:101] op_sel:[1,1,0] op_sel_hi:[1,0,1] neg_lo:[1,0,0]
v_pk_fma_f32 v[212:213], v[24:25], v[130:131], v[132:133] op_sel:[1,1,0] op_sel_hi:[1,0,1] neg_lo:[1,0,0]
v_pk_fma_f32 v[214:215], v[28:29], v[162:163], v[164:165] op_sel:[1,1,0] op_sel_hi:[1,0,1] neg_lo:[1,0,0]
s_add_u32 s11, s97, 180224
s_waitcnt lgkmcnt(4)
buffer_store_dwordx4 v[120:123], v1, s[56:59], s11 offen sc0 sc1
v_pk_fma_f32 v[18:19], v[28:29], v[194:195], v[196:197] op_sel:[1,1,0] op_sel_hi:[1,0,1] neg_lo:[1,0,0]
v_pk_fma_f32 v[68:69], v[20:21], v[66:67], v[208:209] op_sel:[0,0,0] op_sel_hi:[0,1,1]
v_pk_fma_f32 v[100:101], v[24:25], v[98:99], v[210:211] op_sel:[0,0,0] op_sel_hi:[0,1,1]
v_pk_fma_f32 v[132:133], v[24:25], v[130:131], v[212:213] op_sel:[0,0,0] op_sel_hi:[0,1,1]
v_pk_fma_f32 v[164:165], v[28:29], v[162:163], v[214:215] op_sel:[0,0,0] op_sel_hi:[0,1,1]
v_pk_fma_f32 v[196:197], v[28:29], v[194:195], v[18:19] op_sel:[0,0,0] op_sel_hi:[0,1,1]
v_pk_fma_f32 v[208:209], v[20:21], v[68:69], v[70:71] op_sel:[1,1,0] op_sel_hi:[1,0,1] neg_lo:[1,0,0]
v_pk_fma_f32 v[210:211], v[24:25], v[100:101], v[102:103] op_sel:[1,1,0] op_sel_hi:[1,0,1] neg_lo:[1,0,0]
v_pk_fma_f32 v[212:213], v[24:25], v[132:133], v[134:135] op_sel:[1,1,0] op_sel_hi:[1,0,1] neg_lo:[1,0,0]
v_pk_fma_f32 v[214:215], v[28:29], v[164:165], v[166:167] op_sel:[1,1,0] op_sel_hi:[1,0,1] neg_lo:[1,0,0]
s_add_u32 s11, s96, 181248
s_waitcnt lgkmcnt(2)
buffer_store_dwordx4 v[152:155], v1, s[56:59], s11 offen sc0 sc1
v_pk_fma_f32 v[18:19], v[28:29], v[196:197], v[198:199] op_sel:[1,1,0] op_sel_hi:[1,0,1] neg_lo:[1,0,0]
v_pk_fma_f32 v[70:71], v[20:21], v[68:69], v[208:209] op_sel:[0,0,0] op_sel_hi:[0,1,1]
v_pk_fma_f32 v[102:103], v[24:25], v[100:101], v[210:211] op_sel:[0,0,0] op_sel_hi:[0,1,1]
v_pk_fma_f32 v[134:135], v[24:25], v[132:133], v[212:213] op_sel:[0,0,0] op_sel_hi:[0,1,1]
v_pk_fma_f32 v[166:167], v[28:29], v[164:165], v[214:215] op_sel:[0,0,0] op_sel_hi:[0,1,1]
v_pk_fma_f32 v[198:199], v[28:29], v[196:197], v[18:19] op_sel:[0,0,0] op_sel_hi:[0,1,1]
v_cvt_pk_bf16_f32 v64, v64, v66
v_cvt_pk_bf16_f32 v66, -v65, -v67
v_cvt_pk_bf16_f32 v65, v68, v70
v_cvt_pk_bf16_f32 v67, -v69, -v71
s_add_u32 s11, s97, 181248
s_waitcnt lgkmcnt(0)
buffer_store_dwordx4 v[184:187], v1, s[56:59], s11 offen sc0 sc1
ds_write_b128 v2, v[64:67] offset:0
v_cvt_pk_bf16_f32 v96, v96, v98
v_cvt_pk_bf16_f32 v98, -v97, -v99
v_cvt_pk_bf16_f32 v97, v100, v102
v_cvt_pk_bf16_f32 v99, -v101, -v103
ds_write_b128 v2, v[96:99] offset:1024
v_cvt_pk_bf16_f32 v128, v128, v130
v_cvt_pk_bf16_f32 v130, -v129, -v131
v_cvt_pk_bf16_f32 v129, v132, v134
v_cvt_pk_bf16_f32 v131, -v133, -v135
ds_write_b128 v2, v[128:131] offset:2048
v_cvt_pk_bf16_f32 v160, v160, v162
v_cvt_pk_bf16_f32 v162, -v161, -v163
v_cvt_pk_bf16_f32 v161, v164, v166
v_cvt_pk_bf16_f32 v163, -v165, -v167
ds_write_b128 v2, v[160:163] offset:3072
v_cvt_pk_bf16_f32 v192, v192, v194
v_cvt_pk_bf16_f32 v194, -v193, -v195
v_cvt_pk_bf16_f32 v193, v196, v198
v_cvt_pk_bf16_f32 v195, -v197, -v199
ds_write_b128 v2, v[192:195] offset:4096
ds_read_b64_tr_b16 v[64:65], v3 offset:0
ds_read_b64_tr_b16 v[66:67], v10 offset:256
ds_read_b64_tr_b16 v[96:97], v3 offset:1024
ds_read_b64_tr_b16 v[98:99], v10 offset:1280
ds_read_b64_tr_b16 v[128:129], v3 offset:2048
ds_read_b64_tr_b16 v[130:131], v10 offset:2304
ds_read_b64_tr_b16 v[160:161], v3 offset:3072
ds_read_b64_tr_b16 v[162:163], v10 offset:3328
ds_read_b64_tr_b16 v[192:193], v3 offset:4096
ds_read_b64_tr_b16 v[194:195], v10 offset:4352
buffer_load_dwordx2 v[236:237], v54, s[64:67], s84 offen sc0 sc1
v_pk_fma_f32 v[208:209], v[20:21], v[70:71], v[72:73] op_sel:[1,1,0] op_sel_hi:[1,0,1] neg_lo:[1,0,0]
v_pk_fma_f32 v[210:211], v[24:25], v[102:103], v[104:105] op_sel:[1,1,0] op_sel_hi:[1,0,1] neg_lo:[1,0,0]
v_pk_fma_f32 v[212:213], v[24:25], v[134:135], v[136:137] op_sel:[1,1,0] op_sel_hi:[1,0,1] neg_lo:[1,0,0]
v_pk_fma_f32 v[214:215], v[28:29], v[166:167], v[168:169] op_sel:[1,1,0] op_sel_hi:[1,0,1] neg_lo:[1,0,0]
s_add_u32 s11, s13, 364544
s_waitcnt lgkmcnt(8)
buffer_store_dwordx4 v[64:67], v1, s[56:59], s11 offen sc0 sc1
v_pk_fma_f32 v[18:19], v[28:29], v[198:199], v[200:201] op_sel:[1,1,0] op_sel_hi:[1,0,1] neg_lo:[1,0,0]
v_pk_fma_f32 v[72:73], v[20:21], v[70:71], v[208:209] op_sel:[0,0,0] op_sel_hi:[0,1,1]
v_pk_fma_f32 v[104:105], v[24:25], v[102:103], v[210:211] op_sel:[0,0,0] op_sel_hi:[0,1,1]
v_pk_fma_f32 v[136:137], v[24:25], v[134:135], v[212:213] op_sel:[0,0,0] op_sel_hi:[0,1,1]
v_pk_fma_f32 v[168:169], v[28:29], v[166:167], v[214:215] op_sel:[0,0,0] op_sel_hi:[0,1,1]
v_pk_fma_f32 v[200:201], v[28:29], v[198:199], v[18:19] op_sel:[0,0,0] op_sel_hi:[0,1,1]
v_pk_fma_f32 v[208:209], v[20:21], v[72:73], v[74:75] op_sel:[1,1,0] op_sel_hi:[1,0,1] neg_lo:[1,0,0]
v_pk_fma_f32 v[210:211], v[24:25], v[104:105], v[106:107] op_sel:[1,1,0] op_sel_hi:[1,0,1] neg_lo:[1,0,0]
v_pk_fma_f32 v[212:213], v[24:25], v[136:137], v[138:139] op_sel:[1,1,0] op_sel_hi:[1,0,1] neg_lo:[1,0,0]
v_pk_fma_f32 v[214:215], v[28:29], v[168:169], v[170:171] op_sel:[1,1,0] op_sel_hi:[1,0,1] neg_lo:[1,0,0]
s_add_u32 s11, s96, 360448
s_waitcnt lgkmcnt(6)
buffer_store_dwordx4 v[96:99], v1, s[56:59], s11 offen sc0 sc1
v_pk_fma_f32 v[18:19], v[28:29], v[200:201], v[202:203] op_sel:[1,1,0] op_sel_hi:[1,0,1] neg_lo:[1,0,0]
v_pk_fma_f32 v[74:75], v[20:21], v[72:73], v[208:209] op_sel:[0,0,0] op_sel_hi:[0,1,1]
v_pk_fma_f32 v[106:107], v[24:25], v[104:105], v[210:211] op_sel:[0,0,0] op_sel_hi:[0,1,1]
v_pk_fma_f32 v[138:139], v[24:25], v[136:137], v[212:213] op_sel:[0,0,0] op_sel_hi:[0,1,1]
v_pk_fma_f32 v[170:171], v[28:29], v[168:169], v[214:215] op_sel:[0,0,0] op_sel_hi:[0,1,1]
v_pk_fma_f32 v[202:203], v[28:29], v[200:201], v[18:19] op_sel:[0,0,0] op_sel_hi:[0,1,1]
v_pk_fma_f32 v[208:209], v[20:21], v[74:75], v[76:77] op_sel:[1,1,0] op_sel_hi:[1,0,1] neg_lo:[1,0,0]
v_pk_fma_f32 v[210:211], v[24:25], v[106:107], v[108:109] op_sel:[1,1,0] op_sel_hi:[1,0,1] neg_lo:[1,0,0]
v_pk_fma_f32 v[212:213], v[24:25], v[138:139], v[140:141] op_sel:[1,1,0] op_sel_hi:[1,0,1] neg_lo:[1,0,0]
v_pk_fma_f32 v[214:215], v[28:29], v[170:171], v[172:173] op_sel:[1,1,0] op_sel_hi:[1,0,1] neg_lo:[1,0,0]
s_add_u32 s11, s97, 360448
s_waitcnt lgkmcnt(4)
buffer_store_dwordx4 v[128:131], v1, s[56:59], s11 offen sc0 sc1
v_pk_fma_f32 v[18:19], v[28:29], v[202:203], v[204:205] op_sel:[1,1,0] op_sel_hi:[1,0,1] neg_lo:[1,0,0]
v_pk_fma_f32 v[76:77], v[20:21], v[74:75], v[208:209] op_sel:[0,0,0] op_sel_hi:[0,1,1]
v_pk_fma_f32 v[108:109], v[24:25], v[106:107], v[210:211] op_sel:[0,0,0] op_sel_hi:[0,1,1]
v_pk_fma_f32 v[140:141], v[24:25], v[138:139], v[212:213] op_sel:[0,0,0] op_sel_hi:[0,1,1]
v_pk_fma_f32 v[172:173], v[28:29], v[170:171], v[214:215] op_sel:[0,0,0] op_sel_hi:[0,1,1]
v_pk_fma_f32 v[204:205], v[28:29], v[202:203], v[18:19] op_sel:[0,0,0] op_sel_hi:[0,1,1]
v_pk_fma_f32 v[208:209], v[20:21], v[76:77], v[78:79] op_sel:[1,1,0] op_sel_hi:[1,0,1] neg_lo:[1,0,0]
v_pk_fma_f32 v[210:211], v[24:25], v[108:109], v[110:111] op_sel:[1,1,0] op_sel_hi:[1,0,1] neg_lo:[1,0,0]
v_pk_fma_f32 v[212:213], v[24:25], v[140:141], v[142:143] op_sel:[1,1,0] op_sel_hi:[1,0,1] neg_lo:[1,0,0]
v_pk_fma_f32 v[214:215], v[28:29], v[172:173], v[174:175] op_sel:[1,1,0] op_sel_hi:[1,0,1] neg_lo:[1,0,0]
s_add_u32 s11, s96, 361472
s_waitcnt lgkmcnt(2)
buffer_store_dwordx4 v[160:163], v1, s[56:59], s11 offen sc0 sc1
v_pk_fma_f32 v[18:19], v[28:29], v[204:205], v[206:207] op_sel:[1,1,0] op_sel_hi:[1,0,1] neg_lo:[1,0,0]
v_pk_fma_f32 v[78:79], v[20:21], v[76:77], v[208:209] op_sel:[0,0,0] op_sel_hi:[0,1,1]
v_pk_fma_f32 v[110:111], v[24:25], v[108:109], v[210:211] op_sel:[0,0,0] op_sel_hi:[0,1,1]
v_pk_fma_f32 v[142:143], v[24:25], v[140:141], v[212:213] op_sel:[0,0,0] op_sel_hi:[0,1,1]
v_pk_fma_f32 v[174:175], v[28:29], v[172:173], v[214:215] op_sel:[0,0,0] op_sel_hi:[0,1,1]
v_pk_fma_f32 v[206:207], v[28:29], v[204:205], v[18:19] op_sel:[0,0,0] op_sel_hi:[0,1,1]
v_cvt_pk_bf16_f32 v72, v72, v74
v_cvt_pk_bf16_f32 v74, -v73, -v75
v_cvt_pk_bf16_f32 v73, v76, v78
v_cvt_pk_bf16_f32 v75, -v77, -v79
s_add_u32 s11, s97, 361472
s_waitcnt lgkmcnt(0)
buffer_store_dwordx4 v[192:195], v1, s[56:59], s11 offen sc0 sc1
ds_write_b128 v2, v[72:75] offset:0
v_cvt_pk_bf16_f32 v104, v104, v106
v_cvt_pk_bf16_f32 v106, -v105, -v107
v_cvt_pk_bf16_f32 v105, v108, v110
v_cvt_pk_bf16_f32 v107, -v109, -v111
ds_write_b128 v2, v[104:107] offset:1024
v_cvt_pk_bf16_f32 v136, v136, v138
v_cvt_pk_bf16_f32 v138, -v137, -v139
v_cvt_pk_bf16_f32 v137, v140, v142
v_cvt_pk_bf16_f32 v139, -v141, -v143
ds_write_b128 v2, v[136:139] offset:2048
v_cvt_pk_bf16_f32 v168, v168, v170
v_cvt_pk_bf16_f32 v170, -v169, -v171
v_cvt_pk_bf16_f32 v169, v172, v174
v_cvt_pk_bf16_f32 v171, -v173, -v175
ds_write_b128 v2, v[168:171] offset:3072
v_cvt_pk_bf16_f32 v200, v200, v202
v_cvt_pk_bf16_f32 v202, -v201, -v203
v_cvt_pk_bf16_f32 v201, v204, v206
v_cvt_pk_bf16_f32 v203, -v205, -v207
ds_write_b128 v2, v[200:203] offset:4096
ds_read_b64_tr_b16 v[72:73], v3 offset:0
ds_read_b64_tr_b16 v[74:75], v10 offset:256
ds_read_b64_tr_b16 v[104:105], v3 offset:1024
ds_read_b64_tr_b16 v[106:107], v10 offset:1280
ds_read_b64_tr_b16 v[136:137], v3 offset:2048
ds_read_b64_tr_b16 v[138:139], v10 offset:2304
ds_read_b64_tr_b16 v[168:169], v3 offset:3072
ds_read_b64_tr_b16 v[170:171], v10 offset:3328
ds_read_b64_tr_b16 v[200:201], v3 offset:4096
ds_read_b64_tr_b16 v[202:203], v10 offset:4352
s_mov_b32 s10, 0x40000
s_waitcnt vmcnt(5)
L1B_gc_c:
    v_cmp_eq_u32 vcc, s98, v236
    s_mov_b64 s[92:93], vcc
    v_cmp_eq_u32 vcc, s98, v237
    s_and_b64 s[92:93], s[92:93], vcc
    s_or_b64 s[92:93], s[92:93], s[88:89]
    s_cmp_eq_u64 s[92:93], -1
    s_cbranch_scc1 L1B_gc_ok
    buffer_load_dwordx2 v[236:237], v54, s[64:67], s84 offen sc0 sc1
    s_waitcnt vmcnt(0)
    s_sub_u32 s10, s10, 1
    s_cbranch_scc0 L1B_gc_c
L1B_gc_ok:
buffer_load_dwordx4 a[0:3], v1, s[60:63], s78 offen offset:0 sc1
buffer_load_dwordx4 a[4:7], v1, s[60:63], s79 offen offset:0 sc1
buffer_load_dwordx4 a[8:11], v1, s[60:63], s78 offen offset:1024 sc1
buffer_load_dwordx4 a[12:15], v1, s[60:63], s79 offen offset:1024 sc1
buffer_load_dwordx4 a[16:19], v1, s[60:63], s78 offen offset:2048 sc1
buffer_load_dwordx4 a[20:23], v1, s[60:63], s79 offen offset:2048 sc1
buffer_load_dwordx4 a[24:27], v1, s[60:63], s78 offen offset:3072 sc1
buffer_load_dwordx4 a[28:31], v1, s[60:63], s79 offen offset:3072 sc1
s_add_u32 s78, s78, 4096
s_add_u32 s79, s79, 4096
s_add_u32 s11, s13, 544768
s_waitcnt lgkmcnt(8)
buffer_store_dwordx4 v[72:75], v1, s[56:59], s11 offen sc0 sc1
s_add_u32 s11, s96, 540672
s_waitcnt lgkmcnt(6)
buffer_store_dwordx4 v[104:107], v1, s[56:59], s11 offen sc0 sc1
s_add_u32 s11, s97, 540672
s_waitcnt lgkmcnt(4)
buffer_store_dwordx4 v[136:139], v1, s[56:59], s11 offen sc0 sc1
s_add_u32 s11, s96, 541696
s_waitcnt lgkmcnt(2)
buffer_store_dwordx4 v[168:171], v1, s[56:59], s11 offen sc0 sc1
s_add_u32 s11, s97, 541696
s_waitcnt lgkmcnt(0)
buffer_store_dwordx4 v[200:203], v1, s[56:59], s11 offen sc0 sc1
s_branch L2_start
L2_start:
ds_read_b64_tr_b16 a[64:65], v244 offset:0
ds_read_b64_tr_b16 a[66:67], v244 offset:2048
ds_read_b64_tr_b16 a[68:69], v245 offset:0
ds_read_b64_tr_b16 a[70:71], v245 offset:2048
ds_read_b64_tr_b16 a[72:73], v246 offset:0
ds_read_b64_tr_b16 a[74:75], v246 offset:2048
ds_read_b64_tr_b16 a[76:77], v247 offset:0
ds_read_b64_tr_b16 a[78:79], v247 offset:2048
ds_read_b64_tr_b16 a[80:81], v244 offset:16384
ds_read_b64_tr_b16 a[82:83], v244 offset:18432
ds_read_b64_tr_b16 a[84:85], v245 offset:16384
ds_read_b64_tr_b16 a[86:87], v245 offset:18432
ds_read_b64_tr_b16 a[88:89], v246 offset:16384
ds_read_b64_tr_b16 a[90:91], v246 offset:18432
    s_lshl_b32 s11, s80, 7
    s_lshl_b32 s12, s7, 6
    s_add_u32 s11, s11, s12
    s_lshl_b32 s12, s8, 3
    s_add_u32 s96, s11, s12
    s_lshl_b32 s97, s81, 1
    s_add_u32 s97, s97, s15
    s_lshl_b32 s97, s97, 6
    s_mul_i32 s94, s15, 24576
    s_sub_u32 s94, 57344, s94
    s_add_u32 s95, s84, 4096
    v_bfe_u32 v24, v1, 4, 4
    v_lshrrev_b32 v23, 2, v24
    v_lshlrev_b32 v23, 4, v23
    v_and_b32 v22, 3, v24
    v_add_u32 v22, v22, v23
    v_lshlrev_b32 v243, 3, v22
    s_lshl_b32 s82, s96, 3
    v_lshrrev_b32 v22, 7, v1
    v_lshrrev_b32 v23, 2, v22
    v_lshlrev_b32 v23, 4, v23
    v_and_b32 v22, 3, v22
    v_add_u32 v22, v22, v23
    v_and_b32 v23, 0x7ff, v242
    v_lshl_add_u32 v18, v22, 11, v23
    v_xor_b32 v19, 64, v18
    v_lshlrev_b32 v20, 1, v24
    v_mov_b32 v21, 0
    s_lshl_b32 s12, s97, 1
    s_lshl_b32 s11, s96, 11
    s_add_u32 s11, s11, s12
    s_add_u32 s56, s16, s11
    s_addc_u32 s57, s17, 0
    s_mov_b32 s58, 131072
    s_lshl_b32 s13, s3, 13
    s_add_u32 s13, s13, 98304
s_add_u32 m0, s13, 0
s_mov_b32 s11, 0
buffer_load_dwordx4 v18, s[56:59], s11 offen lds
s_add_u32 m0, s13, 1024
s_mov_b32 s11, 65536
buffer_load_dwordx4 v19, s[56:59], s11 offen lds
s_add_u32 m0, s13, 2048
s_mov_b32 s11, 8192
buffer_load_dwordx4 v18, s[56:59], s11 offen lds
s_add_u32 m0, s13, 3072
s_mov_b32 s11, 73728
buffer_load_dwordx4 v19, s[56:59], s11 offen lds
s_add_u32 s56, s32, s12
s_addc_u32 s57, s33, 0
s_mov_b32 s58, 128
buffer_load_ushort v36, v20, s[56:59], 0 offen offset:0
buffer_load_ushort v37, v20, s[56:59], 0 offen offset:32
buffer_load_ushort v38, v20, s[56:59], 0 offen offset:64
buffer_load_ushort v39, v20, s[56:59], 0 offen offset:96
buffer_load_dwordx2 v[48:49], v243, s[64:67], s82 offen offset:0 sc0 sc1
buffer_load_dwordx2 v[50:51], v243, s[64:67], s82 offen offset:32 sc0 sc1
    s_add_u32 s56, s48, 23396352
    s_addc_u32 s57, s49, 0
    s_mov_b32 s58, 65536
    s_xor_b32 s86, s83, 4
    s_lshl_b32 s86, s86, 6
    v_lshrrev_b32 v23, 8, v1
    v_lshrrev_b32 v28, 1, v24
    v_xor_b32 v28, v28, v23
    v_lshlrev_b32 v28, 4, v28
    v_lshl_add_u32 v28, v24, 7, v28
    v_add_u32 v28, s13, v28
    v_xor_b32 v29, 64, v28
ds_read_b64_tr_b16 a[92:93], v247 offset:16384
s_waitcnt vmcnt(20) lgkmcnt(11)
v_mfma_f32_16x16x32_bf16 v[56:59], a[64:67], a[0:3], 0
buffer_load_dwordx4 a[32:35], v1, s[60:63], s78 offen offset:0 sc1
v_mfma_f32_16x16x32_bf16 v[60:63], a[64:67], a[4:7], 0
ds_read_b64_tr_b16 a[94:95], v247 offset:18432
ds_read_b64_tr_b16 a[96:97], v244 offset:4096
v_mfma_f32_16x16x32_bf16 v[68:71], a[68:71], a[4:7], 0
buffer_load_dwordx4 a[36:39], v1, s[60:63], s79 offen offset:0 sc1
v_mfma_f32_16x16x32_bf16 v[64:67], a[68:71], a[0:3], 0
ds_read_b64_tr_b16 a[98:99], v244 offset:6144
s_waitcnt lgkmcnt(10)
v_mfma_f32_16x16x32_bf16 v[72:75], a[72:75], a[0:3], 0
buffer_load_dwordx4 a[40:43], v1, s[60:63], s78 offen offset:1024 sc1
v_mfma_f32_16x16x32_bf16 v[76:79], a[72:75], a[4:7], 0
ds_read_b64_tr_b16 a[100:101], v245 offset:4096
ds_read_b64_tr_b16 a[102:103], v245 offset:6144
v_mfma_f32_16x16x32_bf16 v[84:87], a[76:79], a[4:7], 0
ds_read_b64_tr_b16 a[104:105], v246 offset:4096
ds_read_b64_tr_b16 a[106:107], v246 offset:6144
v_mfma_f32_16x16x32_bf16 v[80:83], a[76:79], a[0:3], 0
ds_read_b64_tr_b16 a[108:109], v247 offset:4096
s_waitcnt lgkmcnt(11)
v_mfma_f32_16x16x32_bf16 v[88:91], a[80:83], a[0:3], 0
buffer_load_dwordx4 a[44:47], v1, s[60:63], s79 offen offset:1024 sc1
v_mfma_f32_16x16x32_bf16 v[92:95], a[80:83], a[4:7], 0
ds_read_b64_tr_b16 a[110:111], v247 offset:6144
ds_read_b64_tr_b16 a[112:113], v244 offset:20480
v_mfma_f32_16x16x32_bf16 v[100:103], a[84:87], a[4:7], 0
buffer_load_dwordx4 a[48:51], v1, s[60:63], s78 offen offset:2048 sc1
v_mfma_f32_16x16x32_bf16 v[96:99], a[84:87], a[0:3], 0
ds_read_b64_tr_b16 a[114:115], v244 offset:22528
s_waitcnt lgkmcnt(10)
v_mfma_f32_16x16x32_bf16 v[104:107], a[88:91], a[0:3], 0
buffer_load_dwordx4 a[52:55], v1, s[60:63], s79 offen offset:2048 sc1
v_mfma_f32_16x16x32_bf16 v[108:111], a[88:91], a[4:7], 0
ds_read_b64_tr_b16 a[116:117], v245 offset:20480
ds_read_b64_tr_b16 a[118:119], v245 offset:22528
v_mfma_f32_16x16x32_bf16 v[116:119], a[92:95], a[4:7], 0
ds_read_b64_tr_b16 a[120:121], v246 offset:20480
ds_read_b64_tr_b16 a[122:123], v246 offset:22528
v_mfma_f32_16x16x32_bf16 v[112:115], a[92:95], a[0:3], 0
ds_read_b64_tr_b16 a[124:125], v247 offset:20480
s_waitcnt vmcnt(24) lgkmcnt(11)
v_mfma_f32_16x16x32_bf16 v[56:59], a[96:99], a[8:11], v[56:59]
buffer_load_dwordx4 a[56:59], v1, s[60:63], s78 offen offset:3072 sc1
v_mfma_f32_16x16x32_bf16 v[60:63], a[96:99], a[12:15], v[60:63]
ds_read_b64_tr_b16 a[126:127], v247 offset:22528
ds_read_b64_tr_b16 a[64:65], v244 offset:8192
v_mfma_f32_16x16x32_bf16 v[68:71], a[100:103], a[12:15], v[68:71]
ds_read_b64_tr_b16 a[66:67], v244 offset:10240
v_mfma_f32_16x16x32_bf16 v[64:67], a[100:103], a[8:11], v[64:67]
ds_read_b64_tr_b16 a[68:69], v245 offset:8192
s_waitcnt lgkmcnt(11)
v_mfma_f32_16x16x32_bf16 v[72:75], a[104:107], a[8:11], v[72:75]
buffer_load_dwordx4 a[60:63], v1, s[60:63], s79 offen offset:3072 sc1
v_mfma_f32_16x16x32_bf16 v[76:79], a[104:107], a[12:15], v[76:79]
ds_read_b64_tr_b16 a[70:71], v245 offset:10240
ds_read_b64_tr_b16 a[72:73], v246 offset:8192
v_mfma_f32_16x16x32_bf16 v[84:87], a[108:111], a[12:15], v[84:87]
ds_read_b64_tr_b16 a[74:75], v246 offset:10240
s_add_u32 s78, s78, 4096
v_mfma_f32_16x16x32_bf16 v[80:83], a[108:111], a[8:11], v[80:83]
s_add_u32 s79, s79, 4096
s_waitcnt lgkmcnt(10)
v_mfma_f32_16x16x32_bf16 v[88:91], a[112:115], a[8:11], v[88:91]
buffer_load_dwordx4 a[0:3], v1, s[60:63], s78 offen offset:0 sc1
v_mfma_f32_16x16x32_bf16 v[92:95], a[112:115], a[12:15], v[92:95]
ds_read_b64_tr_b16 a[76:77], v247 offset:8192
ds_read_b64_tr_b16 a[78:79], v247 offset:10240
v_mfma_f32_16x16x32_bf16 v[100:103], a[116:119], a[12:15], v[100:103]
ds_read_b64_tr_b16 a[80:81], v244 offset:24576
ds_read_b64_tr_b16 a[82:83], v244 offset:26624
v_mfma_f32_16x16x32_bf16 v[96:99], a[116:119], a[8:11], v[96:99]
ds_read_b64_tr_b16 a[84:85], v245 offset:24576
s_waitcnt lgkmcnt(11)
v_mfma_f32_16x16x32_bf16 v[104:107], a[120:123], a[8:11], v[104:107]
buffer_load_dwordx4 a[4:7], v1, s[60:63], s79 offen offset:0 sc1
v_mfma_f32_16x16x32_bf16 v[108:111], a[120:123], a[12:15], v[108:111]
ds_read_b64_tr_b16 a[86:87], v245 offset:26624
ds_read_b64_tr_b16 a[88:89], v246 offset:24576
v_mfma_f32_16x16x32_bf16 v[116:119], a[124:127], a[12:15], v[116:119]
ds_read_b64_tr_b16 a[90:91], v246 offset:26624
v_mfma_f32_16x16x32_bf16 v[112:115], a[124:127], a[8:11], v[112:115]
ds_read_b64_tr_b16 a[92:93], v247 offset:24576
s_waitcnt vmcnt(26) lgkmcnt(11)
v_mfma_f32_16x16x32_bf16 v[56:59], a[64:67], a[16:19], v[56:59]
ds_read_b64_tr_b16 a[94:95], v247 offset:26624
v_mfma_f32_16x16x32_bf16 v[60:63], a[64:67], a[20:23], v[60:63]
ds_read_b64_tr_b16 a[96:97], v244 offset:12288
s_waitcnt vmcnt(16)
v_mfma_f32_16x16x32_bf16 v[68:71], a[68:71], a[20:23], v[68:71]
ds_read_b64_tr_b16 a[98:99], v244 offset:14336
ds_read_b128 v[200:203], v28 offset:0
v_mfma_f32_16x16x32_bf16 v[64:67], a[68:71], a[16:19], v[64:67]
ds_read_b64_tr_b16 a[100:101], v245 offset:12288
s_waitcnt lgkmcnt(12)
v_mfma_f32_16x16x32_bf16 v[72:75], a[72:75], a[16:19], v[72:75]
ds_read_b64_tr_b16 a[102:103], v245 offset:14336
ds_read_b128 v[204:207], v28 offset:2048
v_mfma_f32_16x16x32_bf16 v[76:79], a[72:75], a[20:23], v[76:79]
ds_read_b64_tr_b16 a[104:105], v246 offset:12288
ds_read_b64_tr_b16 a[106:107], v246 offset:14336
v_mfma_f32_16x16x32_bf16 v[84:87], a[76:79], a[20:23], v[84:87]
ds_read_b128 v[208:211], v29 offset:0
ds_read_b128 v[212:215], v29 offset:2048
v_mfma_f32_16x16x32_bf16 v[80:83], a[76:79], a[16:19], v[80:83]
ds_read_b64_tr_b16 a[108:109], v247 offset:12288
s_waitcnt lgkmcnt(15)
v_mfma_f32_16x16x32_bf16 v[88:91], a[80:83], a[16:19], v[88:91]
buffer_load_dwordx4 a[8:11], v1, s[60:63], s78 offen offset:1024 sc1
v_mfma_f32_16x16x32_bf16 v[92:95], a[80:83], a[20:23], v[92:95]
ds_read_b64_tr_b16 a[110:111], v247 offset:14336
ds_read_b64_tr_b16 a[112:113], v244 offset:28672
v_mfma_f32_16x16x32_bf16 v[100:103], a[84:87], a[20:23], v[100:103]
ds_read_b64_tr_b16 a[114:115], v244 offset:30720
s_add_u32 m0, s76, 32768
v_mfma_f32_16x16x32_bf16 v[96:99], a[84:87], a[16:19], v[96:99]
ds_read_b64_tr_b16 a[116:117], v245 offset:28672
s_waitcnt lgkmcnt(15)
v_mfma_f32_16x16x32_bf16 v[104:107], a[88:91], a[16:19], v[104:107]
buffer_load_dwordx4 a[12:15], v1, s[60:63], s79 offen offset:1024 sc1
s_waitcnt lgkmcnt(5)
v_mfma_f32_16x16x32_bf16 v[108:111], a[88:91], a[20:23], v[108:111]
ds_read_b64_tr_b16 a[118:119], v245 offset:30720
s_waitcnt vmcnt(12)
s_barrier
    s_cmp_eq_u32 s3, 0
    s_cbranch_scc0 L2_ps_d
    s_add_u32 s11, s85, 4096
    v_mov_b32 v16, s98
    v_mov_b32 v17, s98
    s_mov_b64 exec, 1
    buffer_store_dwordx2 v[16:17], v54, s[64:67], s11 offen sc0 sc1
    s_mov_b64 exec, -1
    s_nop 1
L2_ps_d:
v_mfma_f32_16x16x32_bf16 v[116:119], a[92:95], a[20:23], v[116:119]
ds_read_b64_tr_b16 a[120:121], v246 offset:28672
ds_read_b64_tr_b16 a[122:123], v246 offset:30720
v_mfma_f32_16x16x32_bf16 v[112:115], a[92:95], a[16:19], v[112:115]
s_add_u32 s52, s52, s77
s_addc_u32 s53, s53, 0
s_waitcnt vmcnt(26)
v_mfma_f32_16x16x32_bf16 v[56:59], a[96:99], a[24:27], v[56:59]
buffer_load_dwordx4 v240, s[52:55], s68 offen offset:0  lds
v_mfma_f32_16x16x32_bf16 v[60:63], a[96:99], a[28:31], v[60:63]
ds_read_b64_tr_b16 a[124:125], v247 offset:28672
ds_read_b64_tr_b16 a[126:127], v247 offset:30720
v_mfma_f32_16x16x32_bf16 v[68:71], a[100:103], a[28:31], v[68:71]
ds_read_b64_tr_b16 a[64:65], v244 offset:32768
ds_read_b64_tr_b16 a[66:67], v244 offset:34816
v_mfma_f32_16x16x32_bf16 v[64:67], a[100:103], a[24:27], v[64:67]
ds_read_b64_tr_b16 a[68:69], v245 offset:32768
s_waitcnt lgkmcnt(11)
v_mfma_f32_16x16x32_bf16 v[72:75], a[104:107], a[24:27], v[72:75]
buffer_load_dwordx4 v241, s[52:55], s69 offen offset:1024  lds
v_mfma_f32_16x16x32_bf16 v[76:79], a[104:107], a[28:31], v[76:79]
ds_read_b64_tr_b16 a[70:71], v245 offset:34816
ds_read_b64_tr_b16 a[72:73], v246 offset:32768
v_mfma_f32_16x16x32_bf16 v[84:87], a[108:111], a[28:31], v[84:87]
ds_read_b64_tr_b16 a[74:75], v246 offset:34816
v_mfma_f32_16x16x32_bf16 v[80:83], a[108:111], a[24:27], v[80:83]
ds_read_b64_tr_b16 a[76:77], v247 offset:32768
s_waitcnt lgkmcnt(11)
v_mfma_f32_16x16x32_bf16 v[88:91], a[112:115], a[24:27], v[88:91]
buffer_load_dwordx4 a[16:19], v1, s[60:63], s78 offen offset:2048 sc1
v_mfma_f32_16x16x32_bf16 v[92:95], a[112:115], a[28:31], v[92:95]
ds_read_b64_tr_b16 a[78:79], v247 offset:34816
ds_read_b64_tr_b16 a[80:81], v244 offset:49152
v_mfma_f32_16x16x32_bf16 v[100:103], a[116:119], a[28:31], v[100:103]
ds_read_b64_tr_b16 a[82:83], v244 offset:51200
v_mfma_f32_16x16x32_bf16 v[96:99], a[116:119], a[24:27], v[96:99]
ds_read_b64_tr_b16 a[84:85], v245 offset:49152
s_waitcnt lgkmcnt(11)
v_mfma_f32_16x16x32_bf16 v[104:107], a[120:123], a[24:27], v[104:107]
buffer_load_dwordx4 a[20:23], v1, s[60:63], s79 offen offset:2048 sc1
v_mfma_f32_16x16x32_bf16 v[108:111], a[120:123], a[28:31], v[108:111]
ds_read_b64_tr_b16 a[86:87], v245 offset:51200
ds_read_b64_tr_b16 a[88:89], v246 offset:49152
v_mfma_f32_16x16x32_bf16 v[116:119], a[124:127], a[28:31], v[116:119]
ds_read_b64_tr_b16 a[90:91], v246 offset:51200
v_mfma_f32_16x16x32_bf16 v[112:115], a[124:127], a[24:27], v[112:115]
ds_read_b64_tr_b16 a[92:93], v247 offset:49152
s_waitcnt vmcnt(14) lgkmcnt(11)
v_mfma_f32_16x16x32_bf16 v[56:59], a[64:67], a[32:35], v[56:59]
buffer_load_dwordx4 v240, s[52:55], s70 offen offset:2048  lds
v_mfma_f32_16x16x32_bf16 v[60:63], a[64:67], a[36:39], v[60:63]
ds_read_b64_tr_b16 a[94:95], v247 offset:51200
ds_read_b64_tr_b16 a[96:97], v244 offset:36864
v_mfma_f32_16x16x32_bf16 v[68:71], a[68:71], a[36:39], v[68:71]
ds_read_b64_tr_b16 a[98:99], v244 offset:38912
v_xor_b32 v248, 65536, v248
v_mfma_f32_16x16x32_bf16 v[64:67], a[68:71], a[32:35], v[64:67]
ds_read_b64_tr_b16 a[100:101], v245 offset:36864
s_waitcnt lgkmcnt(11)
v_mfma_f32_16x16x32_bf16 v[72:75], a[72:75], a[32:35], v[72:75]
buffer_load_dwordx4 v241, s[52:55], s71 offen offset:3072  lds
v_mfma_f32_16x16x32_bf16 v[76:79], a[72:75], a[36:39], v[76:79]
ds_read_b64_tr_b16 a[102:103], v245 offset:38912
ds_read_b64_tr_b16 a[104:105], v246 offset:36864
v_mfma_f32_16x16x32_bf16 v[84:87], a[76:79], a[36:39], v[84:87]
ds_read_b64_tr_b16 a[106:107], v246 offset:38912
s_add_u32 m0, s76, 36864
v_mfma_f32_16x16x32_bf16 v[80:83], a[76:79], a[32:35], v[80:83]
ds_read_b64_tr_b16 a[108:109], v247 offset:36864
s_waitcnt lgkmcnt(11)
v_mfma_f32_16x16x32_bf16 v[88:91], a[80:83], a[32:35], v[88:91]
buffer_load_dwordx4 a[24:27], v1, s[60:63], s78 offen offset:3072 sc1
v_mfma_f32_16x16x32_bf16 v[92:95], a[80:83], a[36:39], v[92:95]
ds_read_b64_tr_b16 a[110:111], v247 offset:38912
ds_read_b64_tr_b16 a[112:113], v244 offset:53248
v_mfma_f32_16x16x32_bf16 v[100:103], a[84:87], a[36:39], v[100:103]
ds_read_b64_tr_b16 a[114:115], v244 offset:55296
v_xor_b32 v249, 65536, v249
v_mfma_f32_16x16x32_bf16 v[96:99], a[84:87], a[32:35], v[96:99]
ds_read_b64_tr_b16 a[116:117], v245 offset:53248
s_waitcnt lgkmcnt(11)
v_mfma_f32_16x16x32_bf16 v[104:107], a[88:91], a[32:35], v[104:107]
buffer_load_dwordx4 a[28:31], v1, s[60:63], s79 offen offset:3072 sc1
v_mfma_f32_16x16x32_bf16 v[108:111], a[88:91], a[36:39], v[108:111]
ds_read_b64_tr_b16 a[118:119], v245 offset:55296
ds_read_b64_tr_b16 a[120:121], v246 offset:53248
v_mfma_f32_16x16x32_bf16 v[116:119], a[92:95], a[36:39], v[116:119]
ds_read_b64_tr_b16 a[122:123], v246 offset:55296
s_add_u32 s78, s78, 4096
v_mfma_f32_16x16x32_bf16 v[112:115], a[92:95], a[32:35], v[112:115]
ds_read_b64_tr_b16 a[124:125], v247 offset:53248
s_waitcnt vmcnt(16) lgkmcnt(11)
v_mfma_f32_16x16x32_bf16 v[56:59], a[96:99], a[40:43], v[56:59]
buffer_load_dwordx4 v240, s[52:55], s72 offen offset:0  lds
v_mfma_f32_16x16x32_bf16 v[60:63], a[96:99], a[44:47], v[60:63]
ds_read_b64_tr_b16 a[126:127], v247 offset:55296
ds_read_b64_tr_b16 a[64:65], v244 offset:40960
v_mfma_f32_16x16x32_bf16 v[68:71], a[100:103], a[44:47], v[68:71]
ds_read_b64_tr_b16 a[66:67], v244 offset:43008
s_add_u32 s79, s79, 4096
v_mfma_f32_16x16x32_bf16 v[64:67], a[100:103], a[40:43], v[64:67]
ds_read_b64_tr_b16 a[68:69], v245 offset:40960
s_waitcnt lgkmcnt(11)
v_mfma_f32_16x16x32_bf16 v[72:75], a[104:107], a[40:43], v[72:75]
buffer_load_dwordx4 v241, s[52:55], s73 offen offset:1024  lds
v_mfma_f32_16x16x32_bf16 v[76:79], a[104:107], a[44:47], v[76:79]
ds_read_b64_tr_b16 a[70:71], v245 offset:43008
ds_read_b64_tr_b16 a[72:73], v246 offset:40960
v_mfma_f32_16x16x32_bf16 v[84:87], a[108:111], a[44:47], v[84:87]
ds_read_b64_tr_b16 a[74:75], v246 offset:43008
v_xor_b32 v250, 65536, v250
v_mfma_f32_16x16x32_bf16 v[80:83], a[108:111], a[40:43], v[80:83]
ds_read_b64_tr_b16 a[76:77], v247 offset:40960
s_waitcnt lgkmcnt(11)
v_mfma_f32_16x16x32_bf16 v[88:91], a[112:115], a[40:43], v[88:91]
buffer_load_dwordx4 a[32:35], v1, s[60:63], s78 offen offset:0 sc1
v_mfma_f32_16x16x32_bf16 v[92:95], a[112:115], a[44:47], v[92:95]
ds_read_b64_tr_b16 a[78:79], v247 offset:43008
ds_read_b64_tr_b16 a[80:81], v244 offset:57344
v_mfma_f32_16x16x32_bf16 v[100:103], a[116:119], a[44:47], v[100:103]
ds_read_b64_tr_b16 a[82:83], v244 offset:59392
v_xor_b32 v251, 65536, v251
v_mfma_f32_16x16x32_bf16 v[96:99], a[116:119], a[40:43], v[96:99]
ds_read_b64_tr_b16 a[84:85], v245 offset:57344
s_waitcnt lgkmcnt(11)
v_mfma_f32_16x16x32_bf16 v[104:107], a[120:123], a[40:43], v[104:107]
buffer_load_dwordx4 a[36:39], v1, s[60:63], s79 offen offset:0 sc1
v_mfma_f32_16x16x32_bf16 v[108:111], a[120:123], a[44:47], v[108:111]
ds_read_b64_tr_b16 a[86:87], v245 offset:59392
ds_read_b64_tr_b16 a[88:89], v246 offset:57344
v_mfma_f32_16x16x32_bf16 v[116:119], a[124:127], a[44:47], v[116:119]
ds_read_b64_tr_b16 a[90:91], v246 offset:59392
v_mfma_f32_16x16x32_bf16 v[112:115], a[124:127], a[40:43], v[112:115]
ds_read_b64_tr_b16 a[92:93], v247 offset:57344
s_waitcnt vmcnt(18) lgkmcnt(11)
v_mfma_f32_16x16x32_bf16 v[56:59], a[64:67], a[48:51], v[56:59]
buffer_load_dwordx4 v240, s[52:55], s74 offen offset:2048  lds
v_mfma_f32_16x16x32_bf16 v[60:63], a[64:67], a[52:55], v[60:63]
ds_read_b64_tr_b16 a[94:95], v247 offset:59392
ds_read_b64_tr_b16 a[96:97], v244 offset:45056
v_mfma_f32_16x16x32_bf16 v[68:71], a[68:71], a[52:55], v[68:71]
ds_read_b64_tr_b16 a[98:99], v244 offset:47104
v_mfma_f32_16x16x32_bf16 v[64:67], a[68:71], a[48:51], v[64:67]
ds_read_b64_tr_b16 a[100:101], v245 offset:45056
s_waitcnt lgkmcnt(11)
v_mfma_f32_16x16x32_bf16 v[72:75], a[72:75], a[48:51], v[72:75]
buffer_load_dwordx4 v241, s[52:55], s75 offen offset:3072  lds
v_mfma_f32_16x16x32_bf16 v[76:79], a[72:75], a[52:55], v[76:79]
ds_read_b64_tr_b16 a[102:103], v245 offset:47104
ds_read_b64_tr_b16 a[104:105], v246 offset:45056
v_mfma_f32_16x16x32_bf16 v[84:87], a[76:79], a[52:55], v[84:87]
ds_read_b64_tr_b16 a[106:107], v246 offset:47104
s_xor_b32 s76, s76, 65536
v_mfma_f32_16x16x32_bf16 v[80:83], a[76:79], a[48:51], v[80:83]
ds_read_b64_tr_b16 a[108:109], v247 offset:45056
s_waitcnt lgkmcnt(11)
v_mfma_f32_16x16x32_bf16 v[88:91], a[80:83], a[48:51], v[88:91]
buffer_load_dwordx4 a[40:43], v1, s[60:63], s78 offen offset:1024 sc1
v_mfma_f32_16x16x32_bf16 v[92:95], a[80:83], a[52:55], v[92:95]
ds_read_b64_tr_b16 a[110:111], v247 offset:47104
ds_read_b64_tr_b16 a[112:113], v244 offset:61440
v_mfma_f32_16x16x32_bf16 v[100:103], a[84:87], a[52:55], v[100:103]
ds_read_b64_tr_b16 a[114:115], v244 offset:63488
s_add_u32 m0, s76, 0
v_mfma_f32_16x16x32_bf16 v[96:99], a[84:87], a[48:51], v[96:99]
ds_read_b64_tr_b16 a[116:117], v245 offset:61440
s_waitcnt lgkmcnt(11)
v_mfma_f32_16x16x32_bf16 v[104:107], a[88:91], a[48:51], v[104:107]
buffer_load_dwordx4 a[44:47], v1, s[60:63], s79 offen offset:1024 sc1
v_mfma_f32_16x16x32_bf16 v[108:111], a[88:91], a[52:55], v[108:111]
ds_read_b64_tr_b16 a[118:119], v245 offset:63488
s_waitcnt vmcnt(50)
s_barrier
v_mfma_f32_16x16x32_bf16 v[116:119], a[92:95], a[52:55], v[116:119]
ds_read_b64_tr_b16 a[120:121], v246 offset:61440
ds_read_b64_tr_b16 a[122:123], v246 offset:63488
v_mfma_f32_16x16x32_bf16 v[112:115], a[92:95], a[48:51], v[112:115]
s_add_u32 s52, s52, s77
s_addc_u32 s53, s53, 0
s_waitcnt vmcnt(20) lgkmcnt(10)
v_mfma_f32_16x16x32_bf16 v[56:59], a[96:99], a[56:59], v[56:59]
buffer_load_dwordx4 v240, s[52:55], s68 offen offset:0  lds
v_mfma_f32_16x16x32_bf16 v[60:63], a[96:99], a[60:63], v[60:63]
ds_read_b64_tr_b16 a[124:125], v247 offset:61440
ds_read_b64_tr_b16 a[126:127], v247 offset:63488
v_mfma_f32_16x16x32_bf16 v[68:71], a[100:103], a[60:63], v[68:71]
v_xor_b32 v244, 65536, v244
v_xor_b32 v245, 65536, v245
v_xor_b32 v246, 65536, v246
v_xor_b32 v247, 65536, v247
v_mfma_f32_16x16x32_bf16 v[64:67], a[100:103], a[56:59], v[64:67]
ds_read_b64_tr_b16 a[64:65], v244 offset:0
ds_read_b64_tr_b16 a[66:67], v244 offset:2048
s_waitcnt lgkmcnt(10)
v_mfma_f32_16x16x32_bf16 v[72:75], a[104:107], a[56:59], v[72:75]
buffer_load_dwordx4 v241, s[52:55], s69 offen offset:1024  lds
v_mfma_f32_16x16x32_bf16 v[76:79], a[104:107], a[60:63], v[76:79]
ds_read_b64_tr_b16 a[68:69], v245 offset:0
ds_read_b64_tr_b16 a[70:71], v245 offset:2048
v_mfma_f32_16x16x32_bf16 v[84:87], a[108:111], a[60:63], v[84:87]
ds_read_b64_tr_b16 a[72:73], v246 offset:0
ds_read_b64_tr_b16 a[74:75], v246 offset:2048
v_mfma_f32_16x16x32_bf16 v[80:83], a[108:111], a[56:59], v[80:83]
ds_read_b64_tr_b16 a[76:77], v247 offset:0
s_waitcnt lgkmcnt(11)
v_mfma_f32_16x16x32_bf16 v[88:91], a[112:115], a[56:59], v[88:91]
buffer_load_dwordx4 a[48:51], v1, s[60:63], s78 offen offset:2048 sc1
v_mfma_f32_16x16x32_bf16 v[92:95], a[112:115], a[60:63], v[92:95]
ds_read_b64_tr_b16 a[78:79], v247 offset:2048
ds_read_b64_tr_b16 a[80:81], v244 offset:16384
v_mfma_f32_16x16x32_bf16 v[100:103], a[116:119], a[60:63], v[100:103]
ds_read_b64_tr_b16 a[82:83], v244 offset:18432
v_mfma_f32_16x16x32_bf16 v[96:99], a[116:119], a[56:59], v[96:99]
ds_read_b64_tr_b16 a[84:85], v245 offset:16384
s_waitcnt lgkmcnt(11)
v_mfma_f32_16x16x32_bf16 v[104:107], a[120:123], a[56:59], v[104:107]
buffer_load_dwordx4 a[52:55], v1, s[60:63], s79 offen offset:2048 sc1
v_mfma_f32_16x16x32_bf16 v[108:111], a[120:123], a[60:63], v[108:111]
ds_read_b64_tr_b16 a[86:87], v245 offset:18432
ds_read_b64_tr_b16 a[88:89], v246 offset:16384
v_mfma_f32_16x16x32_bf16 v[116:119], a[124:127], a[60:63], v[116:119]
ds_read_b64_tr_b16 a[90:91], v246 offset:18432
v_mfma_f32_16x16x32_bf16 v[112:115], a[124:127], a[56:59], v[112:115]
s_mov_b32 s10, 5
.p2align 3
L2_gloop:
ds_read_b64_tr_b16 a[92:93], v247 offset:16384
s_waitcnt vmcnt(22) lgkmcnt(11)
v_mfma_f32_16x16x32_bf16 v[56:59], a[64:67], a[0:3], v[56:59]
buffer_load_dwordx4 v240, s[52:55], s70 offen offset:2048  lds
v_mfma_f32_16x16x32_bf16 v[60:63], a[64:67], a[4:7], v[60:63]
ds_read_b64_tr_b16 a[94:95], v247 offset:18432
ds_read_b64_tr_b16 a[96:97], v244 offset:4096
v_mfma_f32_16x16x32_bf16 v[68:71], a[68:71], a[4:7], v[68:71]
ds_read_b64_tr_b16 a[98:99], v244 offset:6144
s_sub_u32 s10, s10, 1
v_mfma_f32_16x16x32_bf16 v[64:67], a[68:71], a[0:3], v[64:67]
ds_read_b64_tr_b16 a[100:101], v245 offset:4096
s_waitcnt lgkmcnt(11)
v_mfma_f32_16x16x32_bf16 v[72:75], a[72:75], a[0:3], v[72:75]
buffer_load_dwordx4 v241, s[52:55], s71 offen offset:3072  lds
v_mfma_f32_16x16x32_bf16 v[76:79], a[72:75], a[4:7], v[76:79]
ds_read_b64_tr_b16 a[102:103], v245 offset:6144
ds_read_b64_tr_b16 a[104:105], v246 offset:4096
v_mfma_f32_16x16x32_bf16 v[84:87], a[76:79], a[4:7], v[84:87]
ds_read_b64_tr_b16 a[106:107], v246 offset:6144
s_add_u32 m0, s76, 4096
v_mfma_f32_16x16x32_bf16 v[80:83], a[76:79], a[0:3], v[80:83]
ds_read_b64_tr_b16 a[108:109], v247 offset:4096
s_waitcnt lgkmcnt(11)
v_mfma_f32_16x16x32_bf16 v[88:91], a[80:83], a[0:3], v[88:91]
buffer_load_dwordx4 a[56:59], v1, s[60:63], s78 offen offset:3072 sc1
v_mfma_f32_16x16x32_bf16 v[92:95], a[80:83], a[4:7], v[92:95]
ds_read_b64_tr_b16 a[110:111], v247 offset:6144
ds_read_b64_tr_b16 a[112:113], v244 offset:20480
v_mfma_f32_16x16x32_bf16 v[100:103], a[84:87], a[4:7], v[100:103]
ds_read_b64_tr_b16 a[114:115], v244 offset:22528
v_mfma_f32_16x16x32_bf16 v[96:99], a[84:87], a[0:3], v[96:99]
ds_read_b64_tr_b16 a[116:117], v245 offset:20480
s_waitcnt lgkmcnt(11)
v_mfma_f32_16x16x32_bf16 v[104:107], a[88:91], a[0:3], v[104:107]
buffer_load_dwordx4 a[60:63], v1, s[60:63], s79 offen offset:3072 sc1
v_mfma_f32_16x16x32_bf16 v[108:111], a[88:91], a[4:7], v[108:111]
ds_read_b64_tr_b16 a[118:119], v245 offset:22528
ds_read_b64_tr_b16 a[120:121], v246 offset:20480
v_mfma_f32_16x16x32_bf16 v[116:119], a[92:95], a[4:7], v[116:119]
ds_read_b64_tr_b16 a[122:123], v246 offset:22528
s_add_u32 s78, s78, 4096
v_mfma_f32_16x16x32_bf16 v[112:115], a[92:95], a[0:3], v[112:115]
ds_read_b64_tr_b16 a[124:125], v247 offset:20480
s_waitcnt vmcnt(24) lgkmcnt(11)
v_mfma_f32_16x16x32_bf16 v[56:59], a[96:99], a[8:11], v[56:59]
buffer_load_dwordx4 v240, s[52:55], s72 offen offset:0  lds
v_mfma_f32_16x16x32_bf16 v[60:63], a[96:99], a[12:15], v[60:63]
ds_read_b64_tr_b16 a[126:127], v247 offset:22528
ds_read_b64_tr_b16 a[64:65], v244 offset:8192
v_mfma_f32_16x16x32_bf16 v[68:71], a[100:103], a[12:15], v[68:71]
ds_read_b64_tr_b16 a[66:67], v244 offset:10240
s_add_u32 s79, s79, 4096
v_mfma_f32_16x16x32_bf16 v[64:67], a[100:103], a[8:11], v[64:67]
ds_read_b64_tr_b16 a[68:69], v245 offset:8192
s_waitcnt lgkmcnt(11)
v_mfma_f32_16x16x32_bf16 v[72:75], a[104:107], a[8:11], v[72:75]
buffer_load_dwordx4 v241, s[52:55], s73 offen offset:1024  lds
v_mfma_f32_16x16x32_bf16 v[76:79], a[104:107], a[12:15], v[76:79]
ds_read_b64_tr_b16 a[70:71], v245 offset:10240
ds_read_b64_tr_b16 a[72:73], v246 offset:8192
v_mfma_f32_16x16x32_bf16 v[84:87], a[108:111], a[12:15], v[84:87]
ds_read_b64_tr_b16 a[74:75], v246 offset:10240
v_mfma_f32_16x16x32_bf16 v[80:83], a[108:111], a[8:11], v[80:83]
ds_read_b64_tr_b16 a[76:77], v247 offset:8192
s_waitcnt lgkmcnt(11)
v_mfma_f32_16x16x32_bf16 v[88:91], a[112:115], a[8:11], v[88:91]
buffer_load_dwordx4 a[0:3], v1, s[60:63], s78 offen offset:0 sc1
v_mfma_f32_16x16x32_bf16 v[92:95], a[112:115], a[12:15], v[92:95]
ds_read_b64_tr_b16 a[78:79], v247 offset:10240
ds_read_b64_tr_b16 a[80:81], v244 offset:24576
v_mfma_f32_16x16x32_bf16 v[100:103], a[116:119], a[12:15], v[100:103]
ds_read_b64_tr_b16 a[82:83], v244 offset:26624
v_mfma_f32_16x16x32_bf16 v[96:99], a[116:119], a[8:11], v[96:99]
ds_read_b64_tr_b16 a[84:85], v245 offset:24576
s_waitcnt lgkmcnt(11)
v_mfma_f32_16x16x32_bf16 v[104:107], a[120:123], a[8:11], v[104:107]
buffer_load_dwordx4 a[4:7], v1, s[60:63], s79 offen offset:0 sc1
v_mfma_f32_16x16x32_bf16 v[108:111], a[120:123], a[12:15], v[108:111]
ds_read_b64_tr_b16 a[86:87], v245 offset:26624
ds_read_b64_tr_b16 a[88:89], v246 offset:24576
v_mfma_f32_16x16x32_bf16 v[116:119], a[124:127], a[12:15], v[116:119]
ds_read_b64_tr_b16 a[90:91], v246 offset:26624
v_mfma_f32_16x16x32_bf16 v[112:115], a[124:127], a[8:11], v[112:115]
ds_read_b64_tr_b16 a[92:93], v247 offset:24576
s_waitcnt vmcnt(24) lgkmcnt(11)
v_mfma_f32_16x16x32_bf16 v[56:59], a[64:67], a[16:19], v[56:59]
buffer_load_dwordx4 v240, s[52:55], s74 offen offset:2048  lds
v_mfma_f32_16x16x32_bf16 v[60:63], a[64:67], a[20:23], v[60:63]
ds_read_b64_tr_b16 a[94:95], v247 offset:26624
ds_read_b64_tr_b16 a[96:97], v244 offset:12288
v_mfma_f32_16x16x32_bf16 v[68:71], a[68:71], a[20:23], v[68:71]
ds_read_b64_tr_b16 a[98:99], v244 offset:14336
v_mfma_f32_16x16x32_bf16 v[64:67], a[68:71], a[16:19], v[64:67]
ds_read_b64_tr_b16 a[100:101], v245 offset:12288
s_waitcnt lgkmcnt(11)
v_mfma_f32_16x16x32_bf16 v[72:75], a[72:75], a[16:19], v[72:75]
buffer_load_dwordx4 v241, s[52:55], s75 offen offset:3072  lds
v_mfma_f32_16x16x32_bf16 v[76:79], a[72:75], a[20:23], v[76:79]
ds_read_b64_tr_b16 a[102:103], v245 offset:14336
ds_read_b64_tr_b16 a[104:105], v246 offset:12288
v_mfma_f32_16x16x32_bf16 v[84:87], a[76:79], a[20:23], v[84:87]
ds_read_b64_tr_b16 a[106:107], v246 offset:14336
s_add_u32 m0, s76, 32768
v_mfma_f32_16x16x32_bf16 v[80:83], a[76:79], a[16:19], v[80:83]
ds_read_b64_tr_b16 a[108:109], v247 offset:12288
s_waitcnt lgkmcnt(11)
v_mfma_f32_16x16x32_bf16 v[88:91], a[80:83], a[16:19], v[88:91]
buffer_load_dwordx4 a[8:11], v1, s[60:63], s78 offen offset:1024 sc1
v_mfma_f32_16x16x32_bf16 v[92:95], a[80:83], a[20:23], v[92:95]
ds_read_b64_tr_b16 a[110:111], v247 offset:14336
ds_read_b64_tr_b16 a[112:113], v244 offset:28672
v_mfma_f32_16x16x32_bf16 v[100:103], a[84:87], a[20:23], v[100:103]
ds_read_b64_tr_b16 a[114:115], v244 offset:30720
v_mfma_f32_16x16x32_bf16 v[96:99], a[84:87], a[16:19], v[96:99]
ds_read_b64_tr_b16 a[116:117], v245 offset:28672
s_waitcnt lgkmcnt(11)
v_mfma_f32_16x16x32_bf16 v[104:107], a[88:91], a[16:19], v[104:107]
buffer_load_dwordx4 a[12:15], v1, s[60:63], s79 offen offset:1024 sc1
v_mfma_f32_16x16x32_bf16 v[108:111], a[88:91], a[20:23], v[108:111]
ds_read_b64_tr_b16 a[118:119], v245 offset:30720
s_waitcnt vmcnt(18)
s_barrier
v_mfma_f32_16x16x32_bf16 v[116:119], a[92:95], a[20:23], v[116:119]
ds_read_b64_tr_b16 a[120:121], v246 offset:28672
ds_read_b64_tr_b16 a[122:123], v246 offset:30720
v_mfma_f32_16x16x32_bf16 v[112:115], a[92:95], a[16:19], v[112:115]
s_add_u32 s52, s52, s77
s_addc_u32 s53, s53, 0
s_waitcnt vmcnt(24) lgkmcnt(10)
v_mfma_f32_16x16x32_bf16 v[56:59], a[96:99], a[24:27], v[56:59]
buffer_load_dwordx4 v240, s[52:55], s68 offen offset:0  lds
v_mfma_f32_16x16x32_bf16 v[60:63], a[96:99], a[28:31], v[60:63]
ds_read_b64_tr_b16 a[124:125], v247 offset:28672
ds_read_b64_tr_b16 a[126:127], v247 offset:30720
v_mfma_f32_16x16x32_bf16 v[68:71], a[100:103], a[28:31], v[68:71]
ds_read_b64_tr_b16 a[64:65], v244 offset:32768
ds_read_b64_tr_b16 a[66:67], v244 offset:34816
v_mfma_f32_16x16x32_bf16 v[64:67], a[100:103], a[24:27], v[64:67]
ds_read_b64_tr_b16 a[68:69], v245 offset:32768
s_waitcnt lgkmcnt(11)
v_mfma_f32_16x16x32_bf16 v[72:75], a[104:107], a[24:27], v[72:75]
buffer_load_dwordx4 v241, s[52:55], s69 offen offset:1024  lds
v_mfma_f32_16x16x32_bf16 v[76:79], a[104:107], a[28:31], v[76:79]
ds_read_b64_tr_b16 a[70:71], v245 offset:34816
ds_read_b64_tr_b16 a[72:73], v246 offset:32768
v_mfma_f32_16x16x32_bf16 v[84:87], a[108:111], a[28:31], v[84:87]
ds_read_b64_tr_b16 a[74:75], v246 offset:34816
v_mfma_f32_16x16x32_bf16 v[80:83], a[108:111], a[24:27], v[80:83]
ds_read_b64_tr_b16 a[76:77], v247 offset:32768
s_waitcnt lgkmcnt(11)
v_mfma_f32_16x16x32_bf16 v[88:91], a[112:115], a[24:27], v[88:91]
buffer_load_dwordx4 a[16:19], v1, s[60:63], s78 offen offset:2048 sc1
v_mfma_f32_16x16x32_bf16 v[92:95], a[112:115], a[28:31], v[92:95]
ds_read_b64_tr_b16 a[78:79], v247 offset:34816
ds_read_b64_tr_b16 a[80:81], v244 offset:49152
v_mfma_f32_16x16x32_bf16 v[100:103], a[116:119], a[28:31], v[100:103]
buffer_load_dwordx2 v[16:17], v54, s[64:67], s95 offen sc0 sc1
v_mfma_f32_16x16x32_bf16 v[96:99], a[116:119], a[24:27], v[96:99]
ds_read_b64_tr_b16 a[82:83], v244 offset:51200
s_waitcnt lgkmcnt(10)
v_mfma_f32_16x16x32_bf16 v[104:107], a[120:123], a[24:27], v[104:107]
buffer_load_dwordx4 a[20:23], v1, s[60:63], s79 offen offset:2048 sc1
v_mfma_f32_16x16x32_bf16 v[108:111], a[120:123], a[28:31], v[108:111]
ds_read_b64_tr_b16 a[84:85], v245 offset:49152
ds_read_b64_tr_b16 a[86:87], v245 offset:51200
v_mfma_f32_16x16x32_bf16 v[116:119], a[124:127], a[28:31], v[116:119]
ds_read_b64_tr_b16 a[88:89], v246 offset:49152
ds_read_b64_tr_b16 a[90:91], v246 offset:51200
v_mfma_f32_16x16x32_bf16 v[112:115], a[124:127], a[24:27], v[112:115]
ds_read_b64_tr_b16 a[92:93], v247 offset:49152
s_waitcnt vmcnt(25) lgkmcnt(11)
v_mfma_f32_16x16x32_bf16 v[56:59], a[64:67], a[32:35], v[56:59]
buffer_load_dwordx4 v240, s[52:55], s70 offen offset:2048  lds
v_mfma_f32_16x16x32_bf16 v[60:63], a[64:67], a[36:39], v[60:63]
ds_read_b64_tr_b16 a[94:95], v247 offset:51200
ds_read_b64_tr_b16 a[96:97], v244 offset:36864
v_mfma_f32_16x16x32_bf16 v[68:71], a[68:71], a[36:39], v[68:71]
ds_read_b64_tr_b16 a[98:99], v244 offset:38912
v_xor_b32 v248, 65536, v248
v_mfma_f32_16x16x32_bf16 v[64:67], a[68:71], a[32:35], v[64:67]
ds_read_b64_tr_b16 a[100:101], v245 offset:36864
s_waitcnt lgkmcnt(11)
v_mfma_f32_16x16x32_bf16 v[72:75], a[72:75], a[32:35], v[72:75]
buffer_load_dwordx4 v241, s[52:55], s71 offen offset:3072  lds
v_mfma_f32_16x16x32_bf16 v[76:79], a[72:75], a[36:39], v[76:79]
ds_read_b64_tr_b16 a[102:103], v245 offset:38912
ds_read_b64_tr_b16 a[104:105], v246 offset:36864
v_mfma_f32_16x16x32_bf16 v[84:87], a[76:79], a[36:39], v[84:87]
ds_read_b64_tr_b16 a[106:107], v246 offset:38912
s_add_u32 m0, s76, 36864
v_mfma_f32_16x16x32_bf16 v[80:83], a[76:79], a[32:35], v[80:83]
ds_read_b64_tr_b16 a[108:109], v247 offset:36864
s_waitcnt lgkmcnt(11)
v_mfma_f32_16x16x32_bf16 v[88:91], a[80:83], a[32:35], v[88:91]
buffer_load_dwordx4 a[24:27], v1, s[60:63], s78 offen offset:3072 sc1
v_mfma_f32_16x16x32_bf16 v[92:95], a[80:83], a[36:39], v[92:95]
ds_read_b64_tr_b16 a[110:111], v247 offset:38912
ds_read_b64_tr_b16 a[112:113], v244 offset:53248
v_mfma_f32_16x16x32_bf16 v[100:103], a[84:87], a[36:39], v[100:103]
ds_read_b64_tr_b16 a[114:115], v244 offset:55296
v_xor_b32 v249, 65536, v249
v_mfma_f32_16x16x32_bf16 v[96:99], a[84:87], a[32:35], v[96:99]
ds_read_b64_tr_b16 a[116:117], v245 offset:53248
s_waitcnt lgkmcnt(11)
v_mfma_f32_16x16x32_bf16 v[104:107], a[88:91], a[32:35], v[104:107]
buffer_load_dwordx4 a[28:31], v1, s[60:63], s79 offen offset:3072 sc1
v_mfma_f32_16x16x32_bf16 v[108:111], a[88:91], a[36:39], v[108:111]
ds_read_b64_tr_b16 a[118:119], v245 offset:55296
ds_read_b64_tr_b16 a[120:121], v246 offset:53248
v_mfma_f32_16x16x32_bf16 v[116:119], a[92:95], a[36:39], v[116:119]
ds_read_b64_tr_b16 a[122:123], v246 offset:55296
s_add_u32 s78, s78, 4096
v_mfma_f32_16x16x32_bf16 v[112:115], a[92:95], a[32:35], v[112:115]
ds_read_b64_tr_b16 a[124:125], v247 offset:53248
s_waitcnt vmcnt(25) lgkmcnt(11)
v_mfma_f32_16x16x32_bf16 v[56:59], a[96:99], a[40:43], v[56:59]
buffer_load_dwordx4 v240, s[52:55], s72 offen offset:0  lds
v_mfma_f32_16x16x32_bf16 v[60:63], a[96:99], a[44:47], v[60:63]
ds_read_b64_tr_b16 a[126:127], v247 offset:55296
ds_read_b64_tr_b16 a[64:65], v244 offset:40960
v_mfma_f32_16x16x32_bf16 v[68:71], a[100:103], a[44:47], v[68:71]
ds_read_b64_tr_b16 a[66:67], v244 offset:43008
s_add_u32 s79, s79, 4096
v_mfma_f32_16x16x32_bf16 v[64:67], a[100:103], a[40:43], v[64:67]
ds_read_b64_tr_b16 a[68:69], v245 offset:40960
s_waitcnt lgkmcnt(11)
v_mfma_f32_16x16x32_bf16 v[72:75], a[104:107], a[40:43], v[72:75]
buffer_load_dwordx4 v241, s[52:55], s73 offen offset:1024  lds
v_mfma_f32_16x16x32_bf16 v[76:79], a[104:107], a[44:47], v[76:79]
ds_read_b64_tr_b16 a[70:71], v245 offset:43008
ds_read_b64_tr_b16 a[72:73], v246 offset:40960
v_mfma_f32_16x16x32_bf16 v[84:87], a[108:111], a[44:47], v[84:87]
ds_read_b64_tr_b16 a[74:75], v246 offset:43008
v_xor_b32 v250, 65536, v250
v_mfma_f32_16x16x32_bf16 v[80:83], a[108:111], a[40:43], v[80:83]
ds_read_b64_tr_b16 a[76:77], v247 offset:40960
s_waitcnt lgkmcnt(11)
v_mfma_f32_16x16x32_bf16 v[88:91], a[112:115], a[40:43], v[88:91]
buffer_load_dwordx4 a[32:35], v1, s[60:63], s78 offen offset:0 sc1
v_mfma_f32_16x16x32_bf16 v[92:95], a[112:115], a[44:47], v[92:95]
ds_read_b64_tr_b16 a[78:79], v247 offset:43008
ds_read_b64_tr_b16 a[80:81], v244 offset:57344
v_mfma_f32_16x16x32_bf16 v[100:103], a[116:119], a[44:47], v[100:103]
ds_read_b64_tr_b16 a[82:83], v244 offset:59392
v_xor_b32 v251, 65536, v251
v_mfma_f32_16x16x32_bf16 v[96:99], a[116:119], a[40:43], v[96:99]
ds_read_b64_tr_b16 a[84:85], v245 offset:57344
s_waitcnt lgkmcnt(11)
v_mfma_f32_16x16x32_bf16 v[104:107], a[120:123], a[40:43], v[104:107]
buffer_load_dwordx4 a[36:39], v1, s[60:63], s79 offen offset:0 sc1
v_mfma_f32_16x16x32_bf16 v[108:111], a[120:123], a[44:47], v[108:111]
ds_read_b64_tr_b16 a[86:87], v245 offset:59392
ds_read_b64_tr_b16 a[88:89], v246 offset:57344
v_mfma_f32_16x16x32_bf16 v[116:119], a[124:127], a[44:47], v[116:119]
ds_read_b64_tr_b16 a[90:91], v246 offset:59392
v_mfma_f32_16x16x32_bf16 v[112:115], a[124:127], a[40:43], v[112:115]
ds_read_b64_tr_b16 a[92:93], v247 offset:57344
s_waitcnt vmcnt(25) lgkmcnt(11)
v_mfma_f32_16x16x32_bf16 v[56:59], a[64:67], a[48:51], v[56:59]
buffer_load_dwordx4 v240, s[52:55], s74 offen offset:2048  lds
v_mfma_f32_16x16x32_bf16 v[60:63], a[64:67], a[52:55], v[60:63]
ds_read_b64_tr_b16 a[94:95], v247 offset:59392
ds_read_b64_tr_b16 a[96:97], v244 offset:45056
v_mfma_f32_16x16x32_bf16 v[68:71], a[68:71], a[52:55], v[68:71]
ds_read_b64_tr_b16 a[98:99], v244 offset:47104
v_mfma_f32_16x16x32_bf16 v[64:67], a[68:71], a[48:51], v[64:67]
ds_read_b64_tr_b16 a[100:101], v245 offset:45056
s_waitcnt lgkmcnt(11)
v_mfma_f32_16x16x32_bf16 v[72:75], a[72:75], a[48:51], v[72:75]
buffer_load_dwordx4 v241, s[52:55], s75 offen offset:3072  lds
v_mfma_f32_16x16x32_bf16 v[76:79], a[72:75], a[52:55], v[76:79]
ds_read_b64_tr_b16 a[102:103], v245 offset:47104
ds_read_b64_tr_b16 a[104:105], v246 offset:45056
v_mfma_f32_16x16x32_bf16 v[84:87], a[76:79], a[52:55], v[84:87]
ds_read_b64_tr_b16 a[106:107], v246 offset:47104
s_xor_b32 s76, s76, 65536
v_mfma_f32_16x16x32_bf16 v[80:83], a[76:79], a[48:51], v[80:83]
ds_read_b64_tr_b16 a[108:109], v247 offset:45056
s_waitcnt lgkmcnt(11)
v_mfma_f32_16x16x32_bf16 v[88:91], a[80:83], a[48:51], v[88:91]
buffer_load_dwordx4 a[40:43], v1, s[60:63], s78 offen offset:1024 sc1
v_mfma_f32_16x16x32_bf16 v[92:95], a[80:83], a[52:55], v[92:95]
ds_read_b64_tr_b16 a[110:111], v247 offset:47104
ds_read_b64_tr_b16 a[112:113], v244 offset:61440
v_mfma_f32_16x16x32_bf16 v[100:103], a[84:87], a[52:55], v[100:103]
ds_read_b64_tr_b16 a[114:115], v244 offset:63488
s_add_u32 m0, s76, 0
v_mfma_f32_16x16x32_bf16 v[96:99], a[84:87], a[48:51], v[96:99]
ds_read_b64_tr_b16 a[116:117], v245 offset:61440
s_waitcnt lgkmcnt(11)
v_mfma_f32_16x16x32_bf16 v[104:107], a[88:91], a[48:51], v[104:107]
buffer_load_dwordx4 a[44:47], v1, s[60:63], s79 offen offset:1024 sc1
v_mfma_f32_16x16x32_bf16 v[108:111], a[88:91], a[52:55], v[108:111]
ds_read_b64_tr_b16 a[118:119], v245 offset:63488
s_cmp_eq_u32 s10, 0
s_cbranch_scc0 L2_nosw
s_cmp_lt_u32 s3, 2
s_cselect_b32 s52, s26, s28
s_cselect_b32 s53, s27, s29
s_lshl_b32 s11, s81, 1
s_xor_b32 s12, s8, s15
s_add_u32 s11, s11, s12
s_lshl_b32 s11, s11, 17
s_lshl_b32 s12, s15, 10
s_add_u32 s11, s11, s12
s_add_u32 s52, s52, s11
s_addc_u32 s53, s53, 0
s_sub_u32 s52, s52, 3200
s_subb_u32 s53, s53, 0
s_mov_b32 s77, 128
v_mov_b32 v240, v242
v_xor_b32 v241, 64, v242
L2_nosw:
s_waitcnt vmcnt(19)
s_barrier
v_mfma_f32_16x16x32_bf16 v[116:119], a[92:95], a[52:55], v[116:119]
ds_read_b64_tr_b16 a[120:121], v246 offset:61440
ds_read_b64_tr_b16 a[122:123], v246 offset:63488
v_mfma_f32_16x16x32_bf16 v[112:115], a[92:95], a[48:51], v[112:115]
s_add_u32 s52, s52, s77
s_addc_u32 s53, s53, 0
s_waitcnt vmcnt(25) lgkmcnt(10)
v_mfma_f32_16x16x32_bf16 v[56:59], a[96:99], a[56:59], v[56:59]
buffer_load_dwordx4 v240, s[52:55], s68 offen offset:0  lds
v_mfma_f32_16x16x32_bf16 v[60:63], a[96:99], a[60:63], v[60:63]
ds_read_b64_tr_b16 a[124:125], v247 offset:61440
ds_read_b64_tr_b16 a[126:127], v247 offset:63488
v_mfma_f32_16x16x32_bf16 v[68:71], a[100:103], a[60:63], v[68:71]
v_xor_b32 v244, 65536, v244
v_xor_b32 v245, 65536, v245
v_xor_b32 v246, 65536, v246
v_xor_b32 v247, 65536, v247
v_mfma_f32_16x16x32_bf16 v[64:67], a[100:103], a[56:59], v[64:67]
ds_read_b64_tr_b16 a[64:65], v244 offset:0
ds_read_b64_tr_b16 a[66:67], v244 offset:2048
s_waitcnt lgkmcnt(10)
v_mfma_f32_16x16x32_bf16 v[72:75], a[104:107], a[56:59], v[72:75]
buffer_load_dwordx4 v241, s[52:55], s69 offen offset:1024  lds
v_mfma_f32_16x16x32_bf16 v[76:79], a[104:107], a[60:63], v[76:79]
ds_read_b64_tr_b16 a[68:69], v245 offset:0
ds_read_b64_tr_b16 a[70:71], v245 offset:2048
v_mfma_f32_16x16x32_bf16 v[84:87], a[108:111], a[60:63], v[84:87]
ds_read_b64_tr_b16 a[72:73], v246 offset:0
ds_read_b64_tr_b16 a[74:75], v246 offset:2048
v_mfma_f32_16x16x32_bf16 v[80:83], a[108:111], a[56:59], v[80:83]
ds_read_b64_tr_b16 a[76:77], v247 offset:0
s_waitcnt lgkmcnt(11)
v_mfma_f32_16x16x32_bf16 v[88:91], a[112:115], a[56:59], v[88:91]
buffer_load_dwordx4 a[48:51], v1, s[60:63], s78 offen offset:2048 sc1
v_mfma_f32_16x16x32_bf16 v[92:95], a[112:115], a[60:63], v[92:95]
ds_read_b64_tr_b16 a[78:79], v247 offset:2048
ds_read_b64_tr_b16 a[80:81], v244 offset:16384
v_mfma_f32_16x16x32_bf16 v[100:103], a[116:119], a[60:63], v[100:103]
ds_read_b64_tr_b16 a[82:83], v244 offset:18432
v_mfma_f32_16x16x32_bf16 v[96:99], a[116:119], a[56:59], v[96:99]
ds_read_b64_tr_b16 a[84:85], v245 offset:16384
s_waitcnt lgkmcnt(11)
v_mfma_f32_16x16x32_bf16 v[104:107], a[120:123], a[56:59], v[104:107]
buffer_load_dwordx4 a[52:55], v1, s[60:63], s79 offen offset:2048 sc1
v_mfma_f32_16x16x32_bf16 v[108:111], a[120:123], a[60:63], v[108:111]
ds_read_b64_tr_b16 a[86:87], v245 offset:18432
ds_read_b64_tr_b16 a[88:89], v246 offset:16384
v_mfma_f32_16x16x32_bf16 v[116:119], a[124:127], a[60:63], v[116:119]
ds_read_b64_tr_b16 a[90:91], v246 offset:18432
v_mfma_f32_16x16x32_bf16 v[112:115], a[124:127], a[56:59], v[112:115]
s_cmp_lg_u32 s10, 0
s_cbranch_scc1 L2_gloop
ds_read_b64_tr_b16 a[92:93], v247 offset:16384
s_waitcnt vmcnt(25) lgkmcnt(11)
v_mfma_f32_16x16x32_bf16 v[56:59], a[64:67], a[0:3], v[56:59]
buffer_load_dwordx4 v240, s[52:55], s70 offen offset:2048  lds
v_mfma_f32_16x16x32_bf16 v[60:63], a[64:67], a[4:7], v[60:63]
ds_read_b64_tr_b16 a[94:95], v247 offset:18432
ds_read_b64_tr_b16 a[96:97], v244 offset:4096
v_mfma_f32_16x16x32_bf16 v[68:71], a[68:71], a[4:7], v[68:71]
ds_read_b64_tr_b16 a[98:99], v244 offset:6144
v_mfma_f32_16x16x32_bf16 v[64:67], a[68:71], a[0:3], v[64:67]
ds_read_b64_tr_b16 a[100:101], v245 offset:4096
s_waitcnt lgkmcnt(11)
v_mfma_f32_16x16x32_bf16 v[72:75], a[72:75], a[0:3], v[72:75]
buffer_load_dwordx4 v241, s[52:55], s71 offen offset:3072  lds
v_mfma_f32_16x16x32_bf16 v[76:79], a[72:75], a[4:7], v[76:79]
ds_read_b64_tr_b16 a[102:103], v245 offset:6144
ds_read_b64_tr_b16 a[104:105], v246 offset:4096
v_mfma_f32_16x16x32_bf16 v[84:87], a[76:79], a[4:7], v[84:87]
ds_read_b64_tr_b16 a[106:107], v246 offset:6144
s_add_u32 m0, s76, 4096
v_mfma_f32_16x16x32_bf16 v[80:83], a[76:79], a[0:3], v[80:83]
ds_read_b64_tr_b16 a[108:109], v247 offset:4096
s_waitcnt lgkmcnt(11)
v_mfma_f32_16x16x32_bf16 v[88:91], a[80:83], a[0:3], v[88:91]
buffer_load_dwordx4 a[56:59], v1, s[60:63], s78 offen offset:3072 sc1
v_mfma_f32_16x16x32_bf16 v[92:95], a[80:83], a[4:7], v[92:95]
ds_read_b64_tr_b16 a[110:111], v247 offset:6144
ds_read_b64_tr_b16 a[112:113], v244 offset:20480
v_mfma_f32_16x16x32_bf16 v[100:103], a[84:87], a[4:7], v[100:103]
ds_read_b64_tr_b16 a[114:115], v244 offset:22528
v_mfma_f32_16x16x32_bf16 v[96:99], a[84:87], a[0:3], v[96:99]
ds_read_b64_tr_b16 a[116:117], v245 offset:20480
s_waitcnt lgkmcnt(11)
v_mfma_f32_16x16x32_bf16 v[104:107], a[88:91], a[0:3], v[104:107]
buffer_load_dwordx4 a[60:63], v1, s[60:63], s79 offen offset:3072 sc1
v_mfma_f32_16x16x32_bf16 v[108:111], a[88:91], a[4:7], v[108:111]
ds_read_b64_tr_b16 a[118:119], v245 offset:22528
ds_read_b64_tr_b16 a[120:121], v246 offset:20480
v_mfma_f32_16x16x32_bf16 v[116:119], a[92:95], a[4:7], v[116:119]
ds_read_b64_tr_b16 a[122:123], v246 offset:22528
s_add_u32 s78, s78, 4096
v_mfma_f32_16x16x32_bf16 v[112:115], a[92:95], a[0:3], v[112:115]
ds_read_b64_tr_b16 a[124:125], v247 offset:20480
s_waitcnt vmcnt(25) lgkmcnt(11)
v_mfma_f32_16x16x32_bf16 v[56:59], a[96:99], a[8:11], v[56:59]
buffer_load_dwordx4 v240, s[52:55], s72 offen offset:0  lds
v_mfma_f32_16x16x32_bf16 v[60:63], a[96:99], a[12:15], v[60:63]
ds_read_b64_tr_b16 a[126:127], v247 offset:22528
ds_read_b64_tr_b16 a[64:65], v244 offset:8192
v_mfma_f32_16x16x32_bf16 v[68:71], a[100:103], a[12:15], v[68:71]
s_mov_b32 s14, s10
s_mov_b32 s10, 0x40000
s_waitcnt vmcnt(22)
L2_sc_c:
    v_cmp_eq_u32 vcc, s98, v16
    s_mov_b64 s[92:93], vcc
    v_cmp_eq_u32 vcc, s98, v17
    s_and_b64 s[92:93], s[92:93], vcc
    s_or_b64 s[92:93], s[92:93], s[88:89]
    s_cmp_eq_u64 s[92:93], -1
    s_cbranch_scc1 L2_sc_ok
    buffer_load_dwordx2 v[16:17], v54, s[64:67], s95 offen sc0 sc1
    s_waitcnt vmcnt(0)
    s_sub_u32 s10, s10, 1
    s_cbranch_scc0 L2_sc_c
L2_sc_ok:
v_mfma_f32_16x16x32_bf16 v[64:67], a[100:103], a[8:11], v[64:67]
ds_read_b64_tr_b16 a[66:67], v244 offset:10240
s_waitcnt lgkmcnt(10)
v_mfma_f32_16x16x32_bf16 v[72:75], a[104:107], a[8:11], v[72:75]
buffer_load_dwordx4 v241, s[52:55], s73 offen offset:1024  lds
v_mfma_f32_16x16x32_bf16 v[76:79], a[104:107], a[12:15], v[76:79]
ds_read_b64_tr_b16 a[68:69], v245 offset:8192
ds_read_b64_tr_b16 a[70:71], v245 offset:10240
v_mfma_f32_16x16x32_bf16 v[84:87], a[108:111], a[12:15], v[84:87]
ds_read_b64_tr_b16 a[72:73], v246 offset:8192
ds_read_b64_tr_b16 a[74:75], v246 offset:10240
v_mfma_f32_16x16x32_bf16 v[80:83], a[108:111], a[8:11], v[80:83]
s_add_u32 s79, s79, 4096
s_add_u32 s78, s78, s94
s_add_u32 s79, s79, s94
s_waitcnt lgkmcnt(10)
v_mfma_f32_16x16x32_bf16 v[88:91], a[112:115], a[8:11], v[88:91]
buffer_load_dwordx4 a[0:3], v1, s[60:63], s78 offen offset:0 sc1
v_mfma_f32_16x16x32_bf16 v[92:95], a[112:115], a[12:15], v[92:95]
ds_read_b64_tr_b16 a[76:77], v247 offset:8192
ds_read_b64_tr_b16 a[78:79], v247 offset:10240
v_mfma_f32_16x16x32_bf16 v[100:103], a[116:119], a[12:15], v[100:103]
ds_read_b64_tr_b16 a[80:81], v244 offset:24576
ds_read_b64_tr_b16 a[82:83], v244 offset:26624
v_mfma_f32_16x16x32_bf16 v[96:99], a[116:119], a[8:11], v[96:99]
ds_read_b64_tr_b16 a[84:85], v245 offset:24576
s_waitcnt lgkmcnt(11)
v_mfma_f32_16x16x32_bf16 v[104:107], a[120:123], a[8:11], v[104:107]
buffer_load_dwordx4 a[4:7], v1, s[60:63], s79 offen offset:0 sc1
v_mfma_f32_16x16x32_bf16 v[108:111], a[120:123], a[12:15], v[108:111]
ds_read_b64_tr_b16 a[86:87], v245 offset:26624
ds_read_b64_tr_b16 a[88:89], v246 offset:24576
v_mfma_f32_16x16x32_bf16 v[116:119], a[124:127], a[12:15], v[116:119]
ds_read_b64_tr_b16 a[90:91], v246 offset:26624
v_mfma_f32_16x16x32_bf16 v[112:115], a[124:127], a[8:11], v[112:115]
ds_read_b64_tr_b16 a[92:93], v247 offset:24576
s_waitcnt vmcnt(24) lgkmcnt(11)
v_mfma_f32_16x16x32_bf16 v[56:59], a[64:67], a[16:19], v[56:59]
buffer_load_dwordx4 v240, s[52:55], s74 offen offset:2048  lds
v_mfma_f32_16x16x32_bf16 v[60:63], a[64:67], a[20:23], v[60:63]
ds_read_b64_tr_b16 a[94:95], v247 offset:26624
ds_read_b64_tr_b16 a[96:97], v244 offset:12288
v_mfma_f32_16x16x32_bf16 v[68:71], a[68:71], a[20:23], v[68:71]
ds_read_b64_tr_b16 a[98:99], v244 offset:14336
v_mfma_f32_16x16x32_bf16 v[64:67], a[68:71], a[16:19], v[64:67]
ds_read_b64_tr_b16 a[100:101], v245 offset:12288
s_waitcnt lgkmcnt(11)
v_mfma_f32_16x16x32_bf16 v[72:75], a[72:75], a[16:19], v[72:75]
buffer_load_dwordx4 v241, s[52:55], s75 offen offset:3072  lds
v_mfma_f32_16x16x32_bf16 v[76:79], a[72:75], a[20:23], v[76:79]
ds_read_b64_tr_b16 a[102:103], v245 offset:14336
ds_read_b64_tr_b16 a[104:105], v246 offset:12288
v_mfma_f32_16x16x32_bf16 v[84:87], a[76:79], a[20:23], v[84:87]
ds_read_b64_tr_b16 a[106:107], v246 offset:14336
s_add_u32 m0, s76, 32768
v_mfma_f32_16x16x32_bf16 v[80:83], a[76:79], a[16:19], v[80:83]
ds_read_b64_tr_b16 a[108:109], v247 offset:12288
s_waitcnt lgkmcnt(11)
v_mfma_f32_16x16x32_bf16 v[88:91], a[80:83], a[16:19], v[88:91]
buffer_load_dwordx4 a[8:11], v1, s[60:63], s78 offen offset:1024 sc1
v_mfma_f32_16x16x32_bf16 v[92:95], a[80:83], a[20:23], v[92:95]
ds_read_b64_tr_b16 a[110:111], v247 offset:14336
ds_read_b64_tr_b16 a[112:113], v244 offset:28672
v_mfma_f32_16x16x32_bf16 v[100:103], a[84:87], a[20:23], v[100:103]
ds_read_b64_tr_b16 a[114:115], v244 offset:30720
v_mfma_f32_16x16x32_bf16 v[96:99], a[84:87], a[16:19], v[96:99]
ds_read_b64_tr_b16 a[116:117], v245 offset:28672
s_waitcnt lgkmcnt(11)
v_mfma_f32_16x16x32_bf16 v[104:107], a[88:91], a[16:19], v[104:107]
buffer_load_dwordx4 a[12:15], v1, s[60:63], s79 offen offset:1024 sc1
v_mfma_f32_16x16x32_bf16 v[108:111], a[88:91], a[20:23], v[108:111]
ds_read_b64_tr_b16 a[118:119], v245 offset:30720
s_waitcnt vmcnt(18)
s_barrier
v_mfma_f32_16x16x32_bf16 v[116:119], a[92:95], a[20:23], v[116:119]
ds_read_b64_tr_b16 a[120:121], v246 offset:28672
ds_read_b64_tr_b16 a[122:123], v246 offset:30720
v_mfma_f32_16x16x32_bf16 v[112:115], a[92:95], a[16:19], v[112:115]
s_add_u32 s52, s52, s77
s_addc_u32 s53, s53, 0
s_waitcnt vmcnt(24) lgkmcnt(10)
v_mfma_f32_16x16x32_bf16 v[56:59], a[96:99], a[24:27], v[56:59]
buffer_load_dwordx4 v240, s[52:55], s68 offen offset:0  lds
v_mfma_f32_16x16x32_bf16 v[60:63], a[96:99], a[28:31], v[60:63]
ds_read_b64_tr_b16 a[124:125], v247 offset:28672
ds_read_b64_tr_b16 a[126:127], v247 offset:30720
v_mfma_f32_16x16x32_bf16 v[68:71], a[100:103], a[28:31], v[68:71]
ds_read_b64_tr_b16 a[64:65], v244 offset:32768
ds_read_b64_tr_b16 a[66:67], v244 offset:34816
v_mfma_f32_16x16x32_bf16 v[64:67], a[100:103], a[24:27], v[64:67]
ds_read_b64_tr_b16 a[68:69], v245 offset:32768
s_waitcnt lgkmcnt(11)
v_mfma_f32_16x16x32_bf16 v[72:75], a[104:107], a[24:27], v[72:75]
buffer_load_dwordx4 v241, s[52:55], s69 offen offset:1024  lds
v_mfma_f32_16x16x32_bf16 v[76:79], a[104:107], a[28:31], v[76:79]
ds_read_b64_tr_b16 a[70:71], v245 offset:34816
ds_read_b64_tr_b16 a[72:73], v246 offset:32768
v_mfma_f32_16x16x32_bf16 v[84:87], a[108:111], a[28:31], v[84:87]
ds_read_b64_tr_b16 a[74:75], v246 offset:34816
v_mfma_f32_16x16x32_bf16 v[80:83], a[108:111], a[24:27], v[80:83]
ds_read_b64_tr_b16 a[76:77], v247 offset:32768
s_waitcnt lgkmcnt(11)
v_mfma_f32_16x16x32_bf16 v[88:91], a[112:115], a[24:27], v[88:91]
buffer_load_dwordx4 a[16:19], v1, s[60:63], s78 offen offset:2048 sc1
v_mfma_f32_16x16x32_bf16 v[92:95], a[112:115], a[28:31], v[92:95]
ds_read_b64_tr_b16 a[78:79], v247 offset:34816
ds_read_b64_tr_b16 a[80:81], v244 offset:49152
v_mfma_f32_16x16x32_bf16 v[100:103], a[116:119], a[28:31], v[100:103]
ds_read_b64_tr_b16 a[82:83], v244 offset:51200
v_mfma_f32_16x16x32_bf16 v[96:99], a[116:119], a[24:27], v[96:99]
ds_read_b64_tr_b16 a[84:85], v245 offset:49152
s_waitcnt lgkmcnt(11)
v_mfma_f32_16x16x32_bf16 v[104:107], a[120:123], a[24:27], v[104:107]
buffer_load_dwordx4 a[20:23], v1, s[60:63], s79 offen offset:2048 sc1
v_mfma_f32_16x16x32_bf16 v[108:111], a[120:123], a[28:31], v[108:111]
ds_read_b64_tr_b16 a[86:87], v245 offset:51200
ds_read_b64_tr_b16 a[88:89], v246 offset:49152
v_mfma_f32_16x16x32_bf16 v[116:119], a[124:127], a[28:31], v[116:119]
ds_read_b64_tr_b16 a[90:91], v246 offset:51200
v_mfma_f32_16x16x32_bf16 v[112:115], a[124:127], a[24:27], v[112:115]
ds_read_b64_tr_b16 a[92:93], v247 offset:49152
s_waitcnt vmcnt(24) lgkmcnt(11)
v_mfma_f32_16x16x32_bf16 v[56:59], a[64:67], a[32:35], v[56:59]
buffer_load_dwordx4 v240, s[52:55], s70 offen offset:2048  lds
v_mfma_f32_16x16x32_bf16 v[60:63], a[64:67], a[36:39], v[60:63]
ds_read_b64_tr_b16 a[94:95], v247 offset:51200
ds_read_b64_tr_b16 a[96:97], v244 offset:36864
v_mfma_f32_16x16x32_bf16 v[68:71], a[68:71], a[36:39], v[68:71]
ds_read_b64_tr_b16 a[98:99], v244 offset:38912
v_mfma_f32_16x16x32_bf16 v[64:67], a[68:71], a[32:35], v[64:67]
ds_read_b64_tr_b16 a[100:101], v245 offset:36864
s_waitcnt lgkmcnt(11)
v_mfma_f32_16x16x32_bf16 v[72:75], a[72:75], a[32:35], v[72:75]
buffer_load_dwordx4 v241, s[52:55], s71 offen offset:3072  lds
v_mfma_f32_16x16x32_bf16 v[76:79], a[72:75], a[36:39], v[76:79]
ds_read_b64_tr_b16 a[102:103], v245 offset:38912
ds_read_b64_tr_b16 a[104:105], v246 offset:36864
v_mfma_f32_16x16x32_bf16 v[84:87], a[76:79], a[36:39], v[84:87]
ds_read_b64_tr_b16 a[106:107], v246 offset:38912
s_add_u32 m0, s76, 36864
v_mfma_f32_16x16x32_bf16 v[80:83], a[76:79], a[32:35], v[80:83]
ds_read_b64_tr_b16 a[108:109], v247 offset:36864
s_waitcnt lgkmcnt(11)
v_mfma_f32_16x16x32_bf16 v[88:91], a[80:83], a[32:35], v[88:91]
buffer_load_dwordx4 a[24:27], v1, s[60:63], s78 offen offset:3072 sc1
v_mfma_f32_16x16x32_bf16 v[92:95], a[80:83], a[36:39], v[92:95]
ds_read_b64_tr_b16 a[110:111], v247 offset:38912
ds_read_b64_tr_b16 a[112:113], v244 offset:53248
v_mfma_f32_16x16x32_bf16 v[100:103], a[84:87], a[36:39], v[100:103]
ds_read_b64_tr_b16 a[114:115], v244 offset:55296
v_mfma_f32_16x16x32_bf16 v[96:99], a[84:87], a[32:35], v[96:99]
ds_read_b64_tr_b16 a[116:117], v245 offset:53248
s_waitcnt lgkmcnt(11)
v_mfma_f32_16x16x32_bf16 v[104:107], a[88:91], a[32:35], v[104:107]
buffer_load_dwordx4 a[28:31], v1, s[60:63], s79 offen offset:3072 sc1
v_mfma_f32_16x16x32_bf16 v[108:111], a[88:91], a[36:39], v[108:111]
ds_read_b64_tr_b16 a[118:119], v245 offset:55296
ds_read_b64_tr_b16 a[120:121], v246 offset:53248
v_mfma_f32_16x16x32_bf16 v[116:119], a[92:95], a[36:39], v[116:119]
ds_read_b64_tr_b16 a[122:123], v246 offset:55296
s_add_u32 s78, s78, 4096
v_mfma_f32_16x16x32_bf16 v[112:115], a[92:95], a[32:35], v[112:115]
ds_read_b64_tr_b16 a[124:125], v247 offset:53248
s_waitcnt vmcnt(24) lgkmcnt(11)
v_mfma_f32_16x16x32_bf16 v[56:59], a[96:99], a[40:43], v[56:59]
buffer_load_dwordx4 v240, s[52:55], s72 offen offset:0  lds
v_mfma_f32_16x16x32_bf16 v[60:63], a[96:99], a[44:47], v[60:63]
ds_read_b64_tr_b16 a[126:127], v247 offset:55296
ds_read_b64_tr_b16 a[64:65], v244 offset:40960
v_mfma_f32_16x16x32_bf16 v[68:71], a[100:103], a[44:47], v[68:71]
ds_read_b64_tr_b16 a[66:67], v244 offset:43008
s_add_u32 s79, s79, 4096
v_mfma_f32_16x16x32_bf16 v[64:67], a[100:103], a[40:43], v[64:67]
ds_read_b64_tr_b16 a[68:69], v245 offset:40960
s_waitcnt lgkmcnt(11)
v_mfma_f32_16x16x32_bf16 v[72:75], a[104:107], a[40:43], v[72:75]
buffer_load_dwordx4 v241, s[52:55], s73 offen offset:1024  lds
v_mfma_f32_16x16x32_bf16 v[76:79], a[104:107], a[44:47], v[76:79]
ds_read_b64_tr_b16 a[70:71], v245 offset:43008
ds_read_b64_tr_b16 a[72:73], v246 offset:40960
v_mfma_f32_16x16x32_bf16 v[84:87], a[108:111], a[44:47], v[84:87]
ds_read_b64_tr_b16 a[74:75], v246 offset:43008
v_mfma_f32_16x16x32_bf16 v[80:83], a[108:111], a[40:43], v[80:83]
ds_read_b64_tr_b16 a[76:77], v247 offset:40960
s_waitcnt lgkmcnt(11)
v_mfma_f32_16x16x32_bf16 v[88:91], a[112:115], a[40:43], v[88:91]
buffer_load_dwordx4 a[32:35], v1, s[60:63], s78 offen offset:0 sc1
v_mfma_f32_16x16x32_bf16 v[92:95], a[112:115], a[44:47], v[92:95]
ds_read_b64_tr_b16 a[78:79], v247 offset:43008
ds_read_b64_tr_b16 a[80:81], v244 offset:57344
v_mfma_f32_16x16x32_bf16 v[100:103], a[116:119], a[44:47], v[100:103]
ds_read_b64_tr_b16 a[82:83], v244 offset:59392
v_mfma_f32_16x16x32_bf16 v[96:99], a[116:119], a[40:43], v[96:99]
ds_read_b64_tr_b16 a[84:85], v245 offset:57344
s_waitcnt lgkmcnt(11)
v_mfma_f32_16x16x32_bf16 v[104:107], a[120:123], a[40:43], v[104:107]
buffer_load_dwordx4 a[36:39], v1, s[60:63], s79 offen offset:0 sc1
v_mfma_f32_16x16x32_bf16 v[108:111], a[120:123], a[44:47], v[108:111]
ds_read_b64_tr_b16 a[86:87], v245 offset:59392
ds_read_b64_tr_b16 a[88:89], v246 offset:57344
v_mfma_f32_16x16x32_bf16 v[116:119], a[124:127], a[44:47], v[116:119]
ds_read_b64_tr_b16 a[90:91], v246 offset:59392
v_mfma_f32_16x16x32_bf16 v[112:115], a[124:127], a[40:43], v[112:115]
ds_read_b64_tr_b16 a[92:93], v247 offset:57344
s_waitcnt vmcnt(24) lgkmcnt(11)
v_mfma_f32_16x16x32_bf16 v[56:59], a[64:67], a[48:51], v[56:59]
buffer_load_dwordx4 v240, s[52:55], s74 offen offset:2048  lds
v_mfma_f32_16x16x32_bf16 v[60:63], a[64:67], a[52:55], v[60:63]
ds_read_b64_tr_b16 a[94:95], v247 offset:59392
ds_read_b64_tr_b16 a[96:97], v244 offset:45056
v_mfma_f32_16x16x32_bf16 v[68:71], a[68:71], a[52:55], v[68:71]
ds_read_b64_tr_b16 a[98:99], v244 offset:47104
v_mfma_f32_16x16x32_bf16 v[64:67], a[68:71], a[48:51], v[64:67]
ds_read_b64_tr_b16 a[100:101], v245 offset:45056
s_waitcnt lgkmcnt(11)
v_mfma_f32_16x16x32_bf16 v[72:75], a[72:75], a[48:51], v[72:75]
buffer_load_dwordx4 v241, s[52:55], s75 offen offset:3072  lds
v_mfma_f32_16x16x32_bf16 v[76:79], a[72:75], a[52:55], v[76:79]
ds_read_b64_tr_b16 a[102:103], v245 offset:47104
ds_read_b64_tr_b16 a[104:105], v246 offset:45056
v_mfma_f32_16x16x32_bf16 v[84:87], a[76:79], a[52:55], v[84:87]
ds_read_b64_tr_b16 a[106:107], v246 offset:47104
s_xor_b32 s76, s76, 65536
v_mfma_f32_16x16x32_bf16 v[80:83], a[76:79], a[48:51], v[80:83]
ds_read_b64_tr_b16 a[108:109], v247 offset:45056
s_waitcnt lgkmcnt(11)
v_mfma_f32_16x16x32_bf16 v[88:91], a[80:83], a[48:51], v[88:91]
buffer_load_dwordx4 a[40:43], v1, s[60:63], s78 offen offset:1024 sc1
v_mfma_f32_16x16x32_bf16 v[92:95], a[80:83], a[52:55], v[92:95]
ds_read_b64_tr_b16 a[110:111], v247 offset:47104
ds_read_b64_tr_b16 a[112:113], v244 offset:61440
v_mfma_f32_16x16x32_bf16 v[100:103], a[84:87], a[52:55], v[100:103]
ds_read_b64_tr_b16 a[114:115], v244 offset:63488
s_add_u32 m0, s76, 0
v_mfma_f32_16x16x32_bf16 v[96:99], a[84:87], a[48:51], v[96:99]
ds_read_b64_tr_b16 a[116:117], v245 offset:61440
s_waitcnt lgkmcnt(11)
v_mfma_f32_16x16x32_bf16 v[104:107], a[88:91], a[48:51], v[104:107]
buffer_load_dwordx4 a[44:47], v1, s[60:63], s79 offen offset:1024 sc1
v_mfma_f32_16x16x32_bf16 v[108:111], a[88:91], a[52:55], v[108:111]
ds_read_b64_tr_b16 a[118:119], v245 offset:63488
s_waitcnt vmcnt(18)
s_barrier
v_mfma_f32_16x16x32_bf16 v[116:119], a[92:95], a[52:55], v[116:119]
ds_read_b64_tr_b16 a[120:121], v246 offset:61440
ds_read_b64_tr_b16 a[122:123], v246 offset:63488
v_mfma_f32_16x16x32_bf16 v[112:115], a[92:95], a[48:51], v[112:115]
s_add_u32 s52, s52, s77
s_addc_u32 s53, s53, 0
s_waitcnt vmcnt(24) lgkmcnt(10)
v_mfma_f32_16x16x32_bf16 v[56:59], a[96:99], a[56:59], v[56:59]
buffer_load_dwordx4 v240, s[52:55], s68 offen offset:0  lds
v_mfma_f32_16x16x32_bf16 v[60:63], a[96:99], a[60:63], v[60:63]
ds_read_b64_tr_b16 a[124:125], v247 offset:61440
ds_read_b64_tr_b16 a[126:127], v247 offset:63488
v_mfma_f32_16x16x32_bf16 v[68:71], a[100:103], a[60:63], v[68:71]
v_xor_b32 v248, 65536, v248
v_xor_b32 v249, 65536, v249
v_xor_b32 v250, 65536, v250
v_xor_b32 v251, 65536, v251
v_mfma_f32_16x16x32_bf16 v[64:67], a[100:103], a[56:59], v[64:67]
ds_read_b128 a[64:67], v248 offset:0
s_waitcnt lgkmcnt(9)
v_mfma_f32_16x16x32_bf16 v[72:75], a[104:107], a[56:59], v[72:75]
buffer_load_dwordx4 v241, s[52:55], s69 offen offset:1024  lds
v_mfma_f32_16x16x32_bf16 v[76:79], a[104:107], a[60:63], v[76:79]
ds_read_b128 a[68:71], v248 offset:2048
ds_read_b128 a[72:75], v248 offset:4096
v_mfma_f32_16x16x32_bf16 v[84:87], a[108:111], a[60:63], v[84:87]
v_mfma_f32_16x16x32_bf16 v[80:83], a[108:111], a[56:59], v[80:83]
ds_read_b128 a[76:79], v248 offset:6144
s_waitcnt lgkmcnt(8)
v_mfma_f32_16x16x32_bf16 v[88:91], a[112:115], a[56:59], v[88:91]
buffer_load_dwordx4 a[48:51], v1, s[60:63], s78 offen offset:2048 sc1
v_mfma_f32_16x16x32_bf16 v[92:95], a[112:115], a[60:63], v[92:95]
ds_read_b128 a[80:83], v248 offset:8192
v_mfma_f32_16x16x32_bf16 v[100:103], a[116:119], a[60:63], v[100:103]
v_mfma_f32_16x16x32_bf16 v[96:99], a[116:119], a[56:59], v[96:99]
ds_read_b128 a[84:87], v248 offset:10240
s_waitcnt lgkmcnt(6)
v_mfma_f32_16x16x32_bf16 v[104:107], a[120:123], a[56:59], v[104:107]
buffer_load_dwordx4 a[52:55], v1, s[60:63], s79 offen offset:2048 sc1
v_mfma_f32_16x16x32_bf16 v[108:111], a[120:123], a[60:63], v[108:111]
ds_read_b128 a[88:91], v248 offset:12288
v_mfma_f32_16x16x32_bf16 v[116:119], a[124:127], a[60:63], v[116:119]
v_mfma_f32_16x16x32_bf16 v[112:115], a[124:127], a[56:59], v[112:115]
ds_read_b128 a[92:95], v248 offset:14336
s_waitcnt vmcnt(24) lgkmcnt(6)
v_mfma_f32_16x16x32_bf16 v[120:123], a[64:67], a[0:3], 0
buffer_load_dwordx4 v240, s[52:55], s70 offen offset:2048  lds
v_mfma_f32_16x16x32_bf16 v[124:127], a[64:67], a[4:7], 0
ds_read_b128 a[96:99], v249 offset:0
v_lshrrev_b32 v236, 4, v1
v_mfma_f32_16x16x32_bf16 v[132:135], a[68:71], a[4:7], 0
v_and_b32 v237, 15, v236
v_lshrrev_b32 v238, 4, v236
v_mfma_f32_16x16x32_bf16 v[128:131], a[68:71], a[0:3], 0
ds_read_b128 a[100:103], v249 offset:2048
s_waitcnt lgkmcnt(6)
v_mfma_f32_16x16x32_bf16 v[136:139], a[72:75], a[0:3], 0
buffer_load_dwordx4 v241, s[52:55], s71 offen offset:3072  lds
v_mfma_f32_16x16x32_bf16 v[140:143], a[72:75], a[4:7], 0
ds_read_b128 a[104:107], v249 offset:4096
s_add_u32 m0, s76, 4096
v_mfma_f32_16x16x32_bf16 v[148:151], a[76:79], a[4:7], 0
v_and_b32 v232, 7, v237
v_xor_b32 v232, v232, v238
v_mfma_f32_16x16x32_bf16 v[144:147], a[76:79], a[0:3], 0
ds_read_b128 a[108:111], v249 offset:6144
s_waitcnt lgkmcnt(6)
v_mfma_f32_16x16x32_bf16 v[152:155], a[80:83], a[0:3], 0
buffer_load_dwordx4 a[56:59], v1, s[60:63], s78 offen offset:3072 sc1
v_mfma_f32_16x16x32_bf16 v[156:159], a[80:83], a[4:7], 0
ds_read_b128 a[112:115], v249 offset:8192
v_lshlrev_b32 v232, 4, v232
v_mfma_f32_16x16x32_bf16 v[164:167], a[84:87], a[4:7], 0
v_lshl_add_u32 v232, v237, 8, v232
s_lshl_b32 s92, s3, 13
v_mfma_f32_16x16x32_bf16 v[160:163], a[84:87], a[0:3], 0
ds_read_b128 a[116:119], v249 offset:10240
s_waitcnt lgkmcnt(6)
v_mfma_f32_16x16x32_bf16 v[168:171], a[88:91], a[0:3], 0
buffer_load_dwordx4 a[60:63], v1, s[60:63], s79 offen offset:3072 sc1
v_mfma_f32_16x16x32_bf16 v[172:175], a[88:91], a[4:7], 0
ds_read_b128 a[120:123], v249 offset:12288
s_add_u32 s78, s78, 4096
v_mfma_f32_16x16x32_bf16 v[180:183], a[92:95], a[4:7], 0
s_add_u32 s79, s79, 4096
s_add_u32 s92, s92, 131072
v_mfma_f32_16x16x32_bf16 v[176:179], a[92:95], a[0:3], 0
ds_read_b128 a[124:127], v249 offset:14336
s_waitcnt vmcnt(24) lgkmcnt(6)
v_mfma_f32_16x16x32_bf16 v[120:123], a[96:99], a[8:11], v[120:123]
buffer_load_dwordx4 v240, s[52:55], s72 offen offset:0  lds
v_mfma_f32_16x16x32_bf16 v[124:127], a[96:99], a[12:15], v[124:127]
ds_read_b128 a[64:67], v250 offset:0
v_add_u32 v232, s92, v232
v_mfma_f32_16x16x32_bf16 v[132:135], a[100:103], a[12:15], v[132:135]
v_xor_b32 v234, v237, v238
v_lshlrev_b32 v234, 4, v234
v_mfma_f32_16x16x32_bf16 v[128:131], a[100:103], a[8:11], v[128:131]
ds_read_b128 a[68:71], v250 offset:2048
s_waitcnt lgkmcnt(6)
v_mfma_f32_16x16x32_bf16 v[136:139], a[104:107], a[8:11], v[136:139]
buffer_load_dwordx4 v241, s[52:55], s73 offen offset:1024  lds
v_mfma_f32_16x16x32_bf16 v[140:143], a[104:107], a[12:15], v[140:143]
ds_read_b128 a[72:75], v250 offset:4096
v_lshl_add_u32 v234, v238, 8, v234
v_mfma_f32_16x16x32_bf16 v[148:151], a[108:111], a[12:15], v[148:151]
v_add_u32 v234, s92, v234
v_xor_b32 v235, 64, v234
v_mfma_f32_16x16x32_bf16 v[144:147], a[108:111], a[8:11], v[144:147]
ds_read_b128 a[76:79], v250 offset:6144
s_waitcnt lgkmcnt(6)
v_mfma_f32_16x16x32_bf16 v[152:155], a[112:115], a[8:11], v[152:155]
buffer_load_dwordx4 a[0:3], v1, s[60:63], s78 offen offset:0 sc1
v_mfma_f32_16x16x32_bf16 v[156:159], a[112:115], a[12:15], v[156:159]
ds_read_b128 a[80:83], v250 offset:8192
v_lshlrev_b32 v233, 12, v238
v_mfma_f32_16x16x32_bf16 v[164:167], a[116:119], a[12:15], v[164:167]
v_lshl_add_u32 v233, v237, 4, v233
v_bfe_u32 v22, v1, 4, 4
v_mfma_f32_16x16x32_bf16 v[160:163], a[116:119], a[8:11], v[160:163]
ds_read_b128 a[84:87], v250 offset:10240
s_waitcnt lgkmcnt(6)
v_mfma_f32_16x16x32_bf16 v[168:171], a[120:123], a[8:11], v[168:171]
buffer_load_dwordx4 a[4:7], v1, s[60:63], s79 offen offset:0 sc1
v_mfma_f32_16x16x32_bf16 v[172:175], a[120:123], a[12:15], v[172:175]
ds_read_b128 a[88:91], v250 offset:12288
v_lshrrev_b32 v23, 8, v1
v_mfma_f32_16x16x32_bf16 v[180:183], a[124:127], a[12:15], v[180:183]
v_and_b32 v30, 1, v22
v_lshlrev_b32 v30, 4, v30
v_mfma_f32_16x16x32_bf16 v[176:179], a[124:127], a[8:11], v[176:179]
ds_read_b128 a[92:95], v250 offset:14336
s_waitcnt vmcnt(24) lgkmcnt(6)
v_mfma_f32_16x16x32_bf16 v[120:123], a[64:67], a[16:19], v[120:123]
buffer_load_dwordx4 v240, s[52:55], s74 offen offset:2048  lds
v_mfma_f32_16x16x32_bf16 v[124:127], a[64:67], a[20:23], v[124:127]
ds_read_b128 a[96:99], v251 offset:0
v_lshrrev_b32 v31, 3, v22
v_mfma_f32_16x16x32_bf16 v[132:135], a[68:71], a[20:23], v[132:135]
v_sub_u32 v31, v23, v31
v_bfe_u32 v32, v22, 1, 2
v_mfma_f32_16x16x32_bf16 v[128:131], a[68:71], a[16:19], v[128:131]
ds_read_b128 a[100:103], v251 offset:2048
s_waitcnt lgkmcnt(6)
v_mfma_f32_16x16x32_bf16 v[136:139], a[72:75], a[16:19], v[136:139]
buffer_load_dwordx4 v241, s[52:55], s75 offen offset:3072  lds
v_mfma_f32_16x16x32_bf16 v[140:143], a[72:75], a[20:23], v[140:143]
ds_read_b128 a[104:107], v251 offset:4096
s_add_u32 m0, s76, 32768
v_mfma_f32_16x16x32_bf16 v[148:151], a[76:79], a[20:23], v[148:151]
v_lshl_add_u32 v31, v31, 2, v32
v_lshlrev_b32 v36, 16, v36
v_mfma_f32_16x16x32_bf16 v[144:147], a[76:79], a[16:19], v[144:147]
ds_read_b128 a[108:111], v251 offset:6144
s_waitcnt lgkmcnt(6)
v_mfma_f32_16x16x32_bf16 v[152:155], a[80:83], a[16:19], v[152:155]
buffer_load_dwordx4 a[8:11], v1, s[60:63], s78 offen offset:1024 sc1
v_mfma_f32_16x16x32_bf16 v[156:159], a[80:83], a[20:23], v[156:159]
ds_read_b128 a[112:115], v251 offset:8192
v_mul_f32 v36, 0.5, v36
v_mfma_f32_16x16x32_bf16 v[164:167], a[84:87], a[20:23], v[164:167]
v_lshrrev_b32 v36, 16, v36
v_lshlrev_b32 v36, v30, v36
v_mfma_f32_16x16x32_bf16 v[160:163], a[84:87], a[16:19], v[160:163]
ds_read_b128 a[116:119], v251 offset:10240
s_waitcnt lgkmcnt(6)
v_mfma_f32_16x16x32_bf16 v[168:171], a[88:91], a[16:19], v[168:171]
buffer_load_dwordx4 a[12:15], v1, s[60:63], s79 offen offset:1024 sc1
v_mfma_f32_16x16x32_bf16 v[172:175], a[88:91], a[20:23], v[172:175]
s_waitcnt vmcnt(18)
s_barrier
v_mfma_f32_16x16x32_bf16 v[180:183], a[92:95], a[20:23], v[180:183]
ds_read_b128 a[120:123], v251 offset:12288
v_lshlrev_b32 v37, 16, v37
v_mfma_f32_16x16x32_bf16 v[176:179], a[92:95], a[16:19], v[176:179]
s_add_u32 s52, s52, s77
s_addc_u32 s53, s53, 0
s_waitcnt vmcnt(24) lgkmcnt(5)
v_mfma_f32_16x16x32_bf16 v[120:123], a[96:99], a[24:27], v[120:123]
buffer_load_dwordx4 v240, s[52:55], s68 offen offset:0  lds
v_mfma_f32_16x16x32_bf16 v[124:127], a[96:99], a[28:31], v[124:127]
ds_read_b128 a[124:127], v251 offset:14336
ds_read_b128 a[64:67], v248 offset:32768
v_mfma_f32_16x16x32_bf16 v[132:135], a[100:103], a[28:31], v[132:135]
v_mul_f32 v37, 0.5, v37
v_lshrrev_b32 v37, 16, v37
v_mfma_f32_16x16x32_bf16 v[128:131], a[100:103], a[24:27], v[128:131]
ds_read_b128 a[68:71], v248 offset:34816
s_waitcnt lgkmcnt(6)
v_mfma_f32_16x16x32_bf16 v[136:139], a[104:107], a[24:27], v[136:139]
buffer_load_dwordx4 v241, s[52:55], s69 offen offset:1024  lds
v_mfma_f32_16x16x32_bf16 v[140:143], a[104:107], a[28:31], v[140:143]
ds_read_b128 a[72:75], v248 offset:36864
v_lshlrev_b32 v37, v30, v37
v_mfma_f32_16x16x32_bf16 v[148:151], a[108:111], a[28:31], v[148:151]
v_lshlrev_b32 v38, 16, v38
v_mul_f32 v38, 0.5, v38
v_mfma_f32_16x16x32_bf16 v[144:147], a[108:111], a[24:27], v[144:147]
ds_read_b128 a[76:79], v248 offset:38912
s_waitcnt lgkmcnt(6)
v_mfma_f32_16x16x32_bf16 v[152:155], a[112:115], a[24:27], v[152:155]
buffer_load_dwordx4 a[16:19], v1, s[60:63], s78 offen offset:2048 sc1
v_mfma_f32_16x16x32_bf16 v[156:159], a[112:115], a[28:31], v[156:159]
ds_read_b128 a[80:83], v248 offset:40960
v_lshrrev_b32 v38, 16, v38
v_mfma_f32_16x16x32_bf16 v[164:167], a[116:119], a[28:31], v[164:167]
buffer_load_dwordx2 v[46:47], v21, s[56:59], s86 offen sc0 sc1
v_mfma_f32_16x16x32_bf16 v[160:163], a[116:119], a[24:27], v[160:163]
ds_read_b128 a[84:87], v248 offset:43008
s_waitcnt lgkmcnt(6)
v_mfma_f32_16x16x32_bf16 v[168:171], a[120:123], a[24:27], v[168:171]
buffer_load_dwordx4 a[20:23], v1, s[60:63], s79 offen offset:2048 sc1
v_mfma_f32_16x16x32_bf16 v[172:175], a[120:123], a[28:31], v[172:175]
ds_read_b128 a[88:91], v248 offset:45056
v_lshlrev_b32 v38, v30, v38
v_mfma_f32_16x16x32_bf16 v[180:183], a[124:127], a[28:31], v[180:183]
v_mfma_f32_16x16x32_bf16 v[176:179], a[124:127], a[24:27], v[176:179]
ds_read_b128 a[92:95], v248 offset:47104
s_waitcnt vmcnt(25) lgkmcnt(6)
v_mfma_f32_16x16x32_bf16 v[120:123], a[64:67], a[32:35], v[120:123]
buffer_load_dwordx4 v240, s[52:55], s70 offen offset:2048  lds
v_mfma_f32_16x16x32_bf16 v[124:127], a[64:67], a[36:39], v[124:127]
ds_read_b128 a[96:99], v249 offset:32768
v_lshlrev_b32 v39, 16, v39
v_mfma_f32_16x16x32_bf16 v[132:135], a[68:71], a[36:39], v[132:135]
v_mul_f32 v39, 0.5, v39
v_lshrrev_b32 v39, 16, v39
v_mfma_f32_16x16x32_bf16 v[128:131], a[68:71], a[32:35], v[128:131]
ds_read_b128 a[100:103], v249 offset:34816
s_waitcnt lgkmcnt(6)
v_mfma_f32_16x16x32_bf16 v[136:139], a[72:75], a[32:35], v[136:139]
buffer_load_dwordx4 v241, s[52:55], s71 offen offset:3072  lds
v_mfma_f32_16x16x32_bf16 v[140:143], a[72:75], a[36:39], v[140:143]
ds_read_b128 a[104:107], v249 offset:36864
s_add_u32 m0, s76, 36864
v_mfma_f32_16x16x32_bf16 v[148:151], a[76:79], a[36:39], v[148:151]
v_lshlrev_b32 v39, v30, v39
v_cmp_eq_u32 vcc, 0, v31
v_mfma_f32_16x16x32_bf16 v[144:147], a[76:79], a[32:35], v[144:147]
ds_read_b128 a[108:111], v249 offset:38912
s_waitcnt lgkmcnt(6)
v_mfma_f32_16x16x32_bf16 v[152:155], a[80:83], a[32:35], v[152:155]
buffer_load_dwordx4 a[24:27], v1, s[60:63], s78 offen offset:3072 sc1
v_mfma_f32_16x16x32_bf16 v[156:159], a[80:83], a[36:39], v[156:159]
ds_read_b128 a[112:115], v249 offset:40960
s_nop 1
v_mfma_f32_16x16x32_bf16 v[164:167], a[84:87], a[36:39], v[164:167]
v_cndmask_b32 v216, 0, v36, vcc
v_cndmask_b32 v224, 0, v38, vcc
v_mfma_f32_16x16x32_bf16 v[160:163], a[84:87], a[32:35], v[160:163]
ds_read_b128 a[116:119], v249 offset:43008
s_waitcnt lgkmcnt(6)
v_mfma_f32_16x16x32_bf16 v[168:171], a[88:91], a[32:35], v[168:171]
buffer_load_dwordx4 a[28:31], v1, s[60:63], s79 offen offset:3072 sc1
v_mfma_f32_16x16x32_bf16 v[172:175], a[88:91], a[36:39], v[172:175]
ds_read_b128 a[120:123], v249 offset:45056
s_add_u32 s78, s78, 4096
v_mfma_f32_16x16x32_bf16 v[180:183], a[92:95], a[36:39], v[180:183]
s_add_u32 s79, s79, 4096
v_cmp_eq_u32 vcc, 1, v31
v_mfma_f32_16x16x32_bf16 v[176:179], a[92:95], a[32:35], v[176:179]
ds_read_b128 a[124:127], v249 offset:47104
s_waitcnt vmcnt(25) lgkmcnt(6)
v_mfma_f32_16x16x32_bf16 v[120:123], a[96:99], a[40:43], v[120:123]
buffer_load_dwordx4 v240, s[52:55], s72 offen offset:0  lds
v_mfma_f32_16x16x32_bf16 v[124:127], a[96:99], a[44:47], v[124:127]
ds_read_b128 a[64:67], v250 offset:32768
s_nop 1
v_mfma_f32_16x16x32_bf16 v[132:135], a[100:103], a[44:47], v[132:135]
v_cndmask_b32 v217, 0, v36, vcc
v_cndmask_b32 v225, 0, v38, vcc
v_mfma_f32_16x16x32_bf16 v[128:131], a[100:103], a[40:43], v[128:131]
ds_read_b128 a[68:71], v250 offset:34816
s_waitcnt lgkmcnt(6)
v_mfma_f32_16x16x32_bf16 v[136:139], a[104:107], a[40:43], v[136:139]
buffer_load_dwordx4 v241, s[52:55], s73 offen offset:1024  lds
v_mfma_f32_16x16x32_bf16 v[140:143], a[104:107], a[44:47], v[140:143]
ds_read_b128 a[72:75], v250 offset:36864
v_cmp_eq_u32 vcc, 2, v31
v_mfma_f32_16x16x32_bf16 v[148:151], a[108:111], a[44:47], v[148:151]
s_nop 1
v_cndmask_b32 v218, 0, v36, vcc
v_mfma_f32_16x16x32_bf16 v[144:147], a[108:111], a[40:43], v[144:147]
ds_read_b128 a[76:79], v250 offset:38912
s_waitcnt lgkmcnt(6)
v_mfma_f32_16x16x32_bf16 v[152:155], a[112:115], a[40:43], v[152:155]
buffer_load_dwordx4 a[32:35], v1, s[60:63], s78 offen offset:0 sc1
v_mfma_f32_16x16x32_bf16 v[156:159], a[112:115], a[44:47], v[156:159]
ds_read_b128 a[80:83], v250 offset:40960
v_cndmask_b32 v226, 0, v38, vcc
v_mfma_f32_16x16x32_bf16 v[164:167], a[116:119], a[44:47], v[164:167]
v_cmp_eq_u32 vcc, 3, v31
s_nop 1
v_mfma_f32_16x16x32_bf16 v[160:163], a[116:119], a[40:43], v[160:163]
ds_read_b128 a[84:87], v250 offset:43008
s_waitcnt lgkmcnt(6)
v_mfma_f32_16x16x32_bf16 v[168:171], a[120:123], a[40:43], v[168:171]
buffer_load_dwordx4 a[36:39], v1, s[60:63], s79 offen offset:0 sc1
v_mfma_f32_16x16x32_bf16 v[172:175], a[120:123], a[44:47], v[172:175]
ds_read_b128 a[88:91], v250 offset:45056
v_cndmask_b32 v219, 0, v36, vcc
v_mfma_f32_16x16x32_bf16 v[180:183], a[124:127], a[44:47], v[180:183]
v_cndmask_b32 v227, 0, v38, vcc
v_cmp_eq_u32 vcc, 8, v31
v_mfma_f32_16x16x32_bf16 v[176:179], a[124:127], a[40:43], v[176:179]
ds_read_b128 a[92:95], v250 offset:47104
s_waitcnt vmcnt(25) lgkmcnt(6)
v_mfma_f32_16x16x32_bf16 v[120:123], a[64:67], a[48:51], v[120:123]
buffer_load_dwordx4 v240, s[52:55], s74 offen offset:2048  lds
v_mfma_f32_16x16x32_bf16 v[124:127], a[64:67], a[52:55], v[124:127]
ds_read_b128 a[96:99], v251 offset:32768
s_nop 1
v_mfma_f32_16x16x32_bf16 v[132:135], a[68:71], a[52:55], v[132:135]
v_cndmask_b32 v220, 0, v37, vcc
v_cndmask_b32 v228, 0, v39, vcc
v_mfma_f32_16x16x32_bf16 v[128:131], a[68:71], a[48:51], v[128:131]
ds_read_b128 a[100:103], v251 offset:34816
s_waitcnt lgkmcnt(6)
v_mfma_f32_16x16x32_bf16 v[136:139], a[72:75], a[48:51], v[136:139]
buffer_load_dwordx4 v241, s[52:55], s75 offen offset:3072  lds
v_mfma_f32_16x16x32_bf16 v[140:143], a[72:75], a[52:55], v[140:143]
ds_read_b128 a[104:107], v251 offset:36864
s_xor_b32 s76, s76, 65536
v_mfma_f32_16x16x32_bf16 v[148:151], a[76:79], a[52:55], v[148:151]
s_add_u32 m0, s76, 0
v_cmp_eq_u32 vcc, 9, v31
v_mfma_f32_16x16x32_bf16 v[144:147], a[76:79], a[48:51], v[144:147]
ds_read_b128 a[108:111], v251 offset:38912
s_waitcnt lgkmcnt(6)
v_mfma_f32_16x16x32_bf16 v[152:155], a[80:83], a[48:51], v[152:155]
buffer_load_dwordx4 a[40:43], v1, s[60:63], s78 offen offset:1024 sc1
v_mfma_f32_16x16x32_bf16 v[156:159], a[80:83], a[52:55], v[156:159]
ds_read_b128 a[112:115], v251 offset:40960
s_nop 1
v_mfma_f32_16x16x32_bf16 v[164:167], a[84:87], a[52:55], v[164:167]
v_cndmask_b32 v221, 0, v37, vcc
v_cndmask_b32 v229, 0, v39, vcc
v_mfma_f32_16x16x32_bf16 v[160:163], a[84:87], a[48:51], v[160:163]
ds_read_b128 a[116:119], v251 offset:43008
s_waitcnt lgkmcnt(6)
v_mfma_f32_16x16x32_bf16 v[168:171], a[88:91], a[48:51], v[168:171]
buffer_load_dwordx4 a[44:47], v1, s[60:63], s79 offen offset:1024 sc1
v_mfma_f32_16x16x32_bf16 v[172:175], a[88:91], a[52:55], v[172:175]
s_waitcnt vmcnt(19)
s_barrier
v_mfma_f32_16x16x32_bf16 v[180:183], a[92:95], a[52:55], v[180:183]
ds_read_b128 a[120:123], v251 offset:45056
v_cmp_eq_u32 vcc, 10, v31
v_mfma_f32_16x16x32_bf16 v[176:179], a[92:95], a[48:51], v[176:179]
s_add_u32 s52, s52, s77
s_addc_u32 s53, s53, 0
s_waitcnt vmcnt(25) lgkmcnt(5)
v_mfma_f32_16x16x32_bf16 v[120:123], a[96:99], a[56:59], v[120:123]
buffer_load_dwordx4 v240, s[52:55], s68 offen offset:0  lds
v_mfma_f32_16x16x32_bf16 v[124:127], a[96:99], a[60:63], v[124:127]
ds_read_b128 a[124:127], v251 offset:47104
v_xor_b32 v248, 65536, v248
v_mfma_f32_16x16x32_bf16 v[132:135], a[100:103], a[60:63], v[132:135]
v_xor_b32 v249, 65536, v249
v_xor_b32 v250, 65536, v250
v_xor_b32 v251, 65536, v251
v_mfma_f32_16x16x32_bf16 v[128:131], a[100:103], a[56:59], v[128:131]
ds_read_b128 a[64:67], v248 offset:0
s_waitcnt lgkmcnt(5)
v_mfma_f32_16x16x32_bf16 v[136:139], a[104:107], a[56:59], v[136:139]
buffer_load_dwordx4 v241, s[52:55], s69 offen offset:1024  lds
v_mfma_f32_16x16x32_bf16 v[140:143], a[104:107], a[60:63], v[140:143]
ds_read_b128 a[68:71], v248 offset:2048
ds_read_b128 a[72:75], v248 offset:4096
v_mfma_f32_16x16x32_bf16 v[148:151], a[108:111], a[60:63], v[148:151]
s_nop 1
v_cndmask_b32 v222, 0, v37, vcc
v_mfma_f32_16x16x32_bf16 v[144:147], a[108:111], a[56:59], v[144:147]
ds_read_b128 a[76:79], v248 offset:6144
s_waitcnt lgkmcnt(6)
v_mfma_f32_16x16x32_bf16 v[152:155], a[112:115], a[56:59], v[152:155]
buffer_load_dwordx4 a[48:51], v1, s[60:63], s78 offen offset:2048 sc1
v_mfma_f32_16x16x32_bf16 v[156:159], a[112:115], a[60:63], v[156:159]
ds_read_b128 a[80:83], v248 offset:8192
v_cndmask_b32 v230, 0, v39, vcc
v_mfma_f32_16x16x32_bf16 v[164:167], a[116:119], a[60:63], v[164:167]
v_cmp_eq_u32 vcc, 11, v31
s_nop 1
v_mfma_f32_16x16x32_bf16 v[160:163], a[116:119], a[56:59], v[160:163]
ds_read_b128 a[84:87], v248 offset:10240
s_waitcnt lgkmcnt(6)
v_mfma_f32_16x16x32_bf16 v[168:171], a[120:123], a[56:59], v[168:171]
buffer_load_dwordx4 a[52:55], v1, s[60:63], s79 offen offset:2048 sc1
v_mfma_f32_16x16x32_bf16 v[172:175], a[120:123], a[60:63], v[172:175]
ds_read_b128 a[88:91], v248 offset:12288
v_cndmask_b32 v223, 0, v37, vcc
v_mfma_f32_16x16x32_bf16 v[180:183], a[124:127], a[60:63], v[180:183]
v_cndmask_b32 v231, 0, v39, vcc
v_mfma_f32_16x16x32_bf16 v[176:179], a[124:127], a[56:59], v[176:179]
s_mov_b32 s10, 2
.p2align 3
L2_sloop:
ds_read_b128 a[92:95], v248 offset:14336
s_waitcnt vmcnt(24) lgkmcnt(6)
v_mfma_f32_16x16x32_bf16 v[120:123], a[64:67], a[0:3], v[120:123]
buffer_load_dwordx4 v240, s[52:55], s70 offen offset:2048  lds
v_mfma_f32_16x16x32_bf16 v[124:127], a[64:67], a[4:7], v[124:127]
ds_read_b128 a[96:99], v249 offset:0
s_sub_u32 s10, s10, 1
v_mfma_f32_16x16x32_bf16 v[132:135], a[68:71], a[4:7], v[132:135]
v_mfma_f32_16x16x32_bf16 v[128:131], a[68:71], a[0:3], v[128:131]
ds_read_b128 a[100:103], v249 offset:2048
s_waitcnt lgkmcnt(6)
v_mfma_f32_16x16x32_bf16 v[136:139], a[72:75], a[0:3], v[136:139]
buffer_load_dwordx4 v241, s[52:55], s71 offen offset:3072  lds
v_mfma_f32_16x16x32_bf16 v[140:143], a[72:75], a[4:7], v[140:143]
ds_read_b128 a[104:107], v249 offset:4096
s_add_u32 m0, s76, 4096
v_mfma_f32_16x16x32_bf16 v[148:151], a[76:79], a[4:7], v[148:151]
v_mfma_f32_16x16x32_bf16 v[144:147], a[76:79], a[0:3], v[144:147]
ds_read_b128 a[108:111], v249 offset:6144
s_waitcnt lgkmcnt(6)
v_mfma_f32_16x16x32_bf16 v[152:155], a[80:83], a[0:3], v[152:155]
buffer_load_dwordx4 a[56:59], v1, s[60:63], s78 offen offset:3072 sc1
v_mfma_f32_16x16x32_bf16 v[156:159], a[80:83], a[4:7], v[156:159]
ds_read_b128 a[112:115], v249 offset:8192
v_mfma_f32_16x16x32_bf16 v[164:167], a[84:87], a[4:7], v[164:167]
v_mfma_f32_16x16x32_bf16 v[160:163], a[84:87], a[0:3], v[160:163]
ds_read_b128 a[116:119], v249 offset:10240
s_waitcnt lgkmcnt(6)
v_mfma_f32_16x16x32_bf16 v[168:171], a[88:91], a[0:3], v[168:171]
buffer_load_dwordx4 a[60:63], v1, s[60:63], s79 offen offset:3072 sc1
v_mfma_f32_16x16x32_bf16 v[172:175], a[88:91], a[4:7], v[172:175]
ds_read_b128 a[120:123], v249 offset:12288
s_add_u32 s78, s78, 4096
v_mfma_f32_16x16x32_bf16 v[180:183], a[92:95], a[4:7], v[180:183]
s_add_u32 s79, s79, 4096
v_mfma_f32_16x16x32_bf16 v[176:179], a[92:95], a[0:3], v[176:179]
ds_read_b128 a[124:127], v249 offset:14336
s_waitcnt vmcnt(24) lgkmcnt(6)
v_mfma_f32_16x16x32_bf16 v[120:123], a[96:99], a[8:11], v[120:123]
buffer_load_dwordx4 v240, s[52:55], s72 offen offset:0  lds
v_mfma_f32_16x16x32_bf16 v[124:127], a[96:99], a[12:15], v[124:127]
ds_read_b128 a[64:67], v250 offset:0
v_mfma_f32_16x16x32_bf16 v[132:135], a[100:103], a[12:15], v[132:135]
v_mfma_f32_16x16x32_bf16 v[128:131], a[100:103], a[8:11], v[128:131]
ds_read_b128 a[68:71], v250 offset:2048
s_waitcnt lgkmcnt(6)
v_mfma_f32_16x16x32_bf16 v[136:139], a[104:107], a[8:11], v[136:139]
buffer_load_dwordx4 v241, s[52:55], s73 offen offset:1024  lds
v_mfma_f32_16x16x32_bf16 v[140:143], a[104:107], a[12:15], v[140:143]
ds_read_b128 a[72:75], v250 offset:4096
v_mfma_f32_16x16x32_bf16 v[148:151], a[108:111], a[12:15], v[148:151]
v_mfma_f32_16x16x32_bf16 v[144:147], a[108:111], a[8:11], v[144:147]
ds_read_b128 a[76:79], v250 offset:6144
s_waitcnt lgkmcnt(6)
v_mfma_f32_16x16x32_bf16 v[152:155], a[112:115], a[8:11], v[152:155]
buffer_load_dwordx4 a[0:3], v1, s[60:63], s78 offen offset:0 sc1
v_mfma_f32_16x16x32_bf16 v[156:159], a[112:115], a[12:15], v[156:159]
ds_read_b128 a[80:83], v250 offset:8192
v_mfma_f32_16x16x32_bf16 v[164:167], a[116:119], a[12:15], v[164:167]
v_mfma_f32_16x16x32_bf16 v[160:163], a[116:119], a[8:11], v[160:163]
ds_read_b128 a[84:87], v250 offset:10240
s_waitcnt lgkmcnt(6)
v_mfma_f32_16x16x32_bf16 v[168:171], a[120:123], a[8:11], v[168:171]
buffer_load_dwordx4 a[4:7], v1, s[60:63], s79 offen offset:0 sc1
v_mfma_f32_16x16x32_bf16 v[172:175], a[120:123], a[12:15], v[172:175]
ds_read_b128 a[88:91], v250 offset:12288
v_mfma_f32_16x16x32_bf16 v[180:183], a[124:127], a[12:15], v[180:183]
v_mfma_f32_16x16x32_bf16 v[176:179], a[124:127], a[8:11], v[176:179]
ds_read_b128 a[92:95], v250 offset:14336
s_waitcnt vmcnt(24) lgkmcnt(6)
v_mfma_f32_16x16x32_bf16 v[120:123], a[64:67], a[16:19], v[120:123]
buffer_load_dwordx4 v240, s[52:55], s74 offen offset:2048  lds
v_mfma_f32_16x16x32_bf16 v[124:127], a[64:67], a[20:23], v[124:127]
ds_read_b128 a[96:99], v251 offset:0
v_mfma_f32_16x16x32_bf16 v[132:135], a[68:71], a[20:23], v[132:135]
v_mfma_f32_16x16x32_bf16 v[128:131], a[68:71], a[16:19], v[128:131]
ds_read_b128 a[100:103], v251 offset:2048
s_waitcnt lgkmcnt(6)
v_mfma_f32_16x16x32_bf16 v[136:139], a[72:75], a[16:19], v[136:139]
buffer_load_dwordx4 v241, s[52:55], s75 offen offset:3072  lds
v_mfma_f32_16x16x32_bf16 v[140:143], a[72:75], a[20:23], v[140:143]
ds_read_b128 a[104:107], v251 offset:4096
s_add_u32 m0, s76, 32768
v_mfma_f32_16x16x32_bf16 v[148:151], a[76:79], a[20:23], v[148:151]
v_mfma_f32_16x16x32_bf16 v[144:147], a[76:79], a[16:19], v[144:147]
ds_read_b128 a[108:111], v251 offset:6144
s_waitcnt lgkmcnt(6)
v_mfma_f32_16x16x32_bf16 v[152:155], a[80:83], a[16:19], v[152:155]
buffer_load_dwordx4 a[8:11], v1, s[60:63], s78 offen offset:1024 sc1
v_mfma_f32_16x16x32_bf16 v[156:159], a[80:83], a[20:23], v[156:159]
ds_read_b128 a[112:115], v251 offset:8192
v_mfma_f32_16x16x32_bf16 v[164:167], a[84:87], a[20:23], v[164:167]
v_mfma_f32_16x16x32_bf16 v[160:163], a[84:87], a[16:19], v[160:163]
ds_read_b128 a[116:119], v251 offset:10240
s_waitcnt lgkmcnt(6)
v_mfma_f32_16x16x32_bf16 v[168:171], a[88:91], a[16:19], v[168:171]
buffer_load_dwordx4 a[12:15], v1, s[60:63], s79 offen offset:1024 sc1
v_mfma_f32_16x16x32_bf16 v[172:175], a[88:91], a[20:23], v[172:175]
s_waitcnt vmcnt(18)
s_barrier
v_mfma_f32_16x16x32_bf16 v[180:183], a[92:95], a[20:23], v[180:183]
ds_read_b128 a[120:123], v251 offset:12288
v_mfma_f32_16x16x32_bf16 v[176:179], a[92:95], a[16:19], v[176:179]
s_add_u32 s52, s52, s77
s_addc_u32 s53, s53, 0
s_waitcnt vmcnt(24) lgkmcnt(5)
v_mfma_f32_16x16x32_bf16 v[120:123], a[96:99], a[24:27], v[120:123]
buffer_load_dwordx4 v240, s[52:55], s68 offen offset:0  lds
v_mfma_f32_16x16x32_bf16 v[124:127], a[96:99], a[28:31], v[124:127]
ds_read_b128 a[124:127], v251 offset:14336
ds_read_b128 a[64:67], v248 offset:32768
v_mfma_f32_16x16x32_bf16 v[132:135], a[100:103], a[28:31], v[132:135]
v_mfma_f32_16x16x32_bf16 v[128:131], a[100:103], a[24:27], v[128:131]
ds_read_b128 a[68:71], v248 offset:34816
s_waitcnt lgkmcnt(6)
v_mfma_f32_16x16x32_bf16 v[136:139], a[104:107], a[24:27], v[136:139]
buffer_load_dwordx4 v241, s[52:55], s69 offen offset:1024  lds
v_mfma_f32_16x16x32_bf16 v[140:143], a[104:107], a[28:31], v[140:143]
ds_read_b128 a[72:75], v248 offset:36864
v_mfma_f32_16x16x32_bf16 v[148:151], a[108:111], a[28:31], v[148:151]
v_mfma_f32_16x16x32_bf16 v[144:147], a[108:111], a[24:27], v[144:147]
ds_read_b128 a[76:79], v248 offset:38912
s_waitcnt lgkmcnt(6)
v_mfma_f32_16x16x32_bf16 v[152:155], a[112:115], a[24:27], v[152:155]
buffer_load_dwordx4 a[16:19], v1, s[60:63], s78 offen offset:2048 sc1
v_mfma_f32_16x16x32_bf16 v[156:159], a[112:115], a[28:31], v[156:159]
ds_read_b128 a[80:83], v248 offset:40960
v_mfma_f32_16x16x32_bf16 v[164:167], a[116:119], a[28:31], v[164:167]
v_mfma_f32_16x16x32_bf16 v[160:163], a[116:119], a[24:27], v[160:163]
ds_read_b128 a[84:87], v248 offset:43008
s_waitcnt lgkmcnt(6)
v_mfma_f32_16x16x32_bf16 v[168:171], a[120:123], a[24:27], v[168:171]
buffer_load_dwordx4 a[20:23], v1, s[60:63], s79 offen offset:2048 sc1
v_mfma_f32_16x16x32_bf16 v[172:175], a[120:123], a[28:31], v[172:175]
ds_read_b128 a[88:91], v248 offset:45056
v_mfma_f32_16x16x32_bf16 v[180:183], a[124:127], a[28:31], v[180:183]
v_mfma_f32_16x16x32_bf16 v[176:179], a[124:127], a[24:27], v[176:179]
ds_read_b128 a[92:95], v248 offset:47104
s_waitcnt vmcnt(24) lgkmcnt(6)
v_mfma_f32_16x16x32_bf16 v[120:123], a[64:67], a[32:35], v[120:123]
buffer_load_dwordx4 v240, s[52:55], s70 offen offset:2048  lds
v_mfma_f32_16x16x32_bf16 v[124:127], a[64:67], a[36:39], v[124:127]
ds_read_b128 a[96:99], v249 offset:32768
v_mfma_f32_16x16x32_bf16 v[132:135], a[68:71], a[36:39], v[132:135]
v_mfma_f32_16x16x32_bf16 v[128:131], a[68:71], a[32:35], v[128:131]
ds_read_b128 a[100:103], v249 offset:34816
s_waitcnt lgkmcnt(6)
v_mfma_f32_16x16x32_bf16 v[136:139], a[72:75], a[32:35], v[136:139]
buffer_load_dwordx4 v241, s[52:55], s71 offen offset:3072  lds
v_mfma_f32_16x16x32_bf16 v[140:143], a[72:75], a[36:39], v[140:143]
ds_read_b128 a[104:107], v249 offset:36864
s_add_u32 m0, s76, 36864
v_mfma_f32_16x16x32_bf16 v[148:151], a[76:79], a[36:39], v[148:151]
v_mfma_f32_16x16x32_bf16 v[144:147], a[76:79], a[32:35], v[144:147]
ds_read_b128 a[108:111], v249 offset:38912
s_waitcnt lgkmcnt(6)
v_mfma_f32_16x16x32_bf16 v[152:155], a[80:83], a[32:35], v[152:155]
buffer_load_dwordx4 a[24:27], v1, s[60:63], s78 offen offset:3072 sc1
v_mfma_f32_16x16x32_bf16 v[156:159], a[80:83], a[36:39], v[156:159]
ds_read_b128 a[112:115], v249 offset:40960
v_mfma_f32_16x16x32_bf16 v[164:167], a[84:87], a[36:39], v[164:167]
v_mfma_f32_16x16x32_bf16 v[160:163], a[84:87], a[32:35], v[160:163]
ds_read_b128 a[116:119], v249 offset:43008
s_waitcnt lgkmcnt(6)
v_mfma_f32_16x16x32_bf16 v[168:171], a[88:91], a[32:35], v[168:171]
buffer_load_dwordx4 a[28:31], v1, s[60:63], s79 offen offset:3072 sc1
v_mfma_f32_16x16x32_bf16 v[172:175], a[88:91], a[36:39], v[172:175]
ds_read_b128 a[120:123], v249 offset:45056
s_add_u32 s78, s78, 4096
v_mfma_f32_16x16x32_bf16 v[180:183], a[92:95], a[36:39], v[180:183]
s_add_u32 s79, s79, 4096
v_mfma_f32_16x16x32_bf16 v[176:179], a[92:95], a[32:35], v[176:179]
ds_read_b128 a[124:127], v249 offset:47104
s_waitcnt vmcnt(24) lgkmcnt(6)
v_mfma_f32_16x16x32_bf16 v[120:123], a[96:99], a[40:43], v[120:123]
buffer_load_dwordx4 v240, s[52:55], s72 offen offset:0  lds
v_mfma_f32_16x16x32_bf16 v[124:127], a[96:99], a[44:47], v[124:127]
ds_read_b128 a[64:67], v250 offset:32768
v_mfma_f32_16x16x32_bf16 v[132:135], a[100:103], a[44:47], v[132:135]
v_mfma_f32_16x16x32_bf16 v[128:131], a[100:103], a[40:43], v[128:131]
ds_read_b128 a[68:71], v250 offset:34816
s_waitcnt lgkmcnt(6)
v_mfma_f32_16x16x32_bf16 v[136:139], a[104:107], a[40:43], v[136:139]
buffer_load_dwordx4 v241, s[52:55], s73 offen offset:1024  lds
v_mfma_f32_16x16x32_bf16 v[140:143], a[104:107], a[44:47], v[140:143]
ds_read_b128 a[72:75], v250 offset:36864
v_mfma_f32_16x16x32_bf16 v[148:151], a[108:111], a[44:47], v[148:151]
v_mfma_f32_16x16x32_bf16 v[144:147], a[108:111], a[40:43], v[144:147]
ds_read_b128 a[76:79], v250 offset:38912
s_waitcnt lgkmcnt(6)
v_mfma_f32_16x16x32_bf16 v[152:155], a[112:115], a[40:43], v[152:155]
buffer_load_dwordx4 a[32:35], v1, s[60:63], s78 offen offset:0 sc1
v_mfma_f32_16x16x32_bf16 v[156:159], a[112:115], a[44:47], v[156:159]
ds_read_b128 a[80:83], v250 offset:40960
v_mfma_f32_16x16x32_bf16 v[164:167], a[116:119], a[44:47], v[164:167]
v_mfma_f32_16x16x32_bf16 v[160:163], a[116:119], a[40:43], v[160:163]
ds_read_b128 a[84:87], v250 offset:43008
s_waitcnt lgkmcnt(6)
v_mfma_f32_16x16x32_bf16 v[168:171], a[120:123], a[40:43], v[168:171]
buffer_load_dwordx4 a[36:39], v1, s[60:63], s79 offen offset:0 sc1
v_mfma_f32_16x16x32_bf16 v[172:175], a[120:123], a[44:47], v[172:175]
ds_read_b128 a[88:91], v250 offset:45056
v_mfma_f32_16x16x32_bf16 v[180:183], a[124:127], a[44:47], v[180:183]
v_mfma_f32_16x16x32_bf16 v[176:179], a[124:127], a[40:43], v[176:179]
ds_read_b128 a[92:95], v250 offset:47104
s_waitcnt vmcnt(24) lgkmcnt(6)
v_mfma_f32_16x16x32_bf16 v[120:123], a[64:67], a[48:51], v[120:123]
buffer_load_dwordx4 v240, s[52:55], s74 offen offset:2048  lds
v_mfma_f32_16x16x32_bf16 v[124:127], a[64:67], a[52:55], v[124:127]
ds_read_b128 a[96:99], v251 offset:32768
v_mfma_f32_16x16x32_bf16 v[132:135], a[68:71], a[52:55], v[132:135]
v_mfma_f32_16x16x32_bf16 v[128:131], a[68:71], a[48:51], v[128:131]
ds_read_b128 a[100:103], v251 offset:34816
s_waitcnt lgkmcnt(6)
v_mfma_f32_16x16x32_bf16 v[136:139], a[72:75], a[48:51], v[136:139]
buffer_load_dwordx4 v241, s[52:55], s75 offen offset:3072  lds
v_mfma_f32_16x16x32_bf16 v[140:143], a[72:75], a[52:55], v[140:143]
ds_read_b128 a[104:107], v251 offset:36864
s_xor_b32 s76, s76, 65536
v_mfma_f32_16x16x32_bf16 v[148:151], a[76:79], a[52:55], v[148:151]
s_cmp_eq_u32 s10, 0
s_cselect_b32 s54, 0, s54
v_mfma_f32_16x16x32_bf16 v[144:147], a[76:79], a[48:51], v[144:147]
ds_read_b128 a[108:111], v251 offset:38912
s_waitcnt lgkmcnt(6)
v_mfma_f32_16x16x32_bf16 v[152:155], a[80:83], a[48:51], v[152:155]
buffer_load_dwordx4 a[40:43], v1, s[60:63], s78 offen offset:1024 sc1
v_mfma_f32_16x16x32_bf16 v[156:159], a[80:83], a[52:55], v[156:159]
ds_read_b128 a[112:115], v251 offset:40960
s_add_u32 m0, s76, 0
v_mfma_f32_16x16x32_bf16 v[164:167], a[84:87], a[52:55], v[164:167]
v_mfma_f32_16x16x32_bf16 v[160:163], a[84:87], a[48:51], v[160:163]
ds_read_b128 a[116:119], v251 offset:43008
s_waitcnt lgkmcnt(6)
v_mfma_f32_16x16x32_bf16 v[168:171], a[88:91], a[48:51], v[168:171]
buffer_load_dwordx4 a[44:47], v1, s[60:63], s79 offen offset:1024 sc1
v_mfma_f32_16x16x32_bf16 v[172:175], a[88:91], a[52:55], v[172:175]
s_waitcnt vmcnt(18)
s_barrier
v_mfma_f32_16x16x32_bf16 v[180:183], a[92:95], a[52:55], v[180:183]
ds_read_b128 a[120:123], v251 offset:45056
v_mfma_f32_16x16x32_bf16 v[176:179], a[92:95], a[48:51], v[176:179]
s_add_u32 s52, s52, s77
s_addc_u32 s53, s53, 0
s_waitcnt vmcnt(24) lgkmcnt(5)
v_mfma_f32_16x16x32_bf16 v[120:123], a[96:99], a[56:59], v[120:123]
buffer_load_dwordx4 v240, s[52:55], s68 offen offset:0  lds
v_mfma_f32_16x16x32_bf16 v[124:127], a[96:99], a[60:63], v[124:127]
ds_read_b128 a[124:127], v251 offset:47104
v_xor_b32 v248, 65536, v248
v_mfma_f32_16x16x32_bf16 v[132:135], a[100:103], a[60:63], v[132:135]
v_xor_b32 v249, 65536, v249
v_xor_b32 v250, 65536, v250
v_xor_b32 v251, 65536, v251
v_mfma_f32_16x16x32_bf16 v[128:131], a[100:103], a[56:59], v[128:131]
ds_read_b128 a[64:67], v248 offset:0
s_waitcnt lgkmcnt(5)
v_mfma_f32_16x16x32_bf16 v[136:139], a[104:107], a[56:59], v[136:139]
buffer_load_dwordx4 v241, s[52:55], s69 offen offset:1024  lds
v_mfma_f32_16x16x32_bf16 v[140:143], a[104:107], a[60:63], v[140:143]
ds_read_b128 a[68:71], v248 offset:2048
ds_read_b128 a[72:75], v248 offset:4096
v_mfma_f32_16x16x32_bf16 v[148:151], a[108:111], a[60:63], v[148:151]
v_mfma_f32_16x16x32_bf16 v[144:147], a[108:111], a[56:59], v[144:147]
ds_read_b128 a[76:79], v248 offset:6144
s_waitcnt lgkmcnt(6)
v_mfma_f32_16x16x32_bf16 v[152:155], a[112:115], a[56:59], v[152:155]
buffer_load_dwordx4 a[48:51], v1, s[60:63], s78 offen offset:2048 sc1
v_mfma_f32_16x16x32_bf16 v[156:159], a[112:115], a[60:63], v[156:159]
ds_read_b128 a[80:83], v248 offset:8192
v_mfma_f32_16x16x32_bf16 v[164:167], a[116:119], a[60:63], v[164:167]
v_mfma_f32_16x16x32_bf16 v[160:163], a[116:119], a[56:59], v[160:163]
ds_read_b128 a[84:87], v248 offset:10240
s_waitcnt lgkmcnt(6)
v_mfma_f32_16x16x32_bf16 v[168:171], a[120:123], a[56:59], v[168:171]
buffer_load_dwordx4 a[52:55], v1, s[60:63], s79 offen offset:2048 sc1
v_mfma_f32_16x16x32_bf16 v[172:175], a[120:123], a[60:63], v[172:175]
ds_read_b128 a[88:91], v248 offset:12288
v_mfma_f32_16x16x32_bf16 v[180:183], a[124:127], a[60:63], v[180:183]
v_mfma_f32_16x16x32_bf16 v[176:179], a[124:127], a[56:59], v[176:179]
s_cmp_lg_u32 s10, 0
s_cbranch_scc1 L2_sloop
ds_read_b128 a[92:95], v248 offset:14336
s_waitcnt vmcnt(24) lgkmcnt(6)
v_mfma_f32_16x16x32_bf16 v[120:123], a[64:67], a[0:3], v[120:123]
buffer_load_dwordx4 a[56:59], v1, s[60:63], s78 offen offset:3072 sc1
v_mfma_f32_16x16x32_bf16 v[124:127], a[64:67], a[4:7], v[124:127]
ds_read_b128 a[96:99], v249 offset:8192
v_mfma_f32_16x16x32_bf16 v[132:135], a[68:71], a[4:7], v[132:135]
buffer_load_dwordx4 a[60:63], v1, s[60:63], s79 offen offset:3072 sc1
v_mfma_f32_16x16x32_bf16 v[128:131], a[68:71], a[0:3], v[128:131]
ds_read_b128 a[100:103], v249 offset:10240
s_waitcnt lgkmcnt(6)
v_mfma_f32_16x16x32_bf16 v[136:139], a[72:75], a[0:3], v[136:139]
    s_mov_b32 s10, 0x40000
    s_waitcnt vmcnt(24)
L2_gchk:
    v_cmp_eq_u32 vcc, s98, v49
    s_mov_b64 s[92:93], vcc
    v_cmp_eq_u32 vcc, s98, v51
    s_and_b64 s[92:93], s[92:93], vcc
    v_cmp_eq_u32 vcc, s98, v46
    s_and_b64 s[92:93], s[92:93], vcc
    v_cmp_eq_u32 vcc, s98, v47
    s_and_b64 s[92:93], s[92:93], vcc
    s_cmp_eq_u64 s[92:93], -1
    s_cbranch_scc1 L2_gok
    buffer_load_dwordx2 v[48:49], v243, s[64:67], s82 offen offset:0 sc0 sc1
    buffer_load_dwordx2 v[50:51], v243, s[64:67], s82 offen offset:32 sc0 sc1
    buffer_load_dwordx2 v[46:47], v21, s[56:59], s86 offen sc0 sc1
    s_waitcnt vmcnt(0)
    s_sub_u32 s10, s10, 1
    s_cbranch_scc0 L2_gchk
L2_gok:
v_mfma_f32_16x16x32_bf16 v[140:143], a[72:75], a[4:7], v[140:143]
ds_read_b128 a[104:107], v249 offset:12288
v_sub_f32 v24, 1.0, v48
v_mfma_f32_16x16x32_bf16 v[148:151], a[76:79], a[4:7], v[148:151]
v_cvt_pk_bf16_f32 v24, v24, v24
v_and_b32 v24, 0xffff0000, v24
v_mfma_f32_16x16x32_bf16 v[144:147], a[76:79], a[0:3], v[144:147]
ds_read_b128 a[108:111], v249 offset:14336
s_waitcnt lgkmcnt(6)
v_mfma_f32_16x16x32_bf16 v[152:155], a[80:83], a[0:3], v[152:155]
v_add_f32 v25, v48, v48
v_sub_f32 v26, 1.0, v50
v_mfma_f32_16x16x32_bf16 v[156:159], a[80:83], a[4:7], v[156:159]
ds_read_b128 a[112:115], v250 offset:8192
v_cvt_pk_bf16_f32 v26, v26, v26
v_mfma_f32_16x16x32_bf16 v[164:167], a[84:87], a[4:7], v[164:167]
v_and_b32 v26, 0xffff0000, v26
v_add_f32 v27, v50, v50
v_mfma_f32_16x16x32_bf16 v[160:163], a[84:87], a[0:3], v[160:163]
ds_read_b128 a[116:119], v250 offset:10240
s_waitcnt lgkmcnt(6)
v_mfma_f32_16x16x32_bf16 v[168:171], a[88:91], a[0:3], v[168:171]
v_mul_f32 v88, v24, v88
v_mul_f32 v89, v24, v89
v_mfma_f32_16x16x32_bf16 v[172:175], a[88:91], a[4:7], v[172:175]
ds_read_b128 a[120:123], v250 offset:12288
v_mul_f32 v90, v24, v90
v_mfma_f32_16x16x32_bf16 v[180:183], a[92:95], a[4:7], v[180:183]
v_mul_f32 v91, v24, v91
v_mul_f32 v92, v26, v92
v_mfma_f32_16x16x32_bf16 v[176:179], a[92:95], a[0:3], v[176:179]
ds_read_b128 a[124:127], v250 offset:14336
s_waitcnt vmcnt(22) lgkmcnt(6)
v_mfma_f32_16x16x32_bf16 v[152:155], a[96:99], a[8:11], v[152:155]
v_mul_f32 v93, v26, v93
v_mul_f32 v94, v26, v94
v_mfma_f32_16x16x32_bf16 v[156:159], a[96:99], a[12:15], v[156:159]
ds_read_b128 a[64:67], v251 offset:8192
v_mul_f32 v95, v26, v95
v_mfma_f32_16x16x32_bf16 v[164:167], a[100:103], a[12:15], v[164:167]
v_mul_f32 v96, v24, v96
v_mul_f32 v97, v24, v97
v_mfma_f32_16x16x32_bf16 v[160:163], a[100:103], a[8:11], v[160:163]
ds_read_b128 a[68:71], v251 offset:10240
s_waitcnt lgkmcnt(6)
v_mfma_f32_16x16x32_bf16 v[168:171], a[104:107], a[8:11], v[168:171]
v_mul_f32 v98, v24, v98
v_mul_f32 v99, v24, v99
v_mfma_f32_16x16x32_bf16 v[172:175], a[104:107], a[12:15], v[172:175]
ds_read_b128 a[72:75], v251 offset:12288
v_mul_f32 v100, v26, v100
v_mfma_f32_16x16x32_bf16 v[180:183], a[108:111], a[12:15], v[180:183]
v_mul_f32 v101, v26, v101
v_mul_f32 v102, v26, v102
v_mfma_f32_16x16x32_bf16 v[176:179], a[108:111], a[8:11], v[176:179]
s_waitcnt vmcnt(8)
s_barrier
s_waitcnt vmcnt(18) lgkmcnt(5)
v_mfma_f32_16x16x32_bf16 v[152:155], a[112:115], a[16:19], v[152:155]
ds_read_b128 a[76:79], v251 offset:14336
v_mul_f32 v103, v26, v103
v_mfma_f32_16x16x32_bf16 v[156:159], a[112:115], a[20:23], v[156:159]
ds_read_b128 a[80:83], v248 offset:40960
v_mul_f32 v104, v24, v104
v_mfma_f32_16x16x32_bf16 v[164:167], a[116:119], a[20:23], v[164:167]
v_mul_f32 v105, v24, v105
v_mul_f32 v106, v24, v106
v_mfma_f32_16x16x32_bf16 v[160:163], a[116:119], a[16:19], v[160:163]
ds_read_b128 a[84:87], v248 offset:43008
s_waitcnt lgkmcnt(6)
v_mfma_f32_16x16x32_bf16 v[168:171], a[120:123], a[16:19], v[168:171]
v_mul_f32 v107, v24, v107
v_mul_f32 v108, v26, v108
v_mfma_f32_16x16x32_bf16 v[172:175], a[120:123], a[20:23], v[172:175]
ds_read_b128 a[88:91], v248 offset:45056
v_mul_f32 v109, v26, v109
v_mfma_f32_16x16x32_bf16 v[180:183], a[124:127], a[20:23], v[180:183]
v_mul_f32 v110, v26, v110
v_mul_f32 v111, v26, v111
v_mfma_f32_16x16x32_bf16 v[176:179], a[124:127], a[16:19], v[176:179]
ds_read_b128 a[92:95], v248 offset:47104
s_waitcnt vmcnt(14) lgkmcnt(6)
v_mfma_f32_16x16x32_bf16 v[152:155], a[64:67], a[24:27], v[152:155]
v_mul_f32 v112, v24, v112
v_mul_f32 v113, v24, v113
v_mfma_f32_16x16x32_bf16 v[156:159], a[64:67], a[28:31], v[156:159]
ds_read_b128 a[96:99], v249 offset:40960
v_mul_f32 v114, v24, v114
v_mfma_f32_16x16x32_bf16 v[164:167], a[68:71], a[28:31], v[164:167]
v_mul_f32 v115, v24, v115
v_mul_f32 v116, v26, v116
v_mfma_f32_16x16x32_bf16 v[160:163], a[68:71], a[24:27], v[160:163]
ds_read_b128 a[100:103], v249 offset:43008
s_waitcnt lgkmcnt(6)
v_mfma_f32_16x16x32_bf16 v[168:171], a[72:75], a[24:27], v[168:171]
v_mul_f32 v117, v26, v117
v_mul_f32 v118, v26, v118
v_mfma_f32_16x16x32_bf16 v[172:175], a[72:75], a[28:31], v[172:175]
ds_read_b128 a[104:107], v249 offset:45056
v_mul_f32 v119, v26, v119
v_mfma_f32_16x16x32_bf16 v[180:183], a[76:79], a[28:31], v[180:183]
s_lshl_b32 s94, s83, 12
s_xor_b32 s95, s94, 16384
v_mfma_f32_16x16x32_bf16 v[176:179], a[76:79], a[24:27], v[176:179]
ds_read_b128 a[108:111], v249 offset:47104
s_waitcnt vmcnt(10) lgkmcnt(6)
v_mfma_f32_16x16x32_bf16 v[152:155], a[80:83], a[32:35], v[152:155]
s_add_u32 s52, s48, 25165824
s_addc_u32 s53, s49, 0
v_mfma_f32_16x16x32_bf16 v[156:159], a[80:83], a[36:39], v[156:159]
ds_read_b128 a[112:115], v250 offset:40960
s_mov_b32 s54, 4194304
v_mfma_f32_16x16x32_bf16 v[164:167], a[84:87], a[36:39], v[164:167]
s_lshl_b32 s11, s96, 12
s_lshl_b32 s12, s97, 2
v_mfma_f32_16x16x32_bf16 v[160:163], a[84:87], a[32:35], v[160:163]
ds_read_b128 a[116:119], v250 offset:43008
s_waitcnt lgkmcnt(6)
v_mfma_f32_16x16x32_bf16 v[168:171], a[88:91], a[32:35], v[168:171]
s_add_u32 s11, s11, s12
v_mul_f32 v56, v24, v56
v_mfma_f32_16x16x32_bf16 v[172:175], a[88:91], a[36:39], v[172:175]
ds_read_b128 a[120:123], v250 offset:45056
v_mul_f32 v57, v24, v57
v_mfma_f32_16x16x32_bf16 v[180:183], a[92:95], a[36:39], v[180:183]
s_add_u32 s56, s44, s11
s_addc_u32 s57, s45, 0
v_mfma_f32_16x16x32_bf16 v[176:179], a[92:95], a[32:35], v[176:179]
ds_read_b128 a[124:127], v250 offset:47104
s_waitcnt vmcnt(6) lgkmcnt(6)
v_mfma_f32_16x16x32_bf16 v[152:155], a[96:99], a[40:43], v[152:155]
s_mov_b32 s58, 229376
v_mul_f32 v58, v24, v58
v_mfma_f32_16x16x32_bf16 v[156:159], a[96:99], a[44:47], v[156:159]
ds_read_b128 a[64:67], v251 offset:40960
v_mul_f32 v59, v24, v59
v_mfma_f32_16x16x32_bf16 v[164:167], a[100:103], a[44:47], v[164:167]
v_mul_f32 v60, v26, v60
v_mul_f32 v61, v26, v61
v_mfma_f32_16x16x32_bf16 v[160:163], a[100:103], a[40:43], v[160:163]
ds_read_b128 a[68:71], v251 offset:43008
s_waitcnt lgkmcnt(6)
v_mfma_f32_16x16x32_bf16 v[168:171], a[104:107], a[40:43], v[168:171]
v_mul_f32 v62, v26, v62
v_mul_f32 v63, v26, v63
v_mfma_f32_16x16x32_bf16 v[172:175], a[104:107], a[44:47], v[172:175]
ds_read_b128 a[72:75], v251 offset:45056
v_mul_f32 v64, v24, v64
v_mfma_f32_16x16x32_bf16 v[180:183], a[108:111], a[44:47], v[180:183]
v_mul_f32 v65, v24, v65
v_mul_f32 v66, v24, v66
v_mfma_f32_16x16x32_bf16 v[176:179], a[108:111], a[40:43], v[176:179]
ds_read_b128 a[76:79], v251 offset:47104
s_waitcnt vmcnt(2) lgkmcnt(6)
v_mfma_f32_16x16x32_bf16 v[152:155], a[112:115], a[48:51], v[152:155]
v_mul_f32 v67, v24, v67
v_mul_f32 v68, v26, v68
v_mfma_f32_16x16x32_bf16 v[156:159], a[112:115], a[52:55], v[156:159]
ds_read_b128 a[80:83], v249 offset:0
v_mul_f32 v69, v26, v69
v_mfma_f32_16x16x32_bf16 v[164:167], a[116:119], a[52:55], v[164:167]
v_mul_f32 v70, v26, v70
v_mul_f32 v71, v26, v71
v_mfma_f32_16x16x32_bf16 v[160:163], a[116:119], a[48:51], v[160:163]
ds_read_b128 a[84:87], v249 offset:2048
s_waitcnt lgkmcnt(6)
v_mfma_f32_16x16x32_bf16 v[168:171], a[120:123], a[48:51], v[168:171]
v_mul_f32 v72, v24, v72
v_mul_f32 v73, v24, v73
v_mfma_f32_16x16x32_bf16 v[172:175], a[120:123], a[52:55], v[172:175]
ds_read_b128 a[88:91], v249 offset:4096
v_mul_f32 v74, v24, v74
v_mfma_f32_16x16x32_bf16 v[180:183], a[124:127], a[52:55], v[180:183]
v_mul_f32 v75, v24, v75
v_mul_f32 v76, v26, v76
v_mfma_f32_16x16x32_bf16 v[176:179], a[124:127], a[48:51], v[176:179]
ds_read_b128 a[92:95], v249 offset:6144
s_waitcnt vmcnt(0) lgkmcnt(6)
v_mfma_f32_16x16x32_bf16 v[152:155], a[64:67], a[56:59], v[152:155]
v_mul_f32 v77, v26, v77
v_mul_f32 v78, v26, v78
v_mfma_f32_16x16x32_bf16 v[156:159], a[64:67], a[60:63], v[156:159]
ds_read_b128 a[96:99], v250 offset:0
v_mul_f32 v79, v26, v79
v_mfma_f32_16x16x32_bf16 v[164:167], a[68:71], a[60:63], v[164:167]
v_mul_f32 v80, v24, v80
v_mul_f32 v81, v24, v81
v_mfma_f32_16x16x32_bf16 v[160:163], a[68:71], a[56:59], v[160:163]
ds_read_b128 a[100:103], v250 offset:2048
s_waitcnt lgkmcnt(6)
v_mfma_f32_16x16x32_bf16 v[168:171], a[72:75], a[56:59], v[168:171]
v_mul_f32 v82, v24, v82
v_mul_f32 v83, v24, v83
v_mfma_f32_16x16x32_bf16 v[172:175], a[72:75], a[60:63], v[172:175]
ds_read_b128 a[104:107], v250 offset:4096
v_mul_f32 v84, v26, v84
v_mfma_f32_16x16x32_bf16 v[180:183], a[76:79], a[60:63], v[180:183]
v_mul_f32 v85, v26, v85
v_mul_f32 v86, v26, v86
v_mfma_f32_16x16x32_bf16 v[176:179], a[76:79], a[56:59], v[176:179]
ds_read_b128 a[108:111], v250 offset:6144
s_waitcnt lgkmcnt(6)
v_mfma_f32_16x16x32_bf16 v[120:123], a[80:83], a[8:11], v[120:123]
v_mul_f32 v87, v26, v87
v_mfma_f32_16x16x32_bf16 v[124:127], a[80:83], a[12:15], v[124:127]
ds_read_b128 a[112:115], v251 offset:0
v_mfma_f32_16x16x32_bf16 v[132:135], a[84:87], a[12:15], v[132:135]
v_fmac_f32 v88, v25, v152
v_fmac_f32 v89, v25, v153
v_mfma_f32_16x16x32_bf16 v[128:131], a[84:87], a[8:11], v[128:131]
ds_read_b128 a[116:119], v251 offset:2048
s_waitcnt lgkmcnt(6)
v_mfma_f32_16x16x32_bf16 v[136:139], a[88:91], a[8:11], v[136:139]
v_fmac_f32 v90, v25, v154
v_fmac_f32 v91, v25, v155
v_mfma_f32_16x16x32_bf16 v[140:143], a[88:91], a[12:15], v[140:143]
ds_read_b128 a[120:123], v251 offset:4096
v_fmac_f32 v92, v27, v156
v_mfma_f32_16x16x32_bf16 v[148:151], a[92:95], a[12:15], v[148:151]
v_fmac_f32 v93, v27, v157
v_fmac_f32 v94, v27, v158
v_mfma_f32_16x16x32_bf16 v[144:147], a[92:95], a[8:11], v[144:147]
ds_read_b128 a[124:127], v251 offset:6144
s_waitcnt lgkmcnt(6)
v_mfma_f32_16x16x32_bf16 v[120:123], a[96:99], a[16:19], v[120:123]
v_fmac_f32 v95, v27, v159
v_cvt_pk_bf16_f32 v152, v88, v89
v_mfma_f32_16x16x32_bf16 v[124:127], a[96:99], a[20:23], v[124:127]
ds_read_b128 a[64:67], v248 offset:32768
v_cvt_pk_bf16_f32 v153, v90, v91
v_mfma_f32_16x16x32_bf16 v[132:135], a[100:103], a[20:23], v[132:135]
v_cvt_pk_bf16_f32 v154, v92, v93
v_cvt_pk_bf16_f32 v155, v94, v95
v_mfma_f32_16x16x32_bf16 v[128:131], a[100:103], a[16:19], v[128:131]
ds_read_b128 a[68:71], v248 offset:34816
s_waitcnt lgkmcnt(6)
v_mfma_f32_16x16x32_bf16 v[136:139], a[104:107], a[16:19], v[136:139]
buffer_store_dwordx4 v[152:155], v1, s[52:55], s94 offen offset:0 sc0 sc1
v_mfma_f32_16x16x32_bf16 v[140:143], a[104:107], a[20:23], v[140:143]
ds_read_b128 a[72:75], v248 offset:36864
v_fmac_f32 v96, v25, v160
v_mfma_f32_16x16x32_bf16 v[148:151], a[108:111], a[20:23], v[148:151]
v_fmac_f32 v97, v25, v161
v_fmac_f32 v98, v25, v162
v_mfma_f32_16x16x32_bf16 v[144:147], a[108:111], a[16:19], v[144:147]
ds_read_b128 a[76:79], v248 offset:38912
s_waitcnt lgkmcnt(6)
v_mfma_f32_16x16x32_bf16 v[120:123], a[112:115], a[24:27], v[120:123]
v_fmac_f32 v99, v25, v163
v_fmac_f32 v100, v27, v164
v_mfma_f32_16x16x32_bf16 v[124:127], a[112:115], a[28:31], v[124:127]
ds_read_b128 a[80:83], v249 offset:32768
v_fmac_f32 v101, v27, v165
v_mfma_f32_16x16x32_bf16 v[132:135], a[116:119], a[28:31], v[132:135]
v_fmac_f32 v102, v27, v166
v_fmac_f32 v103, v27, v167
v_mfma_f32_16x16x32_bf16 v[128:131], a[116:119], a[24:27], v[128:131]
v_cvt_pk_bf16_f32 v160, v96, v97
v_cvt_pk_bf16_f32 v161, v98, v99
v_cvt_pk_bf16_f32 v162, v100, v101
v_cvt_pk_bf16_f32 v163, v102, v103
s_waitcnt lgkmcnt(5)
v_mfma_f32_16x16x32_bf16 v[136:139], a[120:123], a[24:27], v[136:139]
buffer_store_dwordx4 v[160:163], v1, s[52:55], s94 offen offset:1024 sc0 sc1
v_mfma_f32_16x16x32_bf16 v[140:143], a[120:123], a[28:31], v[140:143]
ds_read_b128 a[84:87], v249 offset:34816
ds_read_b128 a[88:91], v249 offset:36864
v_mfma_f32_16x16x32_bf16 v[148:151], a[124:127], a[28:31], v[148:151]
v_fmac_f32 v104, v25, v168
v_fmac_f32 v105, v25, v169
v_mfma_f32_16x16x32_bf16 v[144:147], a[124:127], a[24:27], v[144:147]
ds_read_b128 a[92:95], v249 offset:38912
s_waitcnt lgkmcnt(6)
v_mfma_f32_16x16x32_bf16 v[120:123], a[64:67], a[32:35], v[120:123]
v_fmac_f32 v106, v25, v170
v_fmac_f32 v107, v25, v171
v_mfma_f32_16x16x32_bf16 v[124:127], a[64:67], a[36:39], v[124:127]
ds_read_b128 a[96:99], v250 offset:32768
v_fmac_f32 v108, v27, v172
v_mfma_f32_16x16x32_bf16 v[132:135], a[68:71], a[36:39], v[132:135]
v_fmac_f32 v109, v27, v173
v_fmac_f32 v110, v27, v174
v_mfma_f32_16x16x32_bf16 v[128:131], a[68:71], a[32:35], v[128:131]
v_fmac_f32 v111, v27, v175
v_cvt_pk_bf16_f32 v168, v104, v105
v_cvt_pk_bf16_f32 v169, v106, v107
v_cvt_pk_bf16_f32 v170, v108, v109
v_cvt_pk_bf16_f32 v171, v110, v111
s_waitcnt lgkmcnt(5)
v_mfma_f32_16x16x32_bf16 v[136:139], a[72:75], a[32:35], v[136:139]
buffer_store_dwordx4 v[168:171], v1, s[52:55], s94 offen offset:2048 sc0 sc1
v_mfma_f32_16x16x32_bf16 v[140:143], a[72:75], a[36:39], v[140:143]
ds_read_b128 a[100:103], v250 offset:34816
ds_read_b128 a[104:107], v250 offset:36864
v_mfma_f32_16x16x32_bf16 v[148:151], a[76:79], a[36:39], v[148:151]
v_fmac_f32 v112, v25, v176
v_fmac_f32 v113, v25, v177
v_mfma_f32_16x16x32_bf16 v[144:147], a[76:79], a[32:35], v[144:147]
ds_read_b128 a[108:111], v250 offset:38912
s_waitcnt lgkmcnt(6)
v_mfma_f32_16x16x32_bf16 v[120:123], a[80:83], a[40:43], v[120:123]
v_fmac_f32 v114, v25, v178
v_fmac_f32 v115, v25, v179
v_mfma_f32_16x16x32_bf16 v[124:127], a[80:83], a[44:47], v[124:127]
ds_read_b128 a[112:115], v251 offset:32768
v_fmac_f32 v116, v27, v180
v_mfma_f32_16x16x32_bf16 v[132:135], a[84:87], a[44:47], v[132:135]
v_fmac_f32 v117, v27, v181
v_fmac_f32 v118, v27, v182
v_mfma_f32_16x16x32_bf16 v[128:131], a[84:87], a[40:43], v[128:131]
v_fmac_f32 v119, v27, v183
v_cvt_pk_bf16_f32 v176, v112, v113
v_cvt_pk_bf16_f32 v177, v114, v115
v_cvt_pk_bf16_f32 v178, v116, v117
v_cvt_pk_bf16_f32 v179, v118, v119
s_waitcnt lgkmcnt(5)
v_mfma_f32_16x16x32_bf16 v[136:139], a[88:91], a[40:43], v[136:139]
buffer_store_dwordx4 v[176:179], v1, s[52:55], s94 offen offset:3072 sc0 sc1
v_mfma_f32_16x16x32_bf16 v[140:143], a[88:91], a[44:47], v[140:143]
ds_read_b128 a[116:119], v251 offset:34816
ds_read_b128 a[120:123], v251 offset:36864
v_mfma_f32_16x16x32_bf16 v[148:151], a[92:95], a[44:47], v[148:151]
v_mfma_f32_16x16x32_bf16 v[144:147], a[92:95], a[40:43], v[144:147]
ds_read_b128 a[124:127], v251 offset:38912
s_waitcnt lgkmcnt(6)
v_mfma_f32_16x16x32_bf16 v[120:123], a[96:99], a[48:51], v[120:123]
v_mfma_f32_16x16x32_bf16 v[124:127], a[96:99], a[52:55], v[124:127]
v_mfma_f32_16x16x32_bf16 v[132:135], a[100:103], a[52:55], v[132:135]
v_mfma_f32_16x16x32_bf16 v[128:131], a[100:103], a[48:51], v[128:131]
s_waitcnt lgkmcnt(4)
v_mfma_f32_16x16x32_bf16 v[136:139], a[104:107], a[48:51], v[136:139]
v_mfma_f32_16x16x32_bf16 v[140:143], a[104:107], a[52:55], v[140:143]
v_mfma_f32_16x16x32_bf16 v[148:151], a[108:111], a[52:55], v[148:151]
v_mfma_f32_16x16x32_bf16 v[144:147], a[108:111], a[48:51], v[144:147]
s_waitcnt lgkmcnt(2)
v_mfma_f32_16x16x32_bf16 v[120:123], a[112:115], a[56:59], v[120:123]
v_mfma_f32_16x16x32_bf16 v[124:127], a[112:115], a[60:63], v[124:127]
v_mfma_f32_16x16x32_bf16 v[132:135], a[116:119], a[60:63], v[132:135]
v_mfma_f32_16x16x32_bf16 v[128:131], a[116:119], a[56:59], v[128:131]
s_waitcnt lgkmcnt(0)
v_mfma_f32_16x16x32_bf16 v[136:139], a[120:123], a[56:59], v[136:139]
v_mfma_f32_16x16x32_bf16 v[140:143], a[120:123], a[60:63], v[140:143]
v_mfma_f32_16x16x32_bf16 v[148:151], a[124:127], a[60:63], v[148:151]
buffer_load_dwordx4 v[184:187], v1, s[52:55], s95 offen offset:0 sc0 sc1
v_mfma_f32_16x16x32_bf16 v[144:147], a[124:127], a[56:59], v[144:147]
v_mfma_f32_16x16x32_bf16 v[120:123], v[216:219], v[200:203], v[120:123]
buffer_load_dwordx4 v[188:191], v1, s[52:55], s95 offen offset:1024 sc0 sc1
v_mfma_f32_16x16x32_bf16 v[124:127], v[216:219], v[204:207], v[124:127]
v_mfma_f32_16x16x32_bf16 v[128:131], v[220:223], v[200:203], v[128:131]
buffer_load_dwordx4 v[192:195], v1, s[52:55], s95 offen offset:2048 sc0 sc1
v_mfma_f32_16x16x32_bf16 v[132:135], v[220:223], v[204:207], v[132:135]
v_mfma_f32_16x16x32_bf16 v[136:139], v[224:227], v[208:211], v[136:139]
buffer_load_dwordx4 v[196:199], v1, s[52:55], s95 offen offset:3072 sc0 sc1
v_mfma_f32_16x16x32_bf16 v[140:143], v[224:227], v[212:215], v[140:143]
v_mfma_f32_16x16x32_bf16 v[144:147], v[228:231], v[208:211], v[144:147]
v_mfma_f32_16x16x32_bf16 v[148:151], v[228:231], v[212:215], v[148:151]
s_nop 7
v_pk_fma_f32 v[56:57], v[120:121], v[24:25], v[56:57] op_sel:[0,1,0]
v_pk_fma_f32 v[58:59], v[122:123], v[24:25], v[58:59] op_sel:[0,1,0]
v_pk_fma_f32 v[60:61], v[124:125], v[26:27], v[60:61] op_sel:[0,1,0]
v_pk_fma_f32 v[62:63], v[126:127], v[26:27], v[62:63] op_sel:[0,1,0]
v_pk_fma_f32 v[64:65], v[128:129], v[24:25], v[64:65] op_sel:[0,1,0]
v_pk_fma_f32 v[66:67], v[130:131], v[24:25], v[66:67] op_sel:[0,1,0]
v_pk_fma_f32 v[68:69], v[132:133], v[26:27], v[68:69] op_sel:[0,1,0]
v_pk_fma_f32 v[70:71], v[134:135], v[26:27], v[70:71] op_sel:[0,1,0]
v_pk_fma_f32 v[72:73], v[136:137], v[24:25], v[72:73] op_sel:[0,1,0]
v_pk_fma_f32 v[74:75], v[138:139], v[24:25], v[74:75] op_sel:[0,1,0]
v_pk_fma_f32 v[76:77], v[140:141], v[26:27], v[76:77] op_sel:[0,1,0]
v_pk_fma_f32 v[78:79], v[142:143], v[26:27], v[78:79] op_sel:[0,1,0]
v_pk_fma_f32 v[80:81], v[144:145], v[24:25], v[80:81] op_sel:[0,1,0]
v_pk_fma_f32 v[82:83], v[146:147], v[24:25], v[82:83] op_sel:[0,1,0]
v_pk_fma_f32 v[84:85], v[148:149], v[26:27], v[84:85] op_sel:[0,1,0]
v_pk_fma_f32 v[86:87], v[150:151], v[26:27], v[86:87] op_sel:[0,1,0]
s_mov_b32 s10, 0x40000
v_xor_b32 v236, 64, v232
v_xor_b32 v237, 128, v232
v_xor_b32 v238, 192, v232
s_waitcnt vmcnt(0)
L2_xchk:
v_max3_u32 v28, v184, v185, v186
v_max3_u32 v28, v28, v187, v188
v_max3_u32 v28, v28, v189, v190
v_max3_u32 v28, v28, v191, v192
v_max3_u32 v28, v28, v193, v194
v_max3_u32 v28, v28, v195, v196
v_max3_u32 v28, v28, v197, v198
v_max_u32 v28, v28, v199
v_cmp_eq_u32 vcc, -1, v28
s_cmp_eq_u64 vcc, 0
s_cbranch_scc1 L2_xok
buffer_load_dwordx4 v[184:187], v1, s[52:55], s95 offen offset:0 sc0 sc1
buffer_load_dwordx4 v[188:191], v1, s[52:55], s95 offen offset:1024 sc0 sc1
buffer_load_dwordx4 v[192:195], v1, s[52:55], s95 offen offset:2048 sc0 sc1
buffer_load_dwordx4 v[196:199], v1, s[52:55], s95 offen offset:3072 sc0 sc1
s_waitcnt vmcnt(0)
s_sub_u32 s10, s10, 1
s_cbranch_scc0 L2_xchk
L2_xok:
v_lshlrev_b32 v200, 16, v184
v_and_b32 v201, 0xffff0000, v184
v_lshlrev_b32 v202, 16, v185
v_and_b32 v203, 0xffff0000, v185
v_pk_add_f32 v[56:57], v[56:57], v[200:201]
v_pk_add_f32 v[58:59], v[58:59], v[202:203]
ds_write_b128 v232, v[56:59] offset:0
v_lshlrev_b32 v208, 16, v188
v_and_b32 v209, 0xffff0000, v188
v_lshlrev_b32 v210, 16, v189
v_and_b32 v211, 0xffff0000, v189
v_pk_add_f32 v[64:65], v[64:65], v[208:209]
v_pk_add_f32 v[66:67], v[66:67], v[210:211]
ds_write_b128 v236, v[64:67] offset:0
v_lshlrev_b32 v216, 16, v192
v_and_b32 v217, 0xffff0000, v192
v_lshlrev_b32 v218, 16, v193
v_and_b32 v219, 0xffff0000, v193
v_pk_add_f32 v[72:73], v[72:73], v[216:217]
v_pk_add_f32 v[74:75], v[74:75], v[218:219]
ds_write_b128 v237, v[72:75] offset:0
v_lshlrev_b32 v224, 16, v196
v_and_b32 v225, 0xffff0000, v196
v_lshlrev_b32 v226, 16, v197
v_and_b32 v227, 0xffff0000, v197
v_pk_add_f32 v[80:81], v[80:81], v[224:225]
v_pk_add_f32 v[82:83], v[82:83], v[226:227]
ds_write_b128 v238, v[80:83] offset:0
ds_read_b128 v[88:91], v234 offset:0
ds_read_b128 v[92:95], v235 offset:1024
ds_read_b128 v[96:99], v234 offset:2048
ds_read_b128 v[100:103], v235 offset:3072
s_mov_b32 s11, 0
s_waitcnt lgkmcnt(3)
buffer_store_dwordx4 v[88:91], v233, s[56:59], s11 offen sc0 sc1
s_mov_b32 s11, 65536
s_waitcnt lgkmcnt(2)
buffer_store_dwordx4 v[92:95], v233, s[56:59], s11 offen sc0 sc1
s_mov_b32 s11, 131072
s_waitcnt lgkmcnt(1)
buffer_store_dwordx4 v[96:99], v233, s[56:59], s11 offen sc0 sc1
s_mov_b32 s11, 196608
s_waitcnt lgkmcnt(0)
buffer_store_dwordx4 v[100:103], v233, s[56:59], s11 offen sc0 sc1
v_lshlrev_b32 v204, 16, v186
v_and_b32 v205, 0xffff0000, v186
v_lshlrev_b32 v206, 16, v187
v_and_b32 v207, 0xffff0000, v187
v_pk_add_f32 v[60:61], v[60:61], v[204:205]
v_pk_add_f32 v[62:63], v[62:63], v[206:207]
ds_write_b128 v232, v[60:63] offset:4096
v_lshlrev_b32 v212, 16, v190
v_and_b32 v213, 0xffff0000, v190
v_lshlrev_b32 v214, 16, v191
v_and_b32 v215, 0xffff0000, v191
v_pk_add_f32 v[68:69], v[68:69], v[212:213]
v_pk_add_f32 v[70:71], v[70:71], v[214:215]
ds_write_b128 v236, v[68:71] offset:4096
v_lshlrev_b32 v220, 16, v194
v_and_b32 v221, 0xffff0000, v194
v_lshlrev_b32 v222, 16, v195
v_and_b32 v223, 0xffff0000, v195
v_pk_add_f32 v[76:77], v[76:77], v[220:221]
v_pk_add_f32 v[78:79], v[78:79], v[222:223]
ds_write_b128 v237, v[76:79] offset:4096
v_lshlrev_b32 v228, 16, v198
v_and_b32 v229, 0xffff0000, v198
v_lshlrev_b32 v230, 16, v199
v_and_b32 v231, 0xffff0000, v199
v_pk_add_f32 v[84:85], v[84:85], v[228:229]
v_pk_add_f32 v[86:87], v[86:87], v[230:231]
ds_write_b128 v238, v[84:87] offset:4096
ds_read_b128 v[104:107], v234 offset:4096
ds_read_b128 v[108:111], v235 offset:5120
ds_read_b128 v[112:115], v234 offset:6144
ds_read_b128 v[116:119], v235 offset:7168
s_mov_b32 s11, 16384
s_waitcnt lgkmcnt(3)
buffer_store_dwordx4 v[104:107], v233, s[56:59], s11 offen sc0 sc1
s_mov_b32 s11, 81920
s_waitcnt lgkmcnt(2)
buffer_store_dwordx4 v[108:111], v233, s[56:59], s11 offen sc0 sc1
s_mov_b32 s11, 147456
s_waitcnt lgkmcnt(1)
buffer_store_dwordx4 v[112:115], v233, s[56:59], s11 offen sc0 sc1
s_mov_b32 s11, 212992
s_waitcnt lgkmcnt(0)
buffer_store_dwordx4 v[116:119], v233, s[56:59], s11 offen sc0 sc1
    s_cmp_eq_u32 s2, 50
    s_cbranch_scc0 L2_noep
    s_cmp_eq_u32 s3, 0
    s_cbranch_scc0 L2_noep
    s_add_u32 s64, s48, 23330816
    s_addc_u32 s65, s49, 0
    v_mov_b32 v28, s98
    v_mov_b32 v30, 0
    s_mov_b64 exec, 1
    buffer_store_dword v28, v30, s[64:67], 0 offen
    s_mov_b64 exec, -1
L2_noep:
L_done:
s_endpgm
.fill 8192, 4, 0xbf800000
.section .rodata,"a"
.p2align 6
.amdhsa_kernel gated_mix__ssm_conv_s5__glu_gated_geglu__prompt_kernel
  .amdhsa_next_free_vgpr 428
  .amdhsa_next_free_sgpr 102
  .amdhsa_accum_offset 256
  .amdhsa_group_segment_fixed_size 0
  .amdhsa_kernarg_size 136
  .amdhsa_user_sgpr_count 2
  .amdhsa_user_sgpr_kernarg_segment_ptr 1
  .amdhsa_system_sgpr_workgroup_id_x 1
.end_amdhsa_kernel
.text
```
